```python
import torch

def _softmax(x, axis=-1):
    return torch.softmax(x, dim=axis)
def _gelu(x):
    return torch.nn.functional.gelu(x, approximate="tanh")
def _silu(x):
    return torch.nn.functional.silu(x)
def _sigmoid(x):
    return torch.sigmoid(x)
def _layernorm(x, axis=-1, eps=1e-5):
    m = x.mean(dim=axis, keepdim=True)
    v = x.var(dim=axis, keepdim=True, unbiased=False)
    return (x - m) / torch.sqrt(v + eps)
def _scatter_add(tgt, idx, src, axis=0):
    return tgt.clone().index_add_(axis, idx, src)
def _segment_sum(src, seg, n):
    out = torch.zeros((n,) + src.shape[1:], dtype=src.dtype)
    return out.index_add_(0, seg, src)
def _pad(x, pw):
    flat = tuple(v for pair in reversed(pw) for v in pair)
    return torch.nn.functional.pad(x, flat)

kernel_name = 'parallel_sum__grouped_kv_mqa__dense_activation_silu__prompt'

def setup_inputs():

    _w = (lambda a: (lambda t: t.to(torch.bfloat16) if t.is_floating_point() else t)(torch.as_tensor(a)))
    def _A_setup():
        B, S, D, H = 1, 2048, 512, 32
        Dh = D // H
        return {
            "x": _w((lambda *s: torch.randn(*s, dtype=torch.bfloat16) * 0.05)(B, S, D)),
            "wq": _w((lambda *s: torch.randn(*s, dtype=torch.bfloat16) * 0.05)(D, H * Dh)),
            "wk": _w((lambda *s: torch.randn(*s, dtype=torch.bfloat16) * 0.05)(D, Dh)),
            "wv": _w((lambda *s: torch.randn(*s, dtype=torch.bfloat16) * 0.05)(D, Dh)),
            "wo": _w((lambda *s: torch.randn(*s, dtype=torch.bfloat16) * 0.05)(H * Dh, D)),
        }
    _A_in = _A_setup()

    def _B_setup():
        B, S, D, F = 1, 2048, 512, 1376
        return {
            "x": _w((lambda *s: torch.randn(*s, dtype=torch.bfloat16) * 0.05)(B, S, D)),
            "w1": _w((lambda *s: torch.randn(*s, dtype=torch.bfloat16) * 0.8)(D, F) * (D ** -0.5)),
            "w2": _w((lambda *s: torch.randn(*s, dtype=torch.bfloat16) * 0.2)(F, D) * (F ** -0.5)),
        }
    _B_in = _B_setup()

    return {
        "A_x": _A_in["x"],
        "A_wq": _A_in["wq"],
        "A_wk": _A_in["wk"],
        "A_wv": _A_in["wv"],
        "A_wo": _A_in["wo"],
        "B_x": _B_in["x"],
        "B_w1": _B_in["w1"],
        "B_w2": _B_in["w2"],
    }

def reference(A_x, A_wq, A_wk, A_wv, A_wo, B_x, B_w1, B_w2):
    def _A_ref(x, wq, wk, wv, wo):
        B, S, D = x.shape
        H = 32
        Dh = D // H
        q = (lambda x, *d: x.permute(*d))((x @ wq).reshape(B, S, H, Dh), 0, 2, 1, 3)
        k = x @ wk
        v = x @ wv
        scores = torch.einsum("bhqd,bkd->bhqk", q, k) * (Dh ** -0.5)
        p = _softmax(scores, axis=-1)
        o = torch.einsum("bhqk,bkd->bhqd", p, v)
        return (lambda x, *d: x.permute(*d))(o, 0, 2, 1, 3).reshape(B, S, H * Dh) @ wo

    def _B_ref(x, w1, w2):
        h = torch.einsum("bsd,df->bsf", x, w1)
        h = _silu(h)
        out = torch.einsum("bsf,fd->bsd", h, w2)
        return out

    x = A_x
    xn = _layernorm(x, axis=-1)
    return x + _A_ref(xn, A_wq, A_wk, A_wv, A_wo) + _B_ref(xn, B_w1, B_w2)
```

```asm
; @launch grid=(256,1,1) block=(512,1,1) lds=163840
.amdgcn_target "amdgcn-amd-amdhsa--gfx950"
.text
.globl parallel_sum__grouped_kv_mqa__dense_activation_silu__prompt_kernel
.p2align 8
.type parallel_sum__grouped_kv_mqa__dense_activation_silu__prompt_kernel,@function
parallel_sum__grouped_kv_mqa__dense_activation_silu__prompt_kernel:
    s_cmp_ge_u32 s2, 256
    s_cbranch_scc1 L_exit
    s_load_dwordx16 s[16:31], s[0:1], 0
    s_load_dwordx4 s[32:35], s[0:1], 64
    s_load_dwordx2 s[36:37], s[0:1], 80
    v_lshrrev_b32 v2, 6, v0
    v_bfe_u32 v4, v0, 4, 4
    s_lshr_b32 s77, s2, 3
    v_readfirstlane_b32 s4, v2
    v_and_b32 v5, 15, v0
    v_and_b32 v0, 63, v0
    s_getpc_b64 s[72:73]
L_pc:
    v_lshl_add_u32 v2, s77, 3, v2
    v_and_b32 v3, 3, v0
    v_lshl_add_u32 v2, v2, 2, v3
    v_lshlrev_b32 v2, 6, v2
    v_min_u32 v2, L_code_end-L_pc-4, v2
    global_load_dword v247, v2, s[72:73]
    s_and_b32 s7, s77, 7
    s_bfe_u32 s71, s2, 0x20001
    s_lshl3_add_u32 s5, s71, s7
    s_lshr_b32 s74, s77, 3
    s_lshl2_add_u32 s65, s5, s74
    s_lshl_b32 s65, s65, 14
    v_lshlrev_b32 v1, 10, v4
    v_lshl_add_u32 v1, v5, 4, v1
    s_mov_b32 s10, 0x200000
    s_mov_b32 s51, 0x20000
    s_bitcmp1_b32 s2, 0
    s_waitcnt lgkmcnt(0)
    s_cselect_b64 s[48:49], s[22:23], s[20:21]
    s_cmp_lt_u32 s4, 4
    s_cselect_b64 s[48:49], s[48:49], s[16:17]
    s_cselect_b32 s50, 0x4000, s10
    s_cselect_b32 s65, 0, s65
    buffer_load_dwordx4 v[8:11], v1, s[48:51], s65 offen
    buffer_load_dwordx4 v[12:15], v1, s[48:51], s65 offen offset:256
    buffer_load_dwordx4 v[16:19], v1, s[48:51], s65 offen offset:512
    buffer_load_dwordx4 v[20:23], v1, s[48:51], s65 offen offset:768
    s_mov_b64 s[8:9], s[16:17]
    s_mov_b32 s11, 0x20000
    s_cbranch_scc1 L_afront
L_hfront:
    s_setprio 2
    v_mov_b32 v232, 0
    v_lshlrev_b32 v233, 2, v0
    v_add_u32 v233, 161280, v233
    ds_write2st64_b32 v233, v232, v232 offset1:1
    s_waitcnt lgkmcnt(0)
    s_barrier
    s_mov_b32 s12, s36
    s_mov_b32 s13, s37
    s_mov_b32 s14, 0x1000000
    s_mov_b32 s15, 0x20000
    s_mov_b32 s44, s34
    s_mov_b32 s45, s35
    s_mov_b32 s46, 0x100
    s_mov_b32 s47, 0x20000
    s_and_b32 s71, s2, 1
    s_lshl2_add_u32 s6, s71, s74
    s_and_b32 s88, s4, 3
    s_mov_b32 s3, 0x40000
    s_lshl_b32 s67, s5, 11
    s_add_u32 s67, s67, 0xe00000
    s_mov_b32 s68, 0x00003f80
    s_mov_b32 s69, 0x3f800000
    s_mov_b32 s70, 0x3f803f80
    v_mul_u32_u24 v2, 1040, v5
    v_lshl_add_u32 v2, v4, 4, v2
    v_lshlrev_b32 v4, 2, v4
    s_lshl2_add_u32 s71, s88, 161280
    v_mov_b32 v253, s71
    v_and_b32 v7, 3, v0
    v_lshlrev_b32 v254, 2, v7
    v_add_u32 v254, 161280, v254
    v_mov_b32 v255, 1
    s_add_u32 s71, s74, 0
    s_and_b32 s71, s71, 3
    s_lshl2_add_u32 s80, s5, s71
    s_lshl_b32 s80, s80, 14
    s_lshl_b32 s72, s71, 8
    s_add_u32 s72, s72, 81920
    v_add_u32 v200, s72, v2
    s_lshl_b32 s72, s71, 6
    s_add_u32 s72, s72, 160768
    v_add_u32 v204, s72, v4
    s_add_u32 s71, s74, 1
    s_and_b32 s71, s71, 3
    s_lshl2_add_u32 s81, s5, s71
    s_lshl_b32 s81, s81, 14
    s_lshl_b32 s72, s71, 8
    s_add_u32 s72, s72, 81920
    v_add_u32 v201, s72, v2
    s_lshl_b32 s72, s71, 6
    s_add_u32 s72, s72, 160768
    v_add_u32 v205, s72, v4
    v_mov_b32 v178, v1
    v_and_b32 v179, 0xfff, v1
    s_lshl_b32 s71, s88, 6
    v_subrev_u32 v2, s71, v2
    v_and_b32 v4, 15, v4
    s_add_u32 s89, s88, 1
    s_add_u32 s71, s74, s89
    s_and_b32 s71, s71, 3
    s_lshl2_add_u32 s82, s5, s71
    s_lshl_b32 s82, s82, 14
    s_lshl_b32 s72, s71, 8
    s_add_u32 s72, s72, 81920
    v_add_u32 v202, s72, v2
    s_lshl_b32 s72, s71, 6
    s_add_u32 s72, s72, 160768
    v_add_u32 v206, s72, v4
    s_mul_i32 s71, s6, 6
    s_lshl1_add_u32 s71, s88, s71
    s_lshl2_add_u32 s72, s6, s88
    s_add_u32 s73, s6, 22
    s_cmp_lt_u32 s88, 3
    s_cselect_b32 s38, s71, s73
    s_cselect_b32 s39, 2, 1
    s_add_u32 s73, s72, 11
    s_cmp_lt_u32 s72, 14
    s_cselect_b32 s38, s38, s73
    s_cselect_b32 s39, s39, 1
    s_add_u32 s86, s88, 1
    s_and_b32 s86, s86, 3
    s_lshl2_add_u32 s71, s86, 161280
    v_mov_b32 v253, s71
    s_lshr_b32 s76, s88, 1
    s_and_b32 s75, s88, 1
    s_mul_i32 s66, s88, 12288
    v_and_b32 v232, 3, v0
    v_bfe_u32 v233, v0, 2, 2
    v_bfe_u32 v234, v0, 4, 1
    v_lshrrev_b32 v235, 5, v0
    v_lshrrev_b32 v236, 2, v0
    v_lshlrev_b32 v251, 4, v0
    v_lshlrev_b32 v3, 3, v232
    v_lshl_add_u32 v3, v233, 6, v3
    v_lshl_add_u32 v3, v234, 5, v3
    v_lshl_add_u32 v3, v235, 8, v3
    v_lshl_add_u32 v74, v235, 8, v3
    s_lshl_b32 s71, s75, 15
    v_add_u32 v172, s71, v74
    v_add_u32 v74, s66, v74
    v_add_u32 v3, s66, v3
    v_lshlrev_b32 v232, 4, v232
    v_lshl_add_u32 v1, v236, 10, v232
    s_lshl_b32 s71, s6, 7
    v_add_u32 v1, s71, v1
    v_add_u32 v60, 64, v1
    v_mul_u32_u24 v72, 2752, v236
    s_lshl_b32 s71, s38, 6
    v_add3_u32 v72, v72, v232, s71
    v_lshl_add_u32 v5, v233, 6, v232
    v_lshl_add_u32 v5, v234, 8, v5
    v_lshl_add_u32 v5, v235, 10, v5
    s_cmp_eq_u32 s75, 0
    s_cselect_b32 s71, 32768, 0
    s_add_u32 s71, s71, 81920
    v_add_u32 v5, s71, v5
    v_lshlrev_b32 v252, 9, v234
    v_lshl_add_u32 v252, v235, 12, v252
    v_and_b32 v232, 31, v0
    v_mul_u32_u24 v233, 1040, v235
    v_lshl_add_u32 v233, v232, 4, v233
    v_add_u32 v233, 81920, v233
    v_lshl_add_u32 v173, s76, 9, v233
    v_min_u32 v62, 20, v232
    v_lshlrev_b32 v62, 5, v62
    v_lshlrev_b32 v232, 2, v232
    v_add_u32 v177, 160768, v232
    v_lshl_add_u32 v174, s76, 7, v177
    s_lshl_b32 s71, s86, 9
    s_add_u32 s71, s71, 156672
    v_add_u32 v4, s71, v232
    s_add_u32 s71, s7, 0
    s_and_b32 s71, s71, 7
    s_mul_i32 s71, s71, 8320
    v_add_u32 v76, s71, v233
    s_add_u32 s71, s7, 1
    s_and_b32 s71, s71, 7
    s_mul_i32 s71, s71, 8320
    v_add_u32 v77, s71, v233
    s_add_u32 s71, s7, 2
    s_and_b32 s71, s71, 7
    s_mul_i32 s71, s71, 8320
    v_add_u32 v78, s71, v233
    s_add_u32 s71, s7, 3
    s_and_b32 s71, s71, 7
    s_mul_i32 s71, s71, 8320
    v_add_u32 v79, s71, v233
    s_add_u32 s71, s7, 4
    s_and_b32 s71, s71, 7
    s_mul_i32 s71, s71, 8320
    v_add_u32 v80, s71, v233
    s_add_u32 s71, s7, 5
    s_and_b32 s71, s71, 7
    s_mul_i32 s71, s71, 8320
    v_add_u32 v81, s71, v233
    s_add_u32 s71, s7, 6
    s_and_b32 s71, s71, 7
    s_mul_i32 s71, s71, 8320
    v_add_u32 v82, s71, v233
    s_add_u32 s71, s7, 7
    s_and_b32 s71, s71, 7
    s_mul_i32 s71, s71, 8320
    v_add_u32 v83, s71, v233
    v_and_b32 v232, 15, v0
    v_lshrrev_b32 v233, 4, v0
    v_min_u32 v176, 11, v232
    v_lshlrev_b32 v176, 2, v176
    v_add_u32 v176, 161280, v176
    v_lshlrev_b32 v249, 10, v232
    v_lshl_add_u32 v249, v233, 4, v249
    v_lshl_add_u32 v232, s76, 4, v232
    v_lshl_add_u32 v252, v232, 4, v252
    v_lshlrev_b32 v248, 4, v232
    v_lshl_add_u32 v248, v233, 10, v248
    v_lshl_add_u32 v248, s75, 12, v248
    v_lshl_add_u32 v175, s88, 11, v251
    v_add_u32 v175, 148480, v175
    v_lshl_add_u32 v2, s86, 11, v251
    v_add_u32 v2, 49152, v2
    v_lshrrev_b32 v75, 1, v0
    v_lshlrev_b32 v75, 10, v75
    v_and_b32 v232, 1, v0
    v_lshl_add_u32 v75, v232, 6, v75
    v_min_u32 v73, 42, v0
    v_lshlrev_b32 v73, 6, v73
    v_mov_b32 v100, -1
    v_mov_b32 v101, -1
    v_mov_b32 v102, -1
    v_mov_b32 v103, -1
    v_mov_b32 v66, 0
    v_mov_b32 v67, 161536
    v_min_u32 v0, 10, v0
    v_lshlrev_b32 v0, 6, v0
    buffer_load_dwordx4 v[24:27], v178, s[8:11], s81 offen
    buffer_load_dwordx4 v[28:31], v178, s[8:11], s81 offen offset:256
    buffer_load_dwordx4 v[32:35], v178, s[8:11], s81 offen offset:512
    buffer_load_dwordx4 v[36:39], v178, s[8:11], s81 offen offset:768
    s_mov_b32 s40, s18
    s_mov_b32 s41, s19
    s_mov_b32 s42, 0x80000
    s_mov_b32 s43, 0x20000
    s_waitcnt vmcnt(4)
    v_dot2_f32_bf16 v216, v8, s70, 0
    v_dot2_f32_bf16 v216, v9, s70, v216
    v_dot2_f32_bf16 v216, v10, s70, v216
    v_dot2_f32_bf16 v216, v11, s70, v216
    v_dot2_f32_bf16 v216, v12, s70, v216
    v_dot2_f32_bf16 v216, v13, s70, v216
    v_dot2_f32_bf16 v216, v14, s70, v216
    v_dot2_f32_bf16 v216, v15, s70, v216
    v_dot2_f32_bf16 v216, v16, s70, v216
    v_dot2_f32_bf16 v216, v17, s70, v216
    v_dot2_f32_bf16 v216, v18, s70, v216
    v_dot2_f32_bf16 v216, v19, s70, v216
    v_dot2_f32_bf16 v216, v20, s70, v216
    v_dot2_f32_bf16 v216, v21, s70, v216
    v_dot2_f32_bf16 v216, v22, s70, v216
    v_dot2_f32_bf16 v216, v23, s70, v216
    s_nop 2
    v_add_f32_dpp v216, v216, v216 row_ror:8 row_mask:0xf bank_mask:0xf
    s_nop 1
    v_add_f32_dpp v216, v216, v216 row_ror:4 row_mask:0xf bank_mask:0xf
    s_nop 1
    v_add_f32_dpp v216, v216, v216 row_ror:2 row_mask:0xf bank_mask:0xf
    s_nop 1
    v_add_f32_dpp v216, v216, v216 row_ror:1 row_mask:0xf bank_mask:0xf
    v_mul_f32 v216, 0xbb000000, v216
    v_dot2_f32_bf16 v220, v8, s68, v216
    v_dot2_f32_bf16 v221, v8, s69, v216
    v_dot2_f32_bf16 v222, v9, s68, v216
    v_dot2_f32_bf16 v223, v9, s69, v216
    v_dot2_f32_bf16 v224, v10, s68, v216
    v_dot2_f32_bf16 v225, v10, s69, v216
    v_dot2_f32_bf16 v226, v11, s68, v216
    v_dot2_f32_bf16 v227, v11, s69, v216
    v_cvt_pk_bf16_f32 v8, v220, v221
    v_cvt_pk_bf16_f32 v9, v222, v223
    v_cvt_pk_bf16_f32 v10, v224, v225
    v_cvt_pk_bf16_f32 v11, v226, v227
    ds_write_b128 v200, v[8:11]
    v_dot2_f32_bf16 v220, v12, s68, v216
    v_dot2_f32_bf16 v221, v12, s69, v216
    v_dot2_f32_bf16 v222, v13, s68, v216
    v_dot2_f32_bf16 v223, v13, s69, v216
    v_dot2_f32_bf16 v224, v14, s68, v216
    v_dot2_f32_bf16 v225, v14, s69, v216
    v_dot2_f32_bf16 v226, v15, s68, v216
    v_dot2_f32_bf16 v227, v15, s69, v216
    v_cvt_pk_bf16_f32 v12, v220, v221
    v_cvt_pk_bf16_f32 v13, v222, v223
    v_cvt_pk_bf16_f32 v14, v224, v225
    v_cvt_pk_bf16_f32 v15, v226, v227
    ds_write_b128 v200, v[12:15] offset:16640
    v_dot2_f32_bf16 v220, v16, s68, v216
    v_dot2_f32_bf16 v221, v16, s69, v216
    v_dot2_f32_bf16 v222, v17, s68, v216
    v_dot2_f32_bf16 v223, v17, s69, v216
    v_dot2_f32_bf16 v224, v18, s68, v216
    v_dot2_f32_bf16 v225, v18, s69, v216
    v_dot2_f32_bf16 v226, v19, s68, v216
    v_dot2_f32_bf16 v227, v19, s69, v216
    v_cvt_pk_bf16_f32 v16, v220, v221
    v_cvt_pk_bf16_f32 v17, v222, v223
    v_cvt_pk_bf16_f32 v18, v224, v225
    v_cvt_pk_bf16_f32 v19, v226, v227
    ds_write_b128 v200, v[16:19] offset:33280
    v_dot2_f32_bf16 v220, v20, s68, v216
    v_dot2_f32_bf16 v221, v20, s69, v216
    v_dot2_f32_bf16 v222, v21, s68, v216
    v_dot2_f32_bf16 v223, v21, s69, v216
    v_dot2_f32_bf16 v224, v22, s68, v216
    v_dot2_f32_bf16 v225, v22, s69, v216
    v_dot2_f32_bf16 v226, v23, s68, v216
    v_dot2_f32_bf16 v227, v23, s69, v216
    v_cvt_pk_bf16_f32 v20, v220, v221
    v_cvt_pk_bf16_f32 v21, v222, v223
    v_cvt_pk_bf16_f32 v22, v224, v225
    v_cvt_pk_bf16_f32 v23, v226, v227
    ds_write_b128 v200, v[20:23] offset:49920
    ds_write_b32 v253, v255 offset:208
    s_bitcmp1_b32 s89, 1
    s_cbranch_scc0 L_no3
    buffer_load_dwordx4 v[40:43], v179, s[8:11], s82 offen
    buffer_load_dwordx4 v[44:47], v179, s[8:11], s82 offen offset:256
    buffer_load_dwordx4 v[48:51], v179, s[8:11], s82 offen offset:512
    buffer_load_dwordx4 v[52:55], v179, s[8:11], s82 offen offset:768
L_no3:
    v_dot2_f32_bf16 v217, v8, v8, 0
    v_dot2_f32_bf16 v217, v9, v9, v217
    v_dot2_f32_bf16 v217, v10, v10, v217
    v_dot2_f32_bf16 v217, v11, v11, v217
    v_dot2_f32_bf16 v217, v12, v12, v217
    v_dot2_f32_bf16 v217, v13, v13, v217
    v_dot2_f32_bf16 v217, v14, v14, v217
    v_dot2_f32_bf16 v217, v15, v15, v217
    v_dot2_f32_bf16 v217, v16, v16, v217
    v_dot2_f32_bf16 v217, v17, v17, v217
    v_dot2_f32_bf16 v217, v18, v18, v217
    v_dot2_f32_bf16 v217, v19, v19, v217
    v_dot2_f32_bf16 v217, v20, v20, v217
    v_dot2_f32_bf16 v217, v21, v21, v217
    v_dot2_f32_bf16 v217, v22, v22, v217
    v_dot2_f32_bf16 v217, v23, v23, v217
    s_nop 2
    v_add_f32_dpp v217, v217, v217 row_ror:8 row_mask:0xf bank_mask:0xf
    s_nop 1
    v_add_f32_dpp v217, v217, v217 row_ror:4 row_mask:0xf bank_mask:0xf
    s_nop 1
    v_add_f32_dpp v217, v217, v217 row_ror:2 row_mask:0xf bank_mask:0xf
    s_nop 1
    v_add_f32_dpp v217, v217, v217 row_ror:1 row_mask:0xf bank_mask:0xf
    v_mov_b32 v216, 0x3727c5ac
    v_fmac_f32 v216, 0x3b000000, v217
    v_rsq_f32 v217, v216
    s_waitcnt lgkmcnt(5)
    v_mul_f32 v216, v216, v217
    ds_write_b32 v204, v217
    ds_write_b32 v204, v216 offset:256
    ds_write_b32 v253, v255 offset:128
    s_bitcmp1_b32 s89, 1
    s_cbranch_scc0 L_ln1
    s_waitcnt vmcnt(4)
    v_dot2_f32_bf16 v216, v24, s70, 0
    v_dot2_f32_bf16 v216, v25, s70, v216
    v_dot2_f32_bf16 v216, v26, s70, v216
    v_dot2_f32_bf16 v216, v27, s70, v216
    v_dot2_f32_bf16 v216, v28, s70, v216
    v_dot2_f32_bf16 v216, v29, s70, v216
    v_dot2_f32_bf16 v216, v30, s70, v216
    v_dot2_f32_bf16 v216, v31, s70, v216
    v_dot2_f32_bf16 v216, v32, s70, v216
    v_dot2_f32_bf16 v216, v33, s70, v216
    v_dot2_f32_bf16 v216, v34, s70, v216
    v_dot2_f32_bf16 v216, v35, s70, v216
    v_dot2_f32_bf16 v216, v36, s70, v216
    v_dot2_f32_bf16 v216, v37, s70, v216
    v_dot2_f32_bf16 v216, v38, s70, v216
    v_dot2_f32_bf16 v216, v39, s70, v216
    s_nop 2
    v_add_f32_dpp v216, v216, v216 row_ror:8 row_mask:0xf bank_mask:0xf
    s_nop 1
    v_add_f32_dpp v216, v216, v216 row_ror:4 row_mask:0xf bank_mask:0xf
    s_nop 1
    v_add_f32_dpp v216, v216, v216 row_ror:2 row_mask:0xf bank_mask:0xf
    s_nop 1
    v_add_f32_dpp v216, v216, v216 row_ror:1 row_mask:0xf bank_mask:0xf
    v_mul_f32 v216, 0xbb000000, v216
    v_dot2_f32_bf16 v220, v24, s68, v216
    v_dot2_f32_bf16 v221, v24, s69, v216
    v_dot2_f32_bf16 v222, v25, s68, v216
    v_dot2_f32_bf16 v223, v25, s69, v216
    v_dot2_f32_bf16 v224, v26, s68, v216
    v_dot2_f32_bf16 v225, v26, s69, v216
    v_dot2_f32_bf16 v226, v27, s68, v216
    v_dot2_f32_bf16 v227, v27, s69, v216
    v_cvt_pk_bf16_f32 v24, v220, v221
    v_cvt_pk_bf16_f32 v25, v222, v223
    v_cvt_pk_bf16_f32 v26, v224, v225
    v_cvt_pk_bf16_f32 v27, v226, v227
    ds_write_b128 v201, v[24:27]
    v_dot2_f32_bf16 v218, v24, v24, 0
    v_dot2_f32_bf16 v218, v25, v25, v218
    v_dot2_f32_bf16 v218, v26, v26, v218
    v_dot2_f32_bf16 v218, v27, v27, v218
    v_dot2_f32_bf16 v220, v28, s68, v216
    v_dot2_f32_bf16 v221, v28, s69, v216
    v_dot2_f32_bf16 v222, v29, s68, v216
    v_dot2_f32_bf16 v223, v29, s69, v216
    v_dot2_f32_bf16 v224, v30, s68, v216
    v_dot2_f32_bf16 v225, v30, s69, v216
    v_dot2_f32_bf16 v226, v31, s68, v216
    v_dot2_f32_bf16 v227, v31, s69, v216
    v_cvt_pk_bf16_f32 v28, v220, v221
    v_cvt_pk_bf16_f32 v29, v222, v223
    v_cvt_pk_bf16_f32 v30, v224, v225
    v_cvt_pk_bf16_f32 v31, v226, v227
    ds_write_b128 v201, v[28:31] offset:16640
    v_dot2_f32_bf16 v218, v28, v28, v218
    v_dot2_f32_bf16 v218, v29, v29, v218
    v_dot2_f32_bf16 v218, v30, v30, v218
    v_dot2_f32_bf16 v218, v31, v31, v218
    v_dot2_f32_bf16 v220, v32, s68, v216
    v_dot2_f32_bf16 v221, v32, s69, v216
    v_dot2_f32_bf16 v222, v33, s68, v216
    v_dot2_f32_bf16 v223, v33, s69, v216
    v_dot2_f32_bf16 v224, v34, s68, v216
    v_dot2_f32_bf16 v225, v34, s69, v216
    v_dot2_f32_bf16 v226, v35, s68, v216
    v_dot2_f32_bf16 v227, v35, s69, v216
    v_cvt_pk_bf16_f32 v32, v220, v221
    v_cvt_pk_bf16_f32 v33, v222, v223
    v_cvt_pk_bf16_f32 v34, v224, v225
    v_cvt_pk_bf16_f32 v35, v226, v227
    ds_write_b128 v201, v[32:35] offset:33280
    v_dot2_f32_bf16 v218, v32, v32, v218
    v_dot2_f32_bf16 v218, v33, v33, v218
    v_dot2_f32_bf16 v218, v34, v34, v218
    v_dot2_f32_bf16 v218, v35, v35, v218
    v_dot2_f32_bf16 v220, v36, s68, v216
    v_dot2_f32_bf16 v221, v36, s69, v216
    v_dot2_f32_bf16 v222, v37, s68, v216
    v_dot2_f32_bf16 v223, v37, s69, v216
    v_dot2_f32_bf16 v224, v38, s68, v216
    v_dot2_f32_bf16 v225, v38, s69, v216
    v_dot2_f32_bf16 v226, v39, s68, v216
    v_dot2_f32_bf16 v227, v39, s69, v216
    v_cvt_pk_bf16_f32 v36, v220, v221
    v_cvt_pk_bf16_f32 v37, v222, v223
    v_cvt_pk_bf16_f32 v38, v224, v225
    v_cvt_pk_bf16_f32 v39, v226, v227
    ds_write_b128 v201, v[36:39] offset:49920
    v_dot2_f32_bf16 v218, v36, v36, v218
    v_dot2_f32_bf16 v218, v37, v37, v218
    v_dot2_f32_bf16 v218, v38, v38, v218
    v_dot2_f32_bf16 v218, v39, v39, v218
    s_waitcnt vmcnt(0)
    v_dot2_f32_bf16 v217, v40, s70, 0
    v_dot2_f32_bf16 v217, v41, s70, v217
    v_dot2_f32_bf16 v217, v42, s70, v217
    v_dot2_f32_bf16 v217, v43, s70, v217
    v_dot2_f32_bf16 v217, v44, s70, v217
    v_dot2_f32_bf16 v217, v45, s70, v217
    v_dot2_f32_bf16 v217, v46, s70, v217
    v_dot2_f32_bf16 v217, v47, s70, v217
    v_dot2_f32_bf16 v217, v48, s70, v217
    v_dot2_f32_bf16 v217, v49, s70, v217
    v_dot2_f32_bf16 v217, v50, s70, v217
    v_dot2_f32_bf16 v217, v51, s70, v217
    v_dot2_f32_bf16 v217, v52, s70, v217
    v_dot2_f32_bf16 v217, v53, s70, v217
    v_dot2_f32_bf16 v217, v54, s70, v217
    v_dot2_f32_bf16 v217, v55, s70, v217
    s_nop 2
    v_add_f32_dpp v217, v217, v217 row_ror:8 row_mask:0xf bank_mask:0xf
    s_nop 1
    v_add_f32_dpp v217, v217, v217 row_ror:4 row_mask:0xf bank_mask:0xf
    s_nop 1
    v_add_f32_dpp v217, v217, v217 row_ror:2 row_mask:0xf bank_mask:0xf
    s_nop 1
    v_add_f32_dpp v217, v217, v217 row_ror:1 row_mask:0xf bank_mask:0xf
    v_mul_f32 v217, 0xbb000000, v217
    v_dot2_f32_bf16 v220, v40, s68, v217
    v_dot2_f32_bf16 v221, v40, s69, v217
    v_dot2_f32_bf16 v222, v41, s68, v217
    v_dot2_f32_bf16 v223, v41, s69, v217
    v_dot2_f32_bf16 v224, v42, s68, v217
    v_dot2_f32_bf16 v225, v42, s69, v217
    v_dot2_f32_bf16 v226, v43, s68, v217
    v_dot2_f32_bf16 v227, v43, s69, v217
    v_cvt_pk_bf16_f32 v40, v220, v221
    v_cvt_pk_bf16_f32 v41, v222, v223
    v_cvt_pk_bf16_f32 v42, v224, v225
    v_cvt_pk_bf16_f32 v43, v226, v227
    ds_write_b128 v202, v[40:43]
    v_dot2_f32_bf16 v219, v40, v40, 0
    v_dot2_f32_bf16 v219, v41, v41, v219
    v_dot2_f32_bf16 v219, v42, v42, v219
    v_dot2_f32_bf16 v219, v43, v43, v219
    v_dot2_f32_bf16 v220, v44, s68, v217
    v_dot2_f32_bf16 v221, v44, s69, v217
    v_dot2_f32_bf16 v222, v45, s68, v217
    v_dot2_f32_bf16 v223, v45, s69, v217
    v_dot2_f32_bf16 v224, v46, s68, v217
    v_dot2_f32_bf16 v225, v46, s69, v217
    v_dot2_f32_bf16 v226, v47, s68, v217
    v_dot2_f32_bf16 v227, v47, s69, v217
    v_cvt_pk_bf16_f32 v44, v220, v221
    v_cvt_pk_bf16_f32 v45, v222, v223
    v_cvt_pk_bf16_f32 v46, v224, v225
    v_cvt_pk_bf16_f32 v47, v226, v227
    ds_write_b128 v202, v[44:47] offset:16640
    v_dot2_f32_bf16 v219, v44, v44, v219
    v_dot2_f32_bf16 v219, v45, v45, v219
    v_dot2_f32_bf16 v219, v46, v46, v219
    v_dot2_f32_bf16 v219, v47, v47, v219
    v_dot2_f32_bf16 v220, v48, s68, v217
    v_dot2_f32_bf16 v221, v48, s69, v217
    v_dot2_f32_bf16 v222, v49, s68, v217
    v_dot2_f32_bf16 v223, v49, s69, v217
    v_dot2_f32_bf16 v224, v50, s68, v217
    v_dot2_f32_bf16 v225, v50, s69, v217
    v_dot2_f32_bf16 v226, v51, s68, v217
    v_dot2_f32_bf16 v227, v51, s69, v217
    v_cvt_pk_bf16_f32 v48, v220, v221
    v_cvt_pk_bf16_f32 v49, v222, v223
    v_cvt_pk_bf16_f32 v50, v224, v225
    v_cvt_pk_bf16_f32 v51, v226, v227
    ds_write_b128 v202, v[48:51] offset:33280
    v_dot2_f32_bf16 v219, v48, v48, v219
    v_dot2_f32_bf16 v219, v49, v49, v219
    v_dot2_f32_bf16 v219, v50, v50, v219
    v_dot2_f32_bf16 v219, v51, v51, v219
    v_dot2_f32_bf16 v220, v52, s68, v217
    v_dot2_f32_bf16 v221, v52, s69, v217
    v_dot2_f32_bf16 v222, v53, s68, v217
    v_dot2_f32_bf16 v223, v53, s69, v217
    v_dot2_f32_bf16 v224, v54, s68, v217
    v_dot2_f32_bf16 v225, v54, s69, v217
    v_dot2_f32_bf16 v226, v55, s68, v217
    v_dot2_f32_bf16 v227, v55, s69, v217
    v_cvt_pk_bf16_f32 v52, v220, v221
    v_cvt_pk_bf16_f32 v53, v222, v223
    v_cvt_pk_bf16_f32 v54, v224, v225
    v_cvt_pk_bf16_f32 v55, v226, v227
    ds_write_b128 v202, v[52:55] offset:49920
    v_dot2_f32_bf16 v219, v52, v52, v219
    v_dot2_f32_bf16 v219, v53, v53, v219
    v_dot2_f32_bf16 v219, v54, v54, v219
    v_dot2_f32_bf16 v219, v55, v55, v219
    s_nop 1
    v_add_f32_dpp v218, v218, v218 row_ror:8 row_mask:0xf bank_mask:0xf
    v_add_f32_dpp v219, v219, v219 row_ror:8 row_mask:0xf bank_mask:0xf
    s_nop 0
    v_add_f32_dpp v218, v218, v218 row_ror:4 row_mask:0xf bank_mask:0xf
    v_add_f32_dpp v219, v219, v219 row_ror:4 row_mask:0xf bank_mask:0xf
    s_nop 0
    v_add_f32_dpp v218, v218, v218 row_ror:2 row_mask:0xf bank_mask:0xf
    v_add_f32_dpp v219, v219, v219 row_ror:2 row_mask:0xf bank_mask:0xf
    s_nop 0
    v_add_f32_dpp v218, v218, v218 row_ror:1 row_mask:0xf bank_mask:0xf
    v_add_f32_dpp v219, v219, v219 row_ror:1 row_mask:0xf bank_mask:0xf
    v_mov_b32 v216, 0x3727c5ac
    v_fmac_f32 v216, 0x3b000000, v218
    v_mov_b32 v217, 0x3727c5ac
    v_fmac_f32 v217, 0x3b000000, v219
    v_rsq_f32 v218, v216
    v_rsq_f32 v219, v217
    s_waitcnt lgkmcnt(5)
    v_mul_f32 v216, v216, v218
    ds_write_b32 v205, v218
    ds_write_b32 v205, v216 offset:256
    v_mul_f32 v217, v217, v219
    ds_write_b32 v206, v219
    ds_write_b32 v206, v217 offset:256
    s_branch L_ln2
L_ln1:
    s_waitcnt vmcnt(0)
    v_dot2_f32_bf16 v216, v24, s70, 0
    v_dot2_f32_bf16 v216, v25, s70, v216
    v_dot2_f32_bf16 v216, v26, s70, v216
    v_dot2_f32_bf16 v216, v27, s70, v216
    v_dot2_f32_bf16 v216, v28, s70, v216
    v_dot2_f32_bf16 v216, v29, s70, v216
    v_dot2_f32_bf16 v216, v30, s70, v216
    v_dot2_f32_bf16 v216, v31, s70, v216
    v_dot2_f32_bf16 v216, v32, s70, v216
    v_dot2_f32_bf16 v216, v33, s70, v216
    v_dot2_f32_bf16 v216, v34, s70, v216
    v_dot2_f32_bf16 v216, v35, s70, v216
    v_dot2_f32_bf16 v216, v36, s70, v216
    v_dot2_f32_bf16 v216, v37, s70, v216
    v_dot2_f32_bf16 v216, v38, s70, v216
    v_dot2_f32_bf16 v216, v39, s70, v216
    s_nop 2
    v_add_f32_dpp v216, v216, v216 row_ror:8 row_mask:0xf bank_mask:0xf
    s_nop 1
    v_add_f32_dpp v216, v216, v216 row_ror:4 row_mask:0xf bank_mask:0xf
    s_nop 1
    v_add_f32_dpp v216, v216, v216 row_ror:2 row_mask:0xf bank_mask:0xf
    s_nop 1
    v_add_f32_dpp v216, v216, v216 row_ror:1 row_mask:0xf bank_mask:0xf
    v_mul_f32 v216, 0xbb000000, v216
    v_dot2_f32_bf16 v220, v24, s68, v216
    v_dot2_f32_bf16 v221, v24, s69, v216
    v_dot2_f32_bf16 v222, v25, s68, v216
    v_dot2_f32_bf16 v223, v25, s69, v216
    v_dot2_f32_bf16 v224, v26, s68, v216
    v_dot2_f32_bf16 v225, v26, s69, v216
    v_dot2_f32_bf16 v226, v27, s68, v216
    v_dot2_f32_bf16 v227, v27, s69, v216
    v_cvt_pk_bf16_f32 v24, v220, v221
    v_cvt_pk_bf16_f32 v25, v222, v223
    v_cvt_pk_bf16_f32 v26, v224, v225
    v_cvt_pk_bf16_f32 v27, v226, v227
    ds_write_b128 v201, v[24:27]
    v_dot2_f32_bf16 v217, v24, v24, 0
    v_dot2_f32_bf16 v217, v25, v25, v217
    v_dot2_f32_bf16 v217, v26, v26, v217
    v_dot2_f32_bf16 v217, v27, v27, v217
    v_dot2_f32_bf16 v220, v28, s68, v216
    v_dot2_f32_bf16 v221, v28, s69, v216
    v_dot2_f32_bf16 v222, v29, s68, v216
    v_dot2_f32_bf16 v223, v29, s69, v216
    v_dot2_f32_bf16 v224, v30, s68, v216
    v_dot2_f32_bf16 v225, v30, s69, v216
    v_dot2_f32_bf16 v226, v31, s68, v216
    v_dot2_f32_bf16 v227, v31, s69, v216
    v_cvt_pk_bf16_f32 v28, v220, v221
    v_cvt_pk_bf16_f32 v29, v222, v223
    v_cvt_pk_bf16_f32 v30, v224, v225
    v_cvt_pk_bf16_f32 v31, v226, v227
    ds_write_b128 v201, v[28:31] offset:16640
    v_dot2_f32_bf16 v217, v28, v28, v217
    v_dot2_f32_bf16 v217, v29, v29, v217
    v_dot2_f32_bf16 v217, v30, v30, v217
    v_dot2_f32_bf16 v217, v31, v31, v217
    v_dot2_f32_bf16 v220, v32, s68, v216
    v_dot2_f32_bf16 v221, v32, s69, v216
    v_dot2_f32_bf16 v222, v33, s68, v216
    v_dot2_f32_bf16 v223, v33, s69, v216
    v_dot2_f32_bf16 v224, v34, s68, v216
    v_dot2_f32_bf16 v225, v34, s69, v216
    v_dot2_f32_bf16 v226, v35, s68, v216
    v_dot2_f32_bf16 v227, v35, s69, v216
    v_cvt_pk_bf16_f32 v32, v220, v221
    v_cvt_pk_bf16_f32 v33, v222, v223
    v_cvt_pk_bf16_f32 v34, v224, v225
    v_cvt_pk_bf16_f32 v35, v226, v227
    ds_write_b128 v201, v[32:35] offset:33280
    v_dot2_f32_bf16 v217, v32, v32, v217
    v_dot2_f32_bf16 v217, v33, v33, v217
    v_dot2_f32_bf16 v217, v34, v34, v217
    v_dot2_f32_bf16 v217, v35, v35, v217
    v_dot2_f32_bf16 v220, v36, s68, v216
    v_dot2_f32_bf16 v221, v36, s69, v216
    v_dot2_f32_bf16 v222, v37, s68, v216
    v_dot2_f32_bf16 v223, v37, s69, v216
    v_dot2_f32_bf16 v224, v38, s68, v216
    v_dot2_f32_bf16 v225, v38, s69, v216
    v_dot2_f32_bf16 v226, v39, s68, v216
    v_dot2_f32_bf16 v227, v39, s69, v216
    v_cvt_pk_bf16_f32 v36, v220, v221
    v_cvt_pk_bf16_f32 v37, v222, v223
    v_cvt_pk_bf16_f32 v38, v224, v225
    v_cvt_pk_bf16_f32 v39, v226, v227
    ds_write_b128 v201, v[36:39] offset:49920
    v_dot2_f32_bf16 v217, v36, v36, v217
    v_dot2_f32_bf16 v217, v37, v37, v217
    v_dot2_f32_bf16 v217, v38, v38, v217
    v_dot2_f32_bf16 v217, v39, v39, v217
    s_nop 2
    v_add_f32_dpp v217, v217, v217 row_ror:8 row_mask:0xf bank_mask:0xf
    s_nop 1
    v_add_f32_dpp v217, v217, v217 row_ror:4 row_mask:0xf bank_mask:0xf
    s_nop 1
    v_add_f32_dpp v217, v217, v217 row_ror:2 row_mask:0xf bank_mask:0xf
    s_nop 1
    v_add_f32_dpp v217, v217, v217 row_ror:1 row_mask:0xf bank_mask:0xf
    v_mov_b32 v216, 0x3727c5ac
    v_fmac_f32 v216, 0x3b000000, v217
    v_rsq_f32 v217, v216
    s_waitcnt lgkmcnt(5)
    v_mul_f32 v216, v216, v217
    ds_write_b32 v205, v217
    ds_write_b32 v205, v216 offset:256
L_ln2:
    ds_write_b32 v253, v255 offset:0
    s_setprio 0
    s_cmp_eq_u32 s4, 7
    s_cbranch_scc0 L_wqdone
    s_mov_b32 m0, 0
    s_mov_b32 s65, 0
    buffer_load_dwordx4 v1, s[40:43], s65 offen lds
    s_mov_b32 m0, 32768
    s_nop 0
    buffer_load_dwordx4 v60, s[40:43], s65 offen lds
    s_mov_b32 m0, 1024
    s_mov_b32 s65, 16384
    buffer_load_dwordx4 v1, s[40:43], s65 offen lds
    s_mov_b32 m0, 33792
    s_nop 0
    buffer_load_dwordx4 v60, s[40:43], s65 offen lds
    s_mov_b32 m0, 2048
    s_mov_b32 s65, 32768
    buffer_load_dwordx4 v1, s[40:43], s65 offen lds
    s_mov_b32 m0, 34816
    s_nop 0
    buffer_load_dwordx4 v60, s[40:43], s65 offen lds
    s_mov_b32 m0, 3072
    s_mov_b32 s65, 49152
    buffer_load_dwordx4 v1, s[40:43], s65 offen lds
    s_mov_b32 m0, 35840
    s_nop 0
    buffer_load_dwordx4 v60, s[40:43], s65 offen lds
    s_mov_b32 m0, 4096
    s_mov_b32 s65, 65536
    buffer_load_dwordx4 v1, s[40:43], s65 offen lds
    s_mov_b32 m0, 36864
    s_nop 0
    buffer_load_dwordx4 v60, s[40:43], s65 offen lds
    s_mov_b32 m0, 5120
    s_mov_b32 s65, 81920
    buffer_load_dwordx4 v1, s[40:43], s65 offen lds
    s_mov_b32 m0, 37888
    s_nop 0
    buffer_load_dwordx4 v60, s[40:43], s65 offen lds
    s_mov_b32 m0, 6144
    s_mov_b32 s65, 98304
    buffer_load_dwordx4 v1, s[40:43], s65 offen lds
    s_mov_b32 m0, 38912
    s_nop 0
    buffer_load_dwordx4 v60, s[40:43], s65 offen lds
    s_mov_b32 m0, 7168
    s_mov_b32 s65, 114688
    buffer_load_dwordx4 v1, s[40:43], s65 offen lds
    s_mov_b32 m0, 39936
    s_nop 0
    buffer_load_dwordx4 v60, s[40:43], s65 offen lds
    s_mov_b32 m0, 8192
    s_mov_b32 s65, 131072
    buffer_load_dwordx4 v1, s[40:43], s65 offen lds
    s_mov_b32 m0, 40960
    s_nop 0
    buffer_load_dwordx4 v60, s[40:43], s65 offen lds
    s_mov_b32 m0, 9216
    s_mov_b32 s65, 147456
    buffer_load_dwordx4 v1, s[40:43], s65 offen lds
    s_mov_b32 m0, 41984
    s_nop 0
    buffer_load_dwordx4 v60, s[40:43], s65 offen lds
    s_mov_b32 m0, 10240
    s_mov_b32 s65, 163840
    buffer_load_dwordx4 v1, s[40:43], s65 offen lds
    s_mov_b32 m0, 43008
    s_nop 0
    buffer_load_dwordx4 v60, s[40:43], s65 offen lds
    s_mov_b32 m0, 11264
    s_mov_b32 s65, 180224
    buffer_load_dwordx4 v1, s[40:43], s65 offen lds
    s_mov_b32 m0, 44032
    s_nop 0
    buffer_load_dwordx4 v60, s[40:43], s65 offen lds
    s_mov_b32 m0, 12288
    s_mov_b32 s65, 196608
    buffer_load_dwordx4 v1, s[40:43], s65 offen lds
    s_mov_b32 m0, 45056
    s_nop 0
    buffer_load_dwordx4 v60, s[40:43], s65 offen lds
    s_mov_b32 m0, 13312
    s_mov_b32 s65, 212992
    buffer_load_dwordx4 v1, s[40:43], s65 offen lds
    s_mov_b32 m0, 46080
    s_nop 0
    buffer_load_dwordx4 v60, s[40:43], s65 offen lds
    s_mov_b32 m0, 14336
    s_mov_b32 s65, 229376
    buffer_load_dwordx4 v1, s[40:43], s65 offen lds
    s_mov_b32 m0, 47104
    s_nop 0
    buffer_load_dwordx4 v60, s[40:43], s65 offen lds
    s_mov_b32 m0, 15360
    s_mov_b32 s65, 245760
    buffer_load_dwordx4 v1, s[40:43], s65 offen lds
    s_mov_b32 m0, 48128
    s_nop 0
    buffer_load_dwordx4 v60, s[40:43], s65 offen lds
    s_mov_b32 m0, 16384
    s_mov_b32 s65, 262144
    buffer_load_dwordx4 v1, s[40:43], s65 offen lds
    s_mov_b32 m0, 49152
    s_nop 0
    buffer_load_dwordx4 v60, s[40:43], s65 offen lds
    s_mov_b32 m0, 17408
    s_mov_b32 s65, 278528
    buffer_load_dwordx4 v1, s[40:43], s65 offen lds
    s_mov_b32 m0, 50176
    s_nop 0
    buffer_load_dwordx4 v60, s[40:43], s65 offen lds
    s_mov_b32 m0, 18432
    s_mov_b32 s65, 294912
    buffer_load_dwordx4 v1, s[40:43], s65 offen lds
    s_mov_b32 m0, 51200
    s_nop 0
    buffer_load_dwordx4 v60, s[40:43], s65 offen lds
    s_mov_b32 m0, 19456
    s_mov_b32 s65, 311296
    buffer_load_dwordx4 v1, s[40:43], s65 offen lds
    s_mov_b32 m0, 52224
    s_nop 0
    buffer_load_dwordx4 v60, s[40:43], s65 offen lds
    s_mov_b32 m0, 20480
    s_mov_b32 s65, 327680
    buffer_load_dwordx4 v1, s[40:43], s65 offen lds
    s_mov_b32 m0, 53248
    s_nop 0
    buffer_load_dwordx4 v60, s[40:43], s65 offen lds
    s_mov_b32 m0, 21504
    s_mov_b32 s65, 344064
    buffer_load_dwordx4 v1, s[40:43], s65 offen lds
    s_mov_b32 m0, 54272
    s_nop 0
    buffer_load_dwordx4 v60, s[40:43], s65 offen lds
    s_mov_b32 m0, 22528
    s_mov_b32 s65, 360448
    buffer_load_dwordx4 v1, s[40:43], s65 offen lds
    s_mov_b32 m0, 55296
    s_nop 0
    buffer_load_dwordx4 v60, s[40:43], s65 offen lds
    s_mov_b32 m0, 23552
    s_mov_b32 s65, 376832
    buffer_load_dwordx4 v1, s[40:43], s65 offen lds
    s_mov_b32 m0, 56320
    s_nop 0
    buffer_load_dwordx4 v60, s[40:43], s65 offen lds
    s_waitcnt vmcnt(16)
    ds_write_b32 v254, v255 offset:304
    s_mov_b32 m0, 24576
    s_mov_b32 s65, 393216
    buffer_load_dwordx4 v1, s[40:43], s65 offen lds
    s_mov_b32 m0, 57344
    s_nop 0
    buffer_load_dwordx4 v60, s[40:43], s65 offen lds
    s_mov_b32 m0, 25600
    s_mov_b32 s65, 409600
    buffer_load_dwordx4 v1, s[40:43], s65 offen lds
    s_mov_b32 m0, 58368
    s_nop 0
    buffer_load_dwordx4 v60, s[40:43], s65 offen lds
    s_mov_b32 m0, 26624
    s_mov_b32 s65, 425984
    buffer_load_dwordx4 v1, s[40:43], s65 offen lds
    s_mov_b32 m0, 59392
    s_nop 0
    buffer_load_dwordx4 v60, s[40:43], s65 offen lds
    s_mov_b32 m0, 27648
    s_mov_b32 s65, 442368
    buffer_load_dwordx4 v1, s[40:43], s65 offen lds
    s_mov_b32 m0, 60416
    s_nop 0
    buffer_load_dwordx4 v60, s[40:43], s65 offen lds
    s_mov_b32 m0, 28672
    s_mov_b32 s65, 458752
    buffer_load_dwordx4 v1, s[40:43], s65 offen lds
    s_mov_b32 m0, 61440
    s_nop 0
    buffer_load_dwordx4 v60, s[40:43], s65 offen lds
    s_mov_b32 m0, 29696
    s_mov_b32 s65, 475136
    buffer_load_dwordx4 v1, s[40:43], s65 offen lds
    s_mov_b32 m0, 62464
    s_nop 0
    buffer_load_dwordx4 v60, s[40:43], s65 offen lds
    s_mov_b32 m0, 30720
    s_mov_b32 s65, 491520
    buffer_load_dwordx4 v1, s[40:43], s65 offen lds
    s_mov_b32 m0, 63488
    s_nop 0
    buffer_load_dwordx4 v60, s[40:43], s65 offen lds
    s_mov_b32 m0, 31744
    s_mov_b32 s65, 507904
    buffer_load_dwordx4 v1, s[40:43], s65 offen lds
    s_mov_b32 m0, 64512
    s_nop 0
    buffer_load_dwordx4 v60, s[40:43], s65 offen lds
    ds_write_b32 v254, v255 offset:336
    s_waitcnt vmcnt(0)
    ds_write_b32 v254, v255 offset:32
L_wqdone:
L_spin_1:
    ds_read_b32 v250, v254 offset:304
    s_waitcnt lgkmcnt(0)
    v_cmp_ne_u32 vcc, 1, v250
    s_nop 0
    s_cbranch_vccnz L_retry_2
    ds_read_b64_tr_b16 v[108:109], v172
    ds_read_b64_tr_b16 v[110:111], v172 offset:256
    ds_read_b64_tr_b16 v[112:113], v172 offset:1024
    ds_read_b64_tr_b16 v[114:115], v172 offset:1280
    ds_read_b64_tr_b16 v[116:117], v172 offset:2048
    ds_read_b64_tr_b16 v[118:119], v172 offset:2304
    ds_read_b64_tr_b16 v[120:121], v172 offset:3072
    ds_read_b64_tr_b16 v[122:123], v172 offset:3328
    s_waitcnt lgkmcnt(4)
    ds_read_b64_tr_b16 v[124:125], v172 offset:4096
    ds_read_b64_tr_b16 v[126:127], v172 offset:4352
    ds_read_b64_tr_b16 v[128:129], v172 offset:5120
    ds_read_b64_tr_b16 v[130:131], v172 offset:5376
    ds_read_b64_tr_b16 v[132:133], v172 offset:6144
    ds_read_b64_tr_b16 v[134:135], v172 offset:6400
    ds_read_b64_tr_b16 v[136:137], v172 offset:7168
    ds_read_b64_tr_b16 v[138:139], v172 offset:7424
    s_waitcnt lgkmcnt(4)
    ds_read_b64_tr_b16 v[140:141], v172 offset:8192
    ds_read_b64_tr_b16 v[142:143], v172 offset:8448
    ds_read_b64_tr_b16 v[144:145], v172 offset:9216
    ds_read_b64_tr_b16 v[146:147], v172 offset:9472
    ds_read_b64_tr_b16 v[148:149], v172 offset:10240
    ds_read_b64_tr_b16 v[150:151], v172 offset:10496
    ds_read_b64_tr_b16 v[152:153], v172 offset:11264
    ds_read_b64_tr_b16 v[154:155], v172 offset:11520
    s_waitcnt lgkmcnt(4)
    ds_read_b64_tr_b16 v[156:157], v172 offset:12288
    ds_read_b64_tr_b16 v[158:159], v172 offset:12544
    ds_read_b64_tr_b16 v[160:161], v172 offset:13312
    ds_read_b64_tr_b16 v[162:163], v172 offset:13568
    ds_read_b64_tr_b16 v[164:165], v172 offset:14336
    ds_read_b64_tr_b16 v[166:167], v172 offset:14592
    ds_read_b64_tr_b16 v[168:169], v172 offset:15360
    ds_read_b64_tr_b16 v[170:171], v172 offset:15616
L_spin_3:
    ds_read_b32 v250, v176
    s_waitcnt lgkmcnt(0)
    v_cmp_ne_u32 vcc, 1, v250
    s_nop 0
    s_cbranch_vccnz L_retry_4
    s_setprio 2
    ds_read_b128 v[8:11], v173
    ds_read_b128 v[12:15], v173 offset:2080
    ds_read_b128 v[16:19], v173 offset:4160
    ds_read_b128 v[20:23], v173 offset:6240
    ds_read_b32 v92, v177
    s_waitcnt lgkmcnt(4)
    v_mfma_f32_32x32x16_bf16 v[200:215], v[108:111], v[8:11], 0
    ds_read_b128 v[8:11], v173 offset:8320
    ds_read_b32 v94, v177 offset:128
    s_waitcnt lgkmcnt(5)
    v_mfma_f32_32x32x16_bf16 v[200:215], v[112:115], v[12:15], v[200:215]
    ds_read_b128 v[12:15], v173 offset:10400
    ds_read_b32 v96, v177 offset:256
    s_waitcnt lgkmcnt(6)
    v_mfma_f32_32x32x16_bf16 v[200:215], v[116:119], v[16:19], v[200:215]
    ds_read_b128 v[16:19], v173 offset:12480
    ds_read_b32 v98, v177 offset:384
    s_waitcnt lgkmcnt(7)
    v_mfma_f32_32x32x16_bf16 v[200:215], v[120:123], v[20:23], v[200:215]
    ds_read_b128 v[20:23], v173 offset:14560
    ds_read_b32 v44, v174
    s_waitcnt lgkmcnt(7)
    v_mfma_f32_32x32x16_bf16 v[200:215], v[124:127], v[8:11], v[200:215]
    ds_read_b128 v[8:11], v173 offset:16640
    s_waitcnt lgkmcnt(6)
    v_mfma_f32_32x32x16_bf16 v[200:215], v[128:131], v[12:15], v[200:215]
    ds_read_b128 v[12:15], v173 offset:18720
    s_waitcnt lgkmcnt(5)
    v_mfma_f32_32x32x16_bf16 v[200:215], v[132:135], v[16:19], v[200:215]
    ds_read_b128 v[16:19], v173 offset:20800
    s_waitcnt lgkmcnt(4)
    v_mfma_f32_32x32x16_bf16 v[200:215], v[136:139], v[20:23], v[200:215]
    ds_read_b128 v[20:23], v173 offset:22880
    s_waitcnt lgkmcnt(3)
    v_mfma_f32_32x32x16_bf16 v[200:215], v[140:143], v[8:11], v[200:215]
    v_mul_f32 v92, 0xbfb8aa3b, v92
    v_mul_f32 v94, 0xbfb8aa3b, v94
    ds_read_b128 v[8:11], v173 offset:24960
    s_waitcnt lgkmcnt(3)
    v_mfma_f32_32x32x16_bf16 v[200:215], v[144:147], v[12:15], v[200:215]
    v_mul_f32 v44, 0x3eb8aa3b, v44
    v_mov_b32 v45, v44
    ds_read_b128 v[12:15], v173 offset:27040
    s_waitcnt lgkmcnt(3)
    v_mfma_f32_32x32x16_bf16 v[200:215], v[148:151], v[16:19], v[200:215]
    v_mov_b32 v93, v92
    v_mov_b32 v95, v94
    ds_read_b128 v[16:19], v173 offset:29120
    s_waitcnt lgkmcnt(3)
    v_mfma_f32_32x32x16_bf16 v[200:215], v[152:155], v[20:23], v[200:215]
    v_mov_b32 v97, v96
    v_mov_b32 v99, v98
    ds_read_b128 v[20:23], v173 offset:31200
    s_waitcnt lgkmcnt(3)
    v_mfma_f32_32x32x16_bf16 v[200:215], v[156:159], v[8:11], v[200:215]
    v_min_u32 v176, 161308, v176
    ds_read_b64_tr_b16 v[24:25], v172 offset:16384
    ds_read_b64_tr_b16 v[26:27], v172 offset:16640
    ds_read_b128 v[8:11], v173 offset:33280
    s_waitcnt lgkmcnt(5)
    v_mfma_f32_32x32x16_bf16 v[200:215], v[160:163], v[12:15], v[200:215]
    ds_read_b64_tr_b16 v[28:29], v172 offset:17408
    ds_read_b64_tr_b16 v[30:31], v172 offset:17664
    ds_read_b128 v[12:15], v173 offset:35360
    s_waitcnt lgkmcnt(7)
    v_mfma_f32_32x32x16_bf16 v[200:215], v[164:167], v[16:19], v[200:215]
    ds_read_b64_tr_b16 v[32:33], v172 offset:18432
    ds_read_b64_tr_b16 v[34:35], v172 offset:18688
    ds_read_b128 v[16:19], v173 offset:37440
    s_waitcnt lgkmcnt(9)
    v_mfma_f32_32x32x16_bf16 v[200:215], v[168:171], v[20:23], v[200:215]
    ds_read_b64_tr_b16 v[36:37], v172 offset:19456
    ds_read_b64_tr_b16 v[38:39], v172 offset:19712
    ds_read_b128 v[20:23], v173 offset:39520
    s_waitcnt lgkmcnt(9)
    v_mfma_f32_32x32x16_bf16 v[200:215], v[24:27], v[8:11], v[200:215]
    ds_read_b64_tr_b16 v[24:25], v172 offset:20480
    ds_read_b64_tr_b16 v[26:27], v172 offset:20736
    ds_read_b128 v[8:11], v173 offset:41600
    s_waitcnt lgkmcnt(9)
    v_mfma_f32_32x32x16_bf16 v[200:215], v[28:31], v[12:15], v[200:215]
    ds_read_b64_tr_b16 v[28:29], v172 offset:21504
    ds_read_b64_tr_b16 v[30:31], v172 offset:21760
    ds_read_b128 v[12:15], v173 offset:43680
    s_waitcnt lgkmcnt(9)
    v_mfma_f32_32x32x16_bf16 v[200:215], v[32:35], v[16:19], v[200:215]
    ds_read_b64_tr_b16 v[32:33], v172 offset:22528
    ds_read_b64_tr_b16 v[34:35], v172 offset:22784
    ds_read_b128 v[16:19], v173 offset:45760
    s_waitcnt lgkmcnt(9)
    v_mfma_f32_32x32x16_bf16 v[200:215], v[36:39], v[20:23], v[200:215]
    ds_read_b64_tr_b16 v[36:37], v172 offset:23552
    ds_read_b64_tr_b16 v[38:39], v172 offset:23808
    ds_read_b128 v[20:23], v173 offset:47840
    s_waitcnt lgkmcnt(9)
    v_mfma_f32_32x32x16_bf16 v[200:215], v[24:27], v[8:11], v[200:215]
    ds_read_b64_tr_b16 v[24:25], v172 offset:24576
    ds_read_b64_tr_b16 v[26:27], v172 offset:24832
    ds_read_b128 v[8:11], v173 offset:49920
    s_waitcnt lgkmcnt(9)
    v_mfma_f32_32x32x16_bf16 v[200:215], v[28:31], v[12:15], v[200:215]
    ds_read_b64_tr_b16 v[28:29], v172 offset:25600
    ds_read_b64_tr_b16 v[30:31], v172 offset:25856
    ds_read_b128 v[12:15], v173 offset:52000
    s_waitcnt lgkmcnt(9)
    v_mfma_f32_32x32x16_bf16 v[200:215], v[32:35], v[16:19], v[200:215]
    ds_read_b64_tr_b16 v[32:33], v172 offset:26624
    ds_read_b64_tr_b16 v[34:35], v172 offset:26880
    ds_read_b128 v[16:19], v173 offset:54080
    s_waitcnt lgkmcnt(9)
    v_mfma_f32_32x32x16_bf16 v[200:215], v[36:39], v[20:23], v[200:215]
    ds_read_b64_tr_b16 v[36:37], v172 offset:27648
    ds_read_b64_tr_b16 v[38:39], v172 offset:27904
    ds_read_b128 v[20:23], v173 offset:56160
    s_waitcnt lgkmcnt(9)
    v_mfma_f32_32x32x16_bf16 v[200:215], v[24:27], v[8:11], v[200:215]
    ds_read_b64_tr_b16 v[24:25], v172 offset:28672
    ds_read_b64_tr_b16 v[26:27], v172 offset:28928
    ds_read_b128 v[8:11], v173 offset:58240
    s_waitcnt lgkmcnt(9)
    v_mfma_f32_32x32x16_bf16 v[200:215], v[28:31], v[12:15], v[200:215]
    ds_read_b64_tr_b16 v[28:29], v172 offset:29696
    ds_read_b64_tr_b16 v[30:31], v172 offset:29952
    ds_read_b128 v[12:15], v173 offset:60320
    s_waitcnt lgkmcnt(9)
    v_mfma_f32_32x32x16_bf16 v[200:215], v[32:35], v[16:19], v[200:215]
    ds_read_b64_tr_b16 v[32:33], v172 offset:30720
    ds_read_b64_tr_b16 v[34:35], v172 offset:30976
    ds_read_b128 v[16:19], v173 offset:62400
    s_waitcnt lgkmcnt(9)
    v_mfma_f32_32x32x16_bf16 v[200:215], v[36:39], v[20:23], v[200:215]
    ds_read_b64_tr_b16 v[36:37], v172 offset:31744
    ds_read_b64_tr_b16 v[38:39], v172 offset:32000
    ds_read_b128 v[20:23], v173 offset:64480
    s_waitcnt lgkmcnt(9)
    v_mfma_f32_32x32x16_bf16 v[200:215], v[24:27], v[8:11], v[200:215]
    s_waitcnt lgkmcnt(6)
    v_mfma_f32_32x32x16_bf16 v[200:215], v[28:31], v[12:15], v[200:215]
    s_waitcnt lgkmcnt(3)
    v_mfma_f32_32x32x16_bf16 v[200:215], v[32:35], v[16:19], v[200:215]
    s_waitcnt lgkmcnt(0)
    v_mfma_f32_32x32x16_bf16 v[200:215], v[36:39], v[20:23], v[200:215]
    s_mov_b32 s40, s28
    s_mov_b32 s41, s29
    s_mov_b32 s42, 0x158000
    s_mov_b32 s43, 0x20000
    s_mov_b32 s52, s30
    s_mov_b32 s53, s31
    s_mov_b32 s54, 0x158000
    s_mov_b32 s55, 0x20000
    s_mov_b32 s56, s24
    s_mov_b32 s57, s25
    s_mov_b32 s58, 0x80000
    s_mov_b32 s59, 0x20000
    v_pk_mul_f32 v[200:201], v[200:201], v[44:45]
    v_pk_mul_f32 v[202:203], v[202:203], v[44:45]
    v_pk_mul_f32 v[204:205], v[204:205], v[44:45]
    v_pk_mul_f32 v[206:207], v[206:207], v[44:45]
    v_cvt_pk_bf16_f32 v8, v200, v201
    v_cvt_pk_bf16_f32 v9, v202, v203
    v_cvt_pk_bf16_f32 v10, v204, v205
    v_cvt_pk_bf16_f32 v11, v206, v207
    ds_write_b128 v175, v[8:11]
    v_pk_mul_f32 v[208:209], v[208:209], v[44:45]
    v_pk_mul_f32 v[210:211], v[210:211], v[44:45]
    v_pk_mul_f32 v[212:213], v[212:213], v[44:45]
    v_pk_mul_f32 v[214:215], v[214:215], v[44:45]
    v_cvt_pk_bf16_f32 v12, v208, v209
    v_cvt_pk_bf16_f32 v13, v210, v211
    v_cvt_pk_bf16_f32 v14, v212, v213
    v_cvt_pk_bf16_f32 v15, v214, v215
    ds_write_b128 v175, v[12:15] offset:1024
    ds_write_b32 v253, v255 offset:48
    s_setprio 0
    s_mov_b32 s60, s32
    s_mov_b32 s61, s33
    s_mov_b32 s62, 0x200000
    s_mov_b32 s63, 0x20000
    s_lshl_b32 s71, s6, 7
    s_lshl_b32 s72, s75, 6
    s_lshl2_add_u32 s73, s5, s76
    s_lshl_b32 s73, s73, 14
    s_add_u32 s73, s73, s71
    s_add_u32 s22, s73, s72
    s_add_u32 s23, s22, 32768
    s_lshl_b32 s73, s5, 16
    s_add_u32 s16, s73, 0x40000
    s_add_u32 s17, s16, 8192
    s_add_u32 s18, s16, 16384
    s_add_u32 s19, s16, 24576
    s_lshl2_add_u32 s73, s6, s86
    s_lshl_b32 s74, s73, 10
    s_add_u32 s20, s16, s74
    s_add_u32 s21, s20, 32768
    s_add_u32 s67, s67, 512
    s_lshl_b32 s73, s38, 5
    s_add_u32 s87, s73, s67
    s_mul_i32 s73, s5, 176128
    s_add_u32 s73, s73, 0x300000
    s_add_u32 s48, s36, s73
    s_addc_u32 s49, s37, 0
    s_mov_b32 s50, 176128
    s_mov_b32 s51, 0x20000
    s_lshl_b32 s84, s38, 12
    s_add_u32 s85, s84, 4096
    s_movk_i32 s24, 0x207
    s_mov_b32 s89, 0
    s_mul_i32 s65, s7, 176128
    s_lshl1_add_u32 s74, s6, s7
    s_and_b32 s74, s74, 7
    s_mul_i32 s74, s74, 11
    s_lshr_b32 s74, s74, 3
    s_mul_i32 s73, s88, 11
    s_add_u32 s73, s73, 44
    s_add_u32 s74, s74, s73
    s_lshl_b32 s64, s74, 11
    s_lshl_b32 s80, s73, 14
    s_add_u32 s81, s80, 180224
    s_lshl_b32 s82, s73, 11
    s_add_u32 s83, s82, 22528
    s_mov_b32 s25, 0
    s_lshl2_add_u32 s72, s7, s88
    s_mul_i32 s73, s72, 44032
    s_add_u32 s73, s73, s71
    s_add_u32 s74, s73, 11264
    s_lshl_b32 s72, s72, 14
    s_add_u32 s72, s72, s71
L_spin_5:
    ds_read_b32 v250, v176 offset:48
    s_waitcnt lgkmcnt(0)
    s_setprio 2
    v_cmp_ne_u32 vcc, 1, v250
    s_setprio 0
    s_cbranch_vccnz L_retry_6
    ds_read_b64 v[64:65], v67
    s_cmp_eq_u32 s39, 2
    s_cbranch_scc0 L_f1one
    s_add_u32 m0, s66, 0
    s_add_u32 s75, s65, 44032
    buffer_load_dwordx4 v72, s[40:43], s65 offen lds
    s_add_u32 m0, s66, 960
    s_cmp_ge_u32 s75, s42
    buffer_load_dwordx4 v72, s[40:43], s65 offen offset:64 lds
    s_cselect_b32 s65, 0, s75
    s_add_u32 m0, s66, 2048
    s_add_u32 s75, s65, 44032
    buffer_load_dwordx4 v72, s[40:43], s65 offen lds
    s_add_u32 m0, s66, 3008
    s_cmp_ge_u32 s75, s42
    buffer_load_dwordx4 v72, s[40:43], s65 offen offset:64 lds
    s_cselect_b32 s65, 0, s75
    s_add_u32 m0, s66, 4096
    s_add_u32 s75, s65, 44032
    buffer_load_dwordx4 v72, s[40:43], s65 offen lds
    s_add_u32 m0, s66, 5056
    s_cmp_ge_u32 s75, s42
    buffer_load_dwordx4 v72, s[40:43], s65 offen offset:64 lds
    s_cselect_b32 s65, 0, s75
    s_add_u32 m0, s66, 6144
    s_add_u32 s75, s65, 44032
    buffer_load_dwordx4 v72, s[40:43], s65 offen lds
    s_add_u32 m0, s66, 7104
    s_cmp_ge_u32 s75, s42
    buffer_load_dwordx4 v72, s[40:43], s65 offen offset:64 lds
    s_cselect_b32 s65, 0, s75
    s_add_u32 m0, s66, 8192
    s_add_u32 s75, s65, 44032
    buffer_load_dwordx4 v72, s[40:43], s65 offen lds
    s_add_u32 m0, s66, 9152
    s_cmp_ge_u32 s75, s42
    buffer_load_dwordx4 v72, s[40:43], s65 offen offset:64 lds
    s_cselect_b32 s65, 0, s75
    s_add_u32 m0, s66, 10240
    s_add_u32 s75, s65, 44032
    buffer_load_dwordx4 v72, s[40:43], s65 offen lds
    s_add_u32 m0, s66, 11200
    s_cmp_ge_u32 s75, s42
    buffer_load_dwordx4 v72, s[40:43], s65 offen offset:64 lds
    s_cselect_b32 s65, 0, s75
    ds_read_b128 v[116:119], v76
    ds_read_b128 v[120:123], v76 offset:512
    s_waitcnt vmcnt(10)
    ds_read_b64_tr_b16 v[108:109], v74
    ds_read_b64_tr_b16 v[110:111], v74 offset:256
    ds_read_b64_tr_b16 v[112:113], v74 offset:1024
    ds_read_b64_tr_b16 v[114:115], v74 offset:1280
    ds_read_b128 v[132:135], v76 offset:2080
    ds_read_b128 v[136:139], v76 offset:2592
    s_waitcnt vmcnt(8)
    ds_read_b64_tr_b16 v[124:125], v74 offset:2048
    ds_read_b64_tr_b16 v[126:127], v74 offset:2304
    ds_read_b64_tr_b16 v[128:129], v74 offset:3072
    ds_read_b64_tr_b16 v[130:131], v74 offset:3328
    s_waitcnt lgkmcnt(6)
    v_mfma_f32_32x32x16_bf16 v[184:199], v[108:111], v[116:119], 0
    ds_read_b128 v[148:151], v76 offset:4160
    ds_read_b128 v[152:155], v76 offset:4672
    v_mfma_f32_32x32x16_bf16 v[200:215], v[108:111], v[120:123], 0
    s_waitcnt vmcnt(6)
    ds_read_b64_tr_b16 v[140:141], v74 offset:4096
    ds_read_b64_tr_b16 v[142:143], v74 offset:4352
    v_mfma_f32_32x32x16_bf16 v[216:231], v[112:115], v[116:119], 0
    ds_read_b64_tr_b16 v[144:145], v74 offset:5120
    ds_read_b64_tr_b16 v[146:147], v74 offset:5376
    s_add_u32 m0, s66, 0
    s_add_u32 s75, s65, 44032
    buffer_load_dwordx4 v72, s[40:43], s65 offen lds
    s_add_u32 m0, s66, 960
    s_cmp_ge_u32 s75, s42
    buffer_load_dwordx4 v72, s[40:43], s65 offen offset:64 lds
    s_cselect_b32 s65, 0, s75
    s_waitcnt lgkmcnt(6)
    v_mfma_f32_32x32x16_bf16 v[232:247], v[112:115], v[120:123], 0
    ds_read_b128 v[164:167], v76 offset:6240
    ds_read_b128 v[168:171], v76 offset:6752
    v_mfma_f32_32x32x16_bf16 v[184:199], v[124:127], v[132:135], v[184:199]
    s_waitcnt vmcnt(6)
    ds_read_b64_tr_b16 v[156:157], v74 offset:6144
    ds_read_b64_tr_b16 v[158:159], v74 offset:6400
    v_mfma_f32_32x32x16_bf16 v[200:215], v[124:127], v[136:139], v[200:215]
    ds_read_b64_tr_b16 v[160:161], v74 offset:7168
    ds_read_b64_tr_b16 v[162:163], v74 offset:7424
    s_add_u32 m0, s66, 2048
    s_add_u32 s75, s65, 44032
    buffer_load_dwordx4 v72, s[40:43], s65 offen lds
    s_add_u32 m0, s66, 3008
    s_cmp_ge_u32 s75, s42
    buffer_load_dwordx4 v72, s[40:43], s65 offen offset:64 lds
    s_cselect_b32 s65, 0, s75
    s_waitcnt lgkmcnt(6)
    v_mfma_f32_32x32x16_bf16 v[216:231], v[128:131], v[132:135], v[216:231]
    ds_read_b128 v[116:119], v77
    ds_read_b128 v[120:123], v77 offset:512
    v_mfma_f32_32x32x16_bf16 v[232:247], v[128:131], v[136:139], v[232:247]
    s_waitcnt vmcnt(6)
    ds_read_b64_tr_b16 v[108:109], v74 offset:8192
    ds_read_b64_tr_b16 v[110:111], v74 offset:8448
    v_mfma_f32_32x32x16_bf16 v[184:199], v[140:143], v[148:151], v[184:199]
    ds_read_b64_tr_b16 v[112:113], v74 offset:9216
    ds_read_b64_tr_b16 v[114:115], v74 offset:9472
    s_add_u32 m0, s66, 4096
    s_add_u32 s75, s65, 44032
    buffer_load_dwordx4 v72, s[40:43], s65 offen lds
    s_add_u32 m0, s66, 5056
    s_cmp_ge_u32 s75, s42
    buffer_load_dwordx4 v72, s[40:43], s65 offen offset:64 lds
    s_cselect_b32 s65, 0, s75
    s_waitcnt lgkmcnt(12)
    v_mfma_f32_32x32x16_bf16 v[200:215], v[140:143], v[152:155], v[200:215]
    v_mfma_f32_32x32x16_bf16 v[216:231], v[144:147], v[148:151], v[216:231]
    v_mfma_f32_32x32x16_bf16 v[232:247], v[144:147], v[152:155], v[232:247]
    s_waitcnt lgkmcnt(6)
    v_mfma_f32_32x32x16_bf16 v[184:199], v[156:159], v[164:167], v[184:199]
    ds_read_b128 v[132:135], v77 offset:2080
    ds_read_b128 v[136:139], v77 offset:2592
    v_mfma_f32_32x32x16_bf16 v[200:215], v[156:159], v[168:171], v[200:215]
    s_waitcnt vmcnt(6)
    ds_read_b64_tr_b16 v[124:125], v74 offset:10240
    ds_read_b64_tr_b16 v[126:127], v74 offset:10496
    v_mfma_f32_32x32x16_bf16 v[216:231], v[160:163], v[164:167], v[216:231]
    ds_read_b64_tr_b16 v[128:129], v74 offset:11264
    ds_read_b64_tr_b16 v[130:131], v74 offset:11520
    s_add_u32 m0, s66, 6144
    s_add_u32 s75, s65, 44032
    buffer_load_dwordx4 v72, s[40:43], s65 offen lds
    s_add_u32 m0, s66, 7104
    s_cmp_ge_u32 s75, s42
    buffer_load_dwordx4 v72, s[40:43], s65 offen offset:64 lds
    s_cselect_b32 s65, 0, s75
    s_waitcnt lgkmcnt(6)
    v_mfma_f32_32x32x16_bf16 v[232:247], v[160:163], v[168:171], v[232:247]
    ds_read_b128 v[148:151], v77 offset:4160
    ds_read_b128 v[152:155], v77 offset:4672
    v_mfma_f32_32x32x16_bf16 v[184:199], v[108:111], v[116:119], v[184:199]
    s_waitcnt vmcnt(6)
    ds_read_b64_tr_b16 v[140:141], v74
    ds_read_b64_tr_b16 v[142:143], v74 offset:256
    v_mfma_f32_32x32x16_bf16 v[200:215], v[108:111], v[120:123], v[200:215]
    ds_read_b64_tr_b16 v[144:145], v74 offset:1024
    ds_read_b64_tr_b16 v[146:147], v74 offset:1280
    s_add_u32 m0, s66, 8192
    s_add_u32 s75, s65, 44032
    buffer_load_dwordx4 v72, s[40:43], s65 offen lds
    s_add_u32 m0, s66, 9152
    s_cmp_ge_u32 s75, s42
    buffer_load_dwordx4 v72, s[40:43], s65 offen offset:64 lds
    s_cselect_b32 s65, 0, s75
    s_waitcnt lgkmcnt(6)
    v_mfma_f32_32x32x16_bf16 v[216:231], v[112:115], v[116:119], v[216:231]
    ds_read_b128 v[164:167], v77 offset:6240
    ds_read_b128 v[168:171], v77 offset:6752
    v_mfma_f32_32x32x16_bf16 v[232:247], v[112:115], v[120:123], v[232:247]
    s_waitcnt vmcnt(6)
    ds_read_b64_tr_b16 v[156:157], v74 offset:2048
    ds_read_b64_tr_b16 v[158:159], v74 offset:2304
    v_mfma_f32_32x32x16_bf16 v[184:199], v[124:127], v[132:135], v[184:199]
    ds_read_b64_tr_b16 v[160:161], v74 offset:3072
    ds_read_b64_tr_b16 v[162:163], v74 offset:3328
    s_add_u32 m0, s66, 10240
    s_add_u32 s75, s65, 44032
    buffer_load_dwordx4 v72, s[40:43], s65 offen lds
    s_add_u32 m0, s66, 11200
    s_cmp_ge_u32 s75, s42
    buffer_load_dwordx4 v72, s[40:43], s65 offen offset:64 lds
    s_cselect_b32 s65, 0, s75
    s_waitcnt lgkmcnt(12)
    v_mfma_f32_32x32x16_bf16 v[200:215], v[124:127], v[136:139], v[200:215]
    v_mfma_f32_32x32x16_bf16 v[216:231], v[128:131], v[132:135], v[216:231]
    v_mfma_f32_32x32x16_bf16 v[232:247], v[128:131], v[136:139], v[232:247]
    s_waitcnt lgkmcnt(6)
    v_mfma_f32_32x32x16_bf16 v[184:199], v[140:143], v[148:151], v[184:199]
    ds_read_b128 v[116:119], v78
    ds_read_b128 v[120:123], v78 offset:512
    v_mfma_f32_32x32x16_bf16 v[200:215], v[140:143], v[152:155], v[200:215]
    s_waitcnt vmcnt(6)
    ds_read_b64_tr_b16 v[108:109], v74 offset:4096
    ds_read_b64_tr_b16 v[110:111], v74 offset:4352
    v_mfma_f32_32x32x16_bf16 v[216:231], v[144:147], v[148:151], v[216:231]
    ds_read_b64_tr_b16 v[112:113], v74 offset:5120
    ds_read_b64_tr_b16 v[114:115], v74 offset:5376
    s_add_u32 m0, s66, 0
    s_add_u32 s75, s65, 44032
    buffer_load_dwordx4 v72, s[40:43], s65 offen lds
    s_add_u32 m0, s66, 960
    s_cmp_ge_u32 s75, s42
    buffer_load_dwordx4 v72, s[40:43], s65 offen offset:64 lds
    s_cselect_b32 s65, 0, s75
    s_waitcnt lgkmcnt(6)
    v_mfma_f32_32x32x16_bf16 v[232:247], v[144:147], v[152:155], v[232:247]
    ds_read_b128 v[132:135], v78 offset:2080
    ds_read_b128 v[136:139], v78 offset:2592
    v_mfma_f32_32x32x16_bf16 v[184:199], v[156:159], v[164:167], v[184:199]
    s_waitcnt vmcnt(6)
    ds_read_b64_tr_b16 v[124:125], v74 offset:6144
    ds_read_b64_tr_b16 v[126:127], v74 offset:6400
    v_mfma_f32_32x32x16_bf16 v[200:215], v[156:159], v[168:171], v[200:215]
    ds_read_b64_tr_b16 v[128:129], v74 offset:7168
    ds_read_b64_tr_b16 v[130:131], v74 offset:7424
    s_add_u32 m0, s66, 2048
    s_add_u32 s75, s65, 44032
    buffer_load_dwordx4 v72, s[40:43], s65 offen lds
    s_add_u32 m0, s66, 3008
    s_cmp_ge_u32 s75, s42
    buffer_load_dwordx4 v72, s[40:43], s65 offen offset:64 lds
    s_cselect_b32 s65, 0, s75
    s_waitcnt lgkmcnt(6)
    v_mfma_f32_32x32x16_bf16 v[216:231], v[160:163], v[164:167], v[216:231]
    ds_read_b128 v[148:151], v78 offset:4160
    ds_read_b128 v[152:155], v78 offset:4672
    v_mfma_f32_32x32x16_bf16 v[232:247], v[160:163], v[168:171], v[232:247]
    s_waitcnt vmcnt(6)
    ds_read_b64_tr_b16 v[140:141], v74 offset:8192
    ds_read_b64_tr_b16 v[142:143], v74 offset:8448
    v_mfma_f32_32x32x16_bf16 v[184:199], v[108:111], v[116:119], v[184:199]
    ds_read_b64_tr_b16 v[144:145], v74 offset:9216
    ds_read_b64_tr_b16 v[146:147], v74 offset:9472
    s_add_u32 m0, s66, 4096
    s_add_u32 s75, s65, 44032
    buffer_load_dwordx4 v72, s[40:43], s65 offen lds
    s_add_u32 m0, s66, 5056
    s_cmp_ge_u32 s75, s42
    buffer_load_dwordx4 v72, s[40:43], s65 offen offset:64 lds
    s_cselect_b32 s65, 0, s75
    s_waitcnt lgkmcnt(12)
    v_mfma_f32_32x32x16_bf16 v[200:215], v[108:111], v[120:123], v[200:215]
    v_mfma_f32_32x32x16_bf16 v[216:231], v[112:115], v[116:119], v[216:231]
    v_mfma_f32_32x32x16_bf16 v[232:247], v[112:115], v[120:123], v[232:247]
    s_waitcnt lgkmcnt(6)
    v_mfma_f32_32x32x16_bf16 v[184:199], v[124:127], v[132:135], v[184:199]
    ds_read_b128 v[164:167], v78 offset:6240
    ds_read_b128 v[168:171], v78 offset:6752
    v_mfma_f32_32x32x16_bf16 v[200:215], v[124:127], v[136:139], v[200:215]
    s_waitcnt vmcnt(6)
    ds_read_b64_tr_b16 v[156:157], v74 offset:10240
    ds_read_b64_tr_b16 v[158:159], v74 offset:10496
    v_mfma_f32_32x32x16_bf16 v[216:231], v[128:131], v[132:135], v[216:231]
    ds_read_b64_tr_b16 v[160:161], v74 offset:11264
    ds_read_b64_tr_b16 v[162:163], v74 offset:11520
    s_add_u32 m0, s66, 6144
    s_add_u32 s75, s65, 44032
    buffer_load_dwordx4 v72, s[40:43], s65 offen lds
    s_add_u32 m0, s66, 7104
    s_cmp_ge_u32 s75, s42
    buffer_load_dwordx4 v72, s[40:43], s65 offen offset:64 lds
    s_cselect_b32 s65, 0, s75
    s_waitcnt lgkmcnt(6)
    v_mfma_f32_32x32x16_bf16 v[232:247], v[128:131], v[136:139], v[232:247]
    ds_read_b128 v[116:119], v79
    ds_read_b128 v[120:123], v79 offset:512
    v_mfma_f32_32x32x16_bf16 v[184:199], v[140:143], v[148:151], v[184:199]
    s_waitcnt vmcnt(6)
    ds_read_b64_tr_b16 v[108:109], v74
    ds_read_b64_tr_b16 v[110:111], v74 offset:256
    v_mfma_f32_32x32x16_bf16 v[200:215], v[140:143], v[152:155], v[200:215]
    ds_read_b64_tr_b16 v[112:113], v74 offset:1024
    ds_read_b64_tr_b16 v[114:115], v74 offset:1280
    s_add_u32 m0, s66, 8192
    s_add_u32 s75, s65, 44032
    buffer_load_dwordx4 v72, s[40:43], s65 offen lds
    s_add_u32 m0, s66, 9152
    s_cmp_ge_u32 s75, s42
    buffer_load_dwordx4 v72, s[40:43], s65 offen offset:64 lds
    s_cselect_b32 s65, 0, s75
    s_waitcnt lgkmcnt(6)
    v_mfma_f32_32x32x16_bf16 v[216:231], v[144:147], v[148:151], v[216:231]
    ds_read_b128 v[132:135], v79 offset:2080
    ds_read_b128 v[136:139], v79 offset:2592
    v_mfma_f32_32x32x16_bf16 v[232:247], v[144:147], v[152:155], v[232:247]
    s_waitcnt vmcnt(6)
    ds_read_b64_tr_b16 v[124:125], v74 offset:2048
    ds_read_b64_tr_b16 v[126:127], v74 offset:2304
    v_mfma_f32_32x32x16_bf16 v[184:199], v[156:159], v[164:167], v[184:199]
    ds_read_b64_tr_b16 v[128:129], v74 offset:3072
    ds_read_b64_tr_b16 v[130:131], v74 offset:3328
    s_add_u32 m0, s66, 10240
    s_add_u32 s75, s65, 44032
    buffer_load_dwordx4 v72, s[40:43], s65 offen lds
    s_add_u32 m0, s66, 11200
    s_cmp_ge_u32 s75, s42
    buffer_load_dwordx4 v72, s[40:43], s65 offen offset:64 lds
    s_cselect_b32 s65, 0, s75
    s_waitcnt lgkmcnt(12)
    v_mfma_f32_32x32x16_bf16 v[200:215], v[156:159], v[168:171], v[200:215]
    v_mfma_f32_32x32x16_bf16 v[216:231], v[160:163], v[164:167], v[216:231]
    v_mfma_f32_32x32x16_bf16 v[232:247], v[160:163], v[168:171], v[232:247]
    s_waitcnt lgkmcnt(6)
    v_mfma_f32_32x32x16_bf16 v[184:199], v[108:111], v[116:119], v[184:199]
    ds_read_b128 v[148:151], v79 offset:4160
    ds_read_b128 v[152:155], v79 offset:4672
    v_mfma_f32_32x32x16_bf16 v[200:215], v[108:111], v[120:123], v[200:215]
    s_waitcnt vmcnt(6)
    ds_read_b64_tr_b16 v[140:141], v74 offset:4096
    ds_read_b64_tr_b16 v[142:143], v74 offset:4352
    v_mfma_f32_32x32x16_bf16 v[216:231], v[112:115], v[116:119], v[216:231]
    ds_read_b64_tr_b16 v[144:145], v74 offset:5120
    ds_read_b64_tr_b16 v[146:147], v74 offset:5376
    s_add_u32 m0, s66, 0
    s_add_u32 s75, s65, 44032
    buffer_load_dwordx4 v72, s[40:43], s65 offen lds
    s_add_u32 m0, s66, 960
    s_cmp_ge_u32 s75, s42
    buffer_load_dwordx4 v72, s[40:43], s65 offen offset:64 lds
    s_cselect_b32 s65, 0, s75
    s_waitcnt lgkmcnt(6)
    v_mfma_f32_32x32x16_bf16 v[232:247], v[112:115], v[120:123], v[232:247]
    ds_read_b128 v[164:167], v79 offset:6240
    ds_read_b128 v[168:171], v79 offset:6752
    v_mfma_f32_32x32x16_bf16 v[184:199], v[124:127], v[132:135], v[184:199]
    s_waitcnt vmcnt(6)
    ds_read_b64_tr_b16 v[156:157], v74 offset:6144
    ds_read_b64_tr_b16 v[158:159], v74 offset:6400
    v_mfma_f32_32x32x16_bf16 v[200:215], v[124:127], v[136:139], v[200:215]
    ds_read_b64_tr_b16 v[160:161], v74 offset:7168
    ds_read_b64_tr_b16 v[162:163], v74 offset:7424
    s_add_u32 m0, s66, 2048
    s_add_u32 s75, s65, 44032
    buffer_load_dwordx4 v72, s[40:43], s65 offen lds
    s_add_u32 m0, s66, 3008
    s_cmp_ge_u32 s75, s42
    buffer_load_dwordx4 v72, s[40:43], s65 offen offset:64 lds
    s_cselect_b32 s65, 0, s75
    s_waitcnt lgkmcnt(6)
    v_mfma_f32_32x32x16_bf16 v[216:231], v[128:131], v[132:135], v[216:231]
    ds_read_b128 v[116:119], v80
    ds_read_b128 v[120:123], v80 offset:512
    v_mfma_f32_32x32x16_bf16 v[232:247], v[128:131], v[136:139], v[232:247]
    s_waitcnt vmcnt(6)
    ds_read_b64_tr_b16 v[108:109], v74 offset:8192
    ds_read_b64_tr_b16 v[110:111], v74 offset:8448
    v_mfma_f32_32x32x16_bf16 v[184:199], v[140:143], v[148:151], v[184:199]
    ds_read_b64_tr_b16 v[112:113], v74 offset:9216
    ds_read_b64_tr_b16 v[114:115], v74 offset:9472
    s_add_u32 m0, s66, 4096
    s_add_u32 s75, s65, 44032
    buffer_load_dwordx4 v72, s[40:43], s65 offen lds
    s_add_u32 m0, s66, 5056
    s_cmp_ge_u32 s75, s42
    buffer_load_dwordx4 v72, s[40:43], s65 offen offset:64 lds
    s_cselect_b32 s65, 0, s75
    s_waitcnt lgkmcnt(12)
    v_mfma_f32_32x32x16_bf16 v[200:215], v[140:143], v[152:155], v[200:215]
    v_mfma_f32_32x32x16_bf16 v[216:231], v[144:147], v[148:151], v[216:231]
    v_mfma_f32_32x32x16_bf16 v[232:247], v[144:147], v[152:155], v[232:247]
    s_mov_b32 exec_hi, 0
    buffer_load_dword v63, v75, s[56:59], s72 offen
    s_mov_b32 exec_hi, -1
    buffer_load_dword v63, v75, s[52:55], s73 offen
    buffer_load_dword v63, v75, s[52:55], s74 offen
    s_waitcnt lgkmcnt(6)
    v_mfma_f32_32x32x16_bf16 v[184:199], v[156:159], v[164:167], v[184:199]
    ds_read_b128 v[132:135], v80 offset:2080
    ds_read_b128 v[136:139], v80 offset:2592
    v_mfma_f32_32x32x16_bf16 v[200:215], v[156:159], v[168:171], v[200:215]
    s_waitcnt vmcnt(9)
    ds_read_b64_tr_b16 v[124:125], v74 offset:10240
    ds_read_b64_tr_b16 v[126:127], v74 offset:10496
    v_mfma_f32_32x32x16_bf16 v[216:231], v[160:163], v[164:167], v[216:231]
    ds_read_b64_tr_b16 v[128:129], v74 offset:11264
    ds_read_b64_tr_b16 v[130:131], v74 offset:11520
    s_add_u32 m0, s66, 6144
    s_add_u32 s75, s65, 44032
    buffer_load_dwordx4 v72, s[40:43], s65 offen lds
    s_add_u32 m0, s66, 7104
    s_cmp_ge_u32 s75, s42
    buffer_load_dwordx4 v72, s[40:43], s65 offen offset:64 lds
    s_cselect_b32 s65, 0, s75
    s_waitcnt lgkmcnt(6)
    v_mfma_f32_32x32x16_bf16 v[232:247], v[160:163], v[168:171], v[232:247]
    ds_read_b128 v[148:151], v80 offset:4160
    ds_read_b128 v[152:155], v80 offset:4672
    v_mfma_f32_32x32x16_bf16 v[184:199], v[108:111], v[116:119], v[184:199]
    s_waitcnt vmcnt(9)
    ds_read_b64_tr_b16 v[140:141], v74
    ds_read_b64_tr_b16 v[142:143], v74 offset:256
    v_mfma_f32_32x32x16_bf16 v[200:215], v[108:111], v[120:123], v[200:215]
    ds_read_b64_tr_b16 v[144:145], v74 offset:1024
    ds_read_b64_tr_b16 v[146:147], v74 offset:1280
    s_add_u32 m0, s66, 8192
    s_add_u32 s75, s65, 44032
    buffer_load_dwordx4 v72, s[40:43], s65 offen lds
    s_add_u32 m0, s66, 9152
    s_cmp_ge_u32 s75, s42
    buffer_load_dwordx4 v72, s[40:43], s65 offen offset:64 lds
    s_cselect_b32 s65, 0, s75
    s_waitcnt lgkmcnt(6)
    v_mfma_f32_32x32x16_bf16 v[216:231], v[112:115], v[116:119], v[216:231]
    ds_read_b128 v[164:167], v80 offset:6240
    ds_read_b128 v[168:171], v80 offset:6752
    v_mfma_f32_32x32x16_bf16 v[232:247], v[112:115], v[120:123], v[232:247]
    s_waitcnt vmcnt(9)
    ds_read_b64_tr_b16 v[156:157], v74 offset:2048
    ds_read_b64_tr_b16 v[158:159], v74 offset:2304
    v_mfma_f32_32x32x16_bf16 v[184:199], v[124:127], v[132:135], v[184:199]
    ds_read_b64_tr_b16 v[160:161], v74 offset:3072
    ds_read_b64_tr_b16 v[162:163], v74 offset:3328
    s_add_u32 m0, s66, 10240
    s_add_u32 s75, s65, 44032
    buffer_load_dwordx4 v72, s[40:43], s65 offen lds
    s_add_u32 m0, s66, 11200
    s_cmp_ge_u32 s75, s42
    buffer_load_dwordx4 v72, s[40:43], s65 offen offset:64 lds
    s_cselect_b32 s65, 0, s75
    s_waitcnt lgkmcnt(12)
    v_mfma_f32_32x32x16_bf16 v[200:215], v[124:127], v[136:139], v[200:215]
    v_mfma_f32_32x32x16_bf16 v[216:231], v[128:131], v[132:135], v[216:231]
    v_mfma_f32_32x32x16_bf16 v[232:247], v[128:131], v[136:139], v[232:247]
    s_waitcnt lgkmcnt(6)
    v_mfma_f32_32x32x16_bf16 v[184:199], v[140:143], v[148:151], v[184:199]
    ds_read_b128 v[116:119], v81
    ds_read_b128 v[120:123], v81 offset:512
    v_mfma_f32_32x32x16_bf16 v[200:215], v[140:143], v[152:155], v[200:215]
    s_waitcnt vmcnt(9)
    ds_read_b64_tr_b16 v[108:109], v74 offset:4096
    ds_read_b64_tr_b16 v[110:111], v74 offset:4352
    v_mfma_f32_32x32x16_bf16 v[216:231], v[144:147], v[148:151], v[216:231]
    ds_read_b64_tr_b16 v[112:113], v74 offset:5120
    ds_read_b64_tr_b16 v[114:115], v74 offset:5376
    s_add_u32 m0, s66, 0
    s_add_u32 s75, s65, 44032
    buffer_load_dwordx4 v72, s[40:43], s65 offen lds
    s_add_u32 m0, s66, 960
    s_cmp_ge_u32 s75, s42
    buffer_load_dwordx4 v72, s[40:43], s65 offen offset:64 lds
    s_cselect_b32 s65, 0, s75
    s_waitcnt lgkmcnt(6)
    v_mfma_f32_32x32x16_bf16 v[232:247], v[144:147], v[152:155], v[232:247]
    ds_read_b128 v[132:135], v81 offset:2080
    ds_read_b128 v[136:139], v81 offset:2592
    v_mfma_f32_32x32x16_bf16 v[184:199], v[156:159], v[164:167], v[184:199]
    s_waitcnt vmcnt(6)
    ds_read_b64_tr_b16 v[124:125], v74 offset:6144
    ds_read_b64_tr_b16 v[126:127], v74 offset:6400
    v_mfma_f32_32x32x16_bf16 v[200:215], v[156:159], v[168:171], v[200:215]
    ds_read_b64_tr_b16 v[128:129], v74 offset:7168
    ds_read_b64_tr_b16 v[130:131], v74 offset:7424
    s_add_u32 m0, s66, 2048
    s_add_u32 s75, s65, 44032
    buffer_load_dwordx4 v72, s[40:43], s65 offen lds
    s_add_u32 m0, s66, 3008
    s_cmp_ge_u32 s75, s42
    buffer_load_dwordx4 v72, s[40:43], s65 offen offset:64 lds
    s_cselect_b32 s65, 0, s75
    s_waitcnt lgkmcnt(6)
    v_mfma_f32_32x32x16_bf16 v[216:231], v[160:163], v[164:167], v[216:231]
    ds_read_b128 v[148:151], v81 offset:4160
    ds_read_b128 v[152:155], v81 offset:4672
    v_mfma_f32_32x32x16_bf16 v[232:247], v[160:163], v[168:171], v[232:247]
    s_waitcnt vmcnt(6)
    ds_read_b64_tr_b16 v[140:141], v74 offset:8192
    ds_read_b64_tr_b16 v[142:143], v74 offset:8448
    v_mfma_f32_32x32x16_bf16 v[184:199], v[108:111], v[116:119], v[184:199]
    ds_read_b64_tr_b16 v[144:145], v74 offset:9216
    ds_read_b64_tr_b16 v[146:147], v74 offset:9472
    s_add_u32 m0, s66, 4096
    s_add_u32 s75, s65, 44032
    buffer_load_dwordx4 v72, s[40:43], s65 offen lds
    s_add_u32 m0, s66, 5056
    s_cmp_ge_u32 s75, s42
    buffer_load_dwordx4 v72, s[40:43], s65 offen offset:64 lds
    s_cselect_b32 s65, 0, s75
    s_waitcnt lgkmcnt(12)
    v_mfma_f32_32x32x16_bf16 v[200:215], v[108:111], v[120:123], v[200:215]
    v_mfma_f32_32x32x16_bf16 v[216:231], v[112:115], v[116:119], v[216:231]
    v_mfma_f32_32x32x16_bf16 v[232:247], v[112:115], v[120:123], v[232:247]
    s_waitcnt lgkmcnt(6)
    v_mfma_f32_32x32x16_bf16 v[184:199], v[124:127], v[132:135], v[184:199]
    ds_read_b128 v[164:167], v81 offset:6240
    ds_read_b128 v[168:171], v81 offset:6752
    v_mfma_f32_32x32x16_bf16 v[200:215], v[124:127], v[136:139], v[200:215]
    s_waitcnt vmcnt(6)
    ds_read_b64_tr_b16 v[156:157], v74 offset:10240
    ds_read_b64_tr_b16 v[158:159], v74 offset:10496
    v_mfma_f32_32x32x16_bf16 v[216:231], v[128:131], v[132:135], v[216:231]
    ds_read_b64_tr_b16 v[160:161], v74 offset:11264
    ds_read_b64_tr_b16 v[162:163], v74 offset:11520
    s_add_u32 m0, s66, 6144
    s_add_u32 s75, s65, 44032
    buffer_load_dwordx4 v72, s[40:43], s65 offen lds
    s_add_u32 m0, s66, 7104
    s_cmp_ge_u32 s75, s42
    buffer_load_dwordx4 v72, s[40:43], s65 offen offset:64 lds
    s_cselect_b32 s65, 0, s75
    s_waitcnt lgkmcnt(6)
    v_mfma_f32_32x32x16_bf16 v[232:247], v[128:131], v[136:139], v[232:247]
    ds_read_b128 v[116:119], v82
    ds_read_b128 v[120:123], v82 offset:512
    v_mfma_f32_32x32x16_bf16 v[184:199], v[140:143], v[148:151], v[184:199]
    s_waitcnt vmcnt(6)
    ds_read_b64_tr_b16 v[108:109], v74
    ds_read_b64_tr_b16 v[110:111], v74 offset:256
    v_mfma_f32_32x32x16_bf16 v[200:215], v[140:143], v[152:155], v[200:215]
    ds_read_b64_tr_b16 v[112:113], v74 offset:1024
    ds_read_b64_tr_b16 v[114:115], v74 offset:1280
    s_add_u32 m0, s66, 8192
    s_add_u32 s75, s65, 44032
    buffer_load_dwordx4 v72, s[40:43], s65 offen lds
    s_add_u32 m0, s66, 9152
    s_cmp_ge_u32 s75, s42
    buffer_load_dwordx4 v72, s[40:43], s65 offen offset:64 lds
    s_cselect_b32 s65, 0, s75
    s_waitcnt lgkmcnt(6)
    v_mfma_f32_32x32x16_bf16 v[216:231], v[144:147], v[148:151], v[216:231]
    ds_read_b128 v[132:135], v82 offset:2080
    ds_read_b128 v[136:139], v82 offset:2592
    v_mfma_f32_32x32x16_bf16 v[232:247], v[144:147], v[152:155], v[232:247]
    s_waitcnt vmcnt(6)
    ds_read_b64_tr_b16 v[124:125], v74 offset:2048
    ds_read_b64_tr_b16 v[126:127], v74 offset:2304
    v_mfma_f32_32x32x16_bf16 v[184:199], v[156:159], v[164:167], v[184:199]
    ds_read_b64_tr_b16 v[128:129], v74 offset:3072
    ds_read_b64_tr_b16 v[130:131], v74 offset:3328
    s_add_u32 m0, s66, 10240
    s_add_u32 s75, s65, 44032
    buffer_load_dwordx4 v72, s[40:43], s65 offen lds
    s_add_u32 m0, s66, 11200
    s_cmp_ge_u32 s75, s42
    buffer_load_dwordx4 v72, s[40:43], s65 offen offset:64 lds
    s_cselect_b32 s65, 0, s75
    s_waitcnt lgkmcnt(12)
    v_mfma_f32_32x32x16_bf16 v[200:215], v[156:159], v[168:171], v[200:215]
    v_mfma_f32_32x32x16_bf16 v[216:231], v[160:163], v[164:167], v[216:231]
    v_mfma_f32_32x32x16_bf16 v[232:247], v[160:163], v[168:171], v[232:247]
    s_waitcnt lgkmcnt(6)
    v_mfma_f32_32x32x16_bf16 v[184:199], v[108:111], v[116:119], v[184:199]
    ds_read_b128 v[148:151], v82 offset:4160
    ds_read_b128 v[152:155], v82 offset:4672
    v_mfma_f32_32x32x16_bf16 v[200:215], v[108:111], v[120:123], v[200:215]
    s_waitcnt vmcnt(6)
    ds_read_b64_tr_b16 v[140:141], v74 offset:4096
    ds_read_b64_tr_b16 v[142:143], v74 offset:4352
    v_mfma_f32_32x32x16_bf16 v[216:231], v[112:115], v[116:119], v[216:231]
    ds_read_b64_tr_b16 v[144:145], v74 offset:5120
    ds_read_b64_tr_b16 v[146:147], v74 offset:5376
    s_add_u32 m0, s66, 0
    s_add_u32 s75, s65, 44032
    buffer_load_dwordx4 v72, s[40:43], s65 offen lds
    s_add_u32 m0, s66, 960
    s_cmp_ge_u32 s75, s42
    buffer_load_dwordx4 v72, s[40:43], s65 offen offset:64 lds
    s_cselect_b32 s65, 0, s75
    s_waitcnt lgkmcnt(6)
    v_mfma_f32_32x32x16_bf16 v[232:247], v[112:115], v[120:123], v[232:247]
    ds_read_b128 v[164:167], v82 offset:6240
    ds_read_b128 v[168:171], v82 offset:6752
    v_mfma_f32_32x32x16_bf16 v[184:199], v[124:127], v[132:135], v[184:199]
    s_waitcnt vmcnt(6)
    ds_read_b64_tr_b16 v[156:157], v74 offset:6144
    ds_read_b64_tr_b16 v[158:159], v74 offset:6400
    v_mfma_f32_32x32x16_bf16 v[200:215], v[124:127], v[136:139], v[200:215]
    ds_read_b64_tr_b16 v[160:161], v74 offset:7168
    ds_read_b64_tr_b16 v[162:163], v74 offset:7424
    s_add_u32 m0, s66, 2048
    s_add_u32 s75, s65, 44032
    buffer_load_dwordx4 v72, s[40:43], s65 offen lds
    s_add_u32 m0, s66, 3008
    s_cmp_ge_u32 s75, s42
    buffer_load_dwordx4 v72, s[40:43], s65 offen offset:64 lds
    s_cselect_b32 s65, 0, s75
    s_waitcnt lgkmcnt(6)
    v_mfma_f32_32x32x16_bf16 v[216:231], v[128:131], v[132:135], v[216:231]
    ds_read_b128 v[116:119], v83
    ds_read_b128 v[120:123], v83 offset:512
    v_mfma_f32_32x32x16_bf16 v[232:247], v[128:131], v[136:139], v[232:247]
    s_waitcnt vmcnt(6)
    ds_read_b64_tr_b16 v[108:109], v74 offset:8192
    ds_read_b64_tr_b16 v[110:111], v74 offset:8448
    v_mfma_f32_32x32x16_bf16 v[184:199], v[140:143], v[148:151], v[184:199]
    ds_read_b64_tr_b16 v[112:113], v74 offset:9216
    ds_read_b64_tr_b16 v[114:115], v74 offset:9472
    s_lshl_b32 s65, s64, 3
    s_add_u32 m0, s66, 4096
    s_add_u32 s75, s65, 16384
    buffer_load_dwordx4 v1, s[52:55], s65 offen lds
    s_add_u32 m0, s66, 5056
    s_cmp_ge_u32 s75, s81
    buffer_load_dwordx4 v1, s[52:55], s65 offen offset:64 lds
    s_cselect_b32 s65, s80, s75
    s_waitcnt lgkmcnt(12)
    v_mfma_f32_32x32x16_bf16 v[200:215], v[140:143], v[152:155], v[200:215]
    v_mfma_f32_32x32x16_bf16 v[216:231], v[144:147], v[148:151], v[216:231]
    v_mfma_f32_32x32x16_bf16 v[232:247], v[144:147], v[152:155], v[232:247]
    s_waitcnt lgkmcnt(6)
    v_mfma_f32_32x32x16_bf16 v[184:199], v[156:159], v[164:167], v[184:199]
    ds_read_b128 v[132:135], v83 offset:2080
    ds_read_b128 v[136:139], v83 offset:2592
    v_mfma_f32_32x32x16_bf16 v[200:215], v[156:159], v[168:171], v[200:215]
    s_waitcnt vmcnt(6)
    ds_read_b64_tr_b16 v[124:125], v74 offset:10240
    ds_read_b64_tr_b16 v[126:127], v74 offset:10496
    v_mfma_f32_32x32x16_bf16 v[216:231], v[160:163], v[164:167], v[216:231]
    ds_read_b64_tr_b16 v[128:129], v74 offset:11264
    ds_read_b64_tr_b16 v[130:131], v74 offset:11520
    s_add_u32 m0, s66, 6144
    s_add_u32 s75, s65, 16384
    buffer_load_dwordx4 v1, s[52:55], s65 offen lds
    s_add_u32 m0, s66, 7104
    s_cmp_ge_u32 s75, s81
    buffer_load_dwordx4 v1, s[52:55], s65 offen offset:64 lds
    s_cselect_b32 s65, s80, s75
    s_waitcnt lgkmcnt(6)
    v_mfma_f32_32x32x16_bf16 v[232:247], v[160:163], v[168:171], v[232:247]
    ds_read_b128 v[148:151], v83 offset:4160
    ds_read_b128 v[152:155], v83 offset:4672
    v_mfma_f32_32x32x16_bf16 v[184:199], v[108:111], v[116:119], v[184:199]
    s_waitcnt vmcnt(6)
    ds_read_b64_tr_b16 v[140:141], v74
    ds_read_b64_tr_b16 v[142:143], v74 offset:256
    v_mfma_f32_32x32x16_bf16 v[200:215], v[108:111], v[120:123], v[200:215]
    ds_read_b64_tr_b16 v[144:145], v74 offset:1024
    ds_read_b64_tr_b16 v[146:147], v74 offset:1280
    s_add_u32 m0, s66, 8192
    s_add_u32 s75, s65, 16384
    buffer_load_dwordx4 v1, s[52:55], s65 offen lds
    s_add_u32 m0, s66, 9152
    s_cmp_ge_u32 s75, s81
    buffer_load_dwordx4 v1, s[52:55], s65 offen offset:64 lds
    s_cselect_b32 s65, s80, s75
    s_waitcnt lgkmcnt(6)
    v_mfma_f32_32x32x16_bf16 v[216:231], v[112:115], v[116:119], v[216:231]
    ds_read_b128 v[164:167], v83 offset:6240
    ds_read_b128 v[168:171], v83 offset:6752
    v_mfma_f32_32x32x16_bf16 v[232:247], v[112:115], v[120:123], v[232:247]
    s_waitcnt vmcnt(6)
    ds_read_b64_tr_b16 v[156:157], v74 offset:2048
    ds_read_b64_tr_b16 v[158:159], v74 offset:2304
    v_mfma_f32_32x32x16_bf16 v[184:199], v[124:127], v[132:135], v[184:199]
    ds_read_b64_tr_b16 v[160:161], v74 offset:3072
    ds_read_b64_tr_b16 v[162:163], v74 offset:3328
    s_add_u32 m0, s66, 10240
    s_add_u32 s75, s65, 16384
    buffer_load_dwordx4 v1, s[52:55], s65 offen lds
    s_add_u32 m0, s66, 11200
    s_cmp_ge_u32 s75, s81
    buffer_load_dwordx4 v1, s[52:55], s65 offen offset:64 lds
    s_cselect_b32 s65, s80, s75
    s_waitcnt lgkmcnt(12)
    v_mfma_f32_32x32x16_bf16 v[200:215], v[124:127], v[136:139], v[200:215]
    v_mfma_f32_32x32x16_bf16 v[216:231], v[128:131], v[132:135], v[216:231]
    v_mfma_f32_32x32x16_bf16 v[232:247], v[128:131], v[136:139], v[232:247]
    s_waitcnt lgkmcnt(6)
    v_mfma_f32_32x32x16_bf16 v[184:199], v[140:143], v[148:151], v[184:199]
    v_mfma_f32_32x32x16_bf16 v[200:215], v[140:143], v[152:155], v[200:215]
    v_mfma_f32_32x32x16_bf16 v[216:231], v[144:147], v[148:151], v[216:231]
    s_add_u32 m0, s66, 0
    s_add_u32 s75, s65, 16384
    buffer_load_dwordx4 v1, s[52:55], s65 offen lds
    s_add_u32 m0, s66, 960
    s_cmp_ge_u32 s75, s81
    buffer_load_dwordx4 v1, s[52:55], s65 offen offset:64 lds
    s_cselect_b32 s65, s80, s75
    s_waitcnt lgkmcnt(0)
    v_mfma_f32_32x32x16_bf16 v[232:247], v[144:147], v[152:155], v[232:247]
    v_mfma_f32_32x32x16_bf16 v[184:199], v[156:159], v[164:167], v[184:199]
    v_mfma_f32_32x32x16_bf16 v[200:215], v[156:159], v[168:171], v[200:215]
    s_add_u32 m0, s66, 2048
    s_add_u32 s75, s65, 16384
    buffer_load_dwordx4 v1, s[52:55], s65 offen lds
    s_add_u32 m0, s66, 3008
    s_cmp_ge_u32 s75, s81
    buffer_load_dwordx4 v1, s[52:55], s65 offen offset:64 lds
    s_cselect_b32 s65, s80, s75
    s_waitcnt lgkmcnt(0)
    v_mfma_f32_32x32x16_bf16 v[216:231], v[160:163], v[164:167], v[216:231]
    v_mfma_f32_32x32x16_bf16 v[232:247], v[160:163], v[168:171], v[232:247]
L_f1done:
    buffer_store_dwordx4 v[100:103], v251, s[12:15], s20 offen sc1
    buffer_store_dwordx4 v[100:103], v251, s[12:15], s21 offen sc1
    ds_write_b32 v253, v255 offset:80
    s_setprio 2
    v_readfirstlane_b32 s26, v64
    v_readfirstlane_b32 s27, v65
    s_nop 4
    s_nop 1
    v_pk_mul_f32 v[8:9], v[184:185], v[92:93]
    v_pk_mul_f32 v[10:11], v[186:187], v[92:93]
    v_pk_mul_f32 v[12:13], v[188:189], v[92:93]
    v_pk_mul_f32 v[14:15], v[190:191], v[92:93]
    v_exp_f32 v8, v8
    v_exp_f32 v9, v9
    v_exp_f32 v10, v10
    v_exp_f32 v11, v11
    v_exp_f32 v12, v12
    v_exp_f32 v13, v13
    v_exp_f32 v14, v14
    v_exp_f32 v15, v15
    v_pk_fma_f32 v[8:9], v[8:9], v[96:97], v[96:97]
    v_pk_fma_f32 v[10:11], v[10:11], v[96:97], v[96:97]
    v_pk_fma_f32 v[12:13], v[12:13], v[96:97], v[96:97]
    v_pk_fma_f32 v[14:15], v[14:15], v[96:97], v[96:97]
    v_rcp_f32 v8, v8
    v_rcp_f32 v9, v9
    v_rcp_f32 v10, v10
    v_rcp_f32 v11, v11
    v_rcp_f32 v12, v12
    v_rcp_f32 v13, v13
    v_rcp_f32 v14, v14
    v_rcp_f32 v15, v15
    v_pk_mul_f32 v[8:9], v[8:9], v[184:185]
    v_pk_mul_f32 v[10:11], v[10:11], v[186:187]
    v_pk_mul_f32 v[12:13], v[12:13], v[188:189]
    v_pk_mul_f32 v[14:15], v[14:15], v[190:191]
    v_cvt_pk_bf16_f32 v16, v8, v9
    v_cvt_pk_bf16_f32 v17, v10, v11
    v_cvt_pk_bf16_f32 v18, v12, v13
    v_cvt_pk_bf16_f32 v19, v14, v15
    buffer_store_dwordx4 v[16:19], v251, s[48:51], s84 offen sc1
    v_pk_mul_f32 v[8:9], v[192:193], v[92:93]
    v_pk_mul_f32 v[10:11], v[194:195], v[92:93]
    v_pk_mul_f32 v[12:13], v[196:197], v[92:93]
    v_pk_mul_f32 v[14:15], v[198:199], v[92:93]
    v_exp_f32 v8, v8
    v_exp_f32 v9, v9
    v_exp_f32 v10, v10
    v_exp_f32 v11, v11
    v_exp_f32 v12, v12
    v_exp_f32 v13, v13
    v_exp_f32 v14, v14
    v_exp_f32 v15, v15
    v_pk_fma_f32 v[8:9], v[8:9], v[96:97], v[96:97]
    v_pk_fma_f32 v[10:11], v[10:11], v[96:97], v[96:97]
    v_pk_fma_f32 v[12:13], v[12:13], v[96:97], v[96:97]
    v_pk_fma_f32 v[14:15], v[14:15], v[96:97], v[96:97]
    v_rcp_f32 v8, v8
    v_rcp_f32 v9, v9
    v_rcp_f32 v10, v10
    v_rcp_f32 v11, v11
    v_rcp_f32 v12, v12
    v_rcp_f32 v13, v13
    v_rcp_f32 v14, v14
    v_rcp_f32 v15, v15
    v_pk_mul_f32 v[8:9], v[8:9], v[192:193]
    v_pk_mul_f32 v[10:11], v[10:11], v[194:195]
    v_pk_mul_f32 v[12:13], v[12:13], v[196:197]
    v_pk_mul_f32 v[14:15], v[14:15], v[198:199]
    v_cvt_pk_bf16_f32 v20, v8, v9
    v_cvt_pk_bf16_f32 v21, v10, v11
    v_cvt_pk_bf16_f32 v22, v12, v13
    v_cvt_pk_bf16_f32 v23, v14, v15
    buffer_store_dwordx4 v[20:23], v251, s[48:51], s84 offen offset:2048 sc1
    v_pk_mul_f32 v[8:9], v[200:201], v[94:95]
    v_pk_mul_f32 v[10:11], v[202:203], v[94:95]
    v_pk_mul_f32 v[12:13], v[204:205], v[94:95]
    v_pk_mul_f32 v[14:15], v[206:207], v[94:95]
    v_exp_f32 v8, v8
    v_exp_f32 v9, v9
    v_exp_f32 v10, v10
    v_exp_f32 v11, v11
    v_exp_f32 v12, v12
    v_exp_f32 v13, v13
    v_exp_f32 v14, v14
    v_exp_f32 v15, v15
    v_pk_fma_f32 v[8:9], v[8:9], v[98:99], v[98:99]
    v_pk_fma_f32 v[10:11], v[10:11], v[98:99], v[98:99]
    v_pk_fma_f32 v[12:13], v[12:13], v[98:99], v[98:99]
    v_pk_fma_f32 v[14:15], v[14:15], v[98:99], v[98:99]
    v_rcp_f32 v8, v8
    v_rcp_f32 v9, v9
    v_rcp_f32 v10, v10
    v_rcp_f32 v11, v11
    v_rcp_f32 v12, v12
    v_rcp_f32 v13, v13
    v_rcp_f32 v14, v14
    v_rcp_f32 v15, v15
    v_pk_mul_f32 v[8:9], v[8:9], v[200:201]
    v_pk_mul_f32 v[10:11], v[10:11], v[202:203]
    v_pk_mul_f32 v[12:13], v[12:13], v[204:205]
    v_pk_mul_f32 v[14:15], v[14:15], v[206:207]
    v_cvt_pk_bf16_f32 v24, v8, v9
    v_cvt_pk_bf16_f32 v25, v10, v11
    v_cvt_pk_bf16_f32 v26, v12, v13
    v_cvt_pk_bf16_f32 v27, v14, v15
    buffer_store_dwordx4 v[24:27], v251, s[48:51], s84 offen offset:1024 sc1
    v_pk_mul_f32 v[8:9], v[208:209], v[94:95]
    v_pk_mul_f32 v[10:11], v[210:211], v[94:95]
    v_pk_mul_f32 v[12:13], v[212:213], v[94:95]
    v_pk_mul_f32 v[14:15], v[214:215], v[94:95]
    v_exp_f32 v8, v8
    v_exp_f32 v9, v9
    v_exp_f32 v10, v10
    v_exp_f32 v11, v11
    v_exp_f32 v12, v12
    v_exp_f32 v13, v13
    v_exp_f32 v14, v14
    v_exp_f32 v15, v15
    v_pk_fma_f32 v[8:9], v[8:9], v[98:99], v[98:99]
    v_pk_fma_f32 v[10:11], v[10:11], v[98:99], v[98:99]
    v_pk_fma_f32 v[12:13], v[12:13], v[98:99], v[98:99]
    v_pk_fma_f32 v[14:15], v[14:15], v[98:99], v[98:99]
    v_rcp_f32 v8, v8
    v_rcp_f32 v9, v9
    v_rcp_f32 v10, v10
    v_rcp_f32 v11, v11
    v_rcp_f32 v12, v12
    v_rcp_f32 v13, v13
    v_rcp_f32 v14, v14
    v_rcp_f32 v15, v15
    v_pk_mul_f32 v[8:9], v[8:9], v[208:209]
    v_pk_mul_f32 v[10:11], v[10:11], v[210:211]
    v_pk_mul_f32 v[12:13], v[12:13], v[212:213]
    v_pk_mul_f32 v[14:15], v[14:15], v[214:215]
    v_cvt_pk_bf16_f32 v28, v8, v9
    v_cvt_pk_bf16_f32 v29, v10, v11
    v_cvt_pk_bf16_f32 v30, v12, v13
    v_cvt_pk_bf16_f32 v31, v14, v15
    buffer_store_dwordx4 v[28:31], v251, s[48:51], s84 offen offset:3072 sc1
    s_cmp_eq_u32 s39, 1
    s_cbranch_scc1 L_silu_done
    v_pk_mul_f32 v[8:9], v[216:217], v[92:93]
    v_pk_mul_f32 v[10:11], v[218:219], v[92:93]
    v_pk_mul_f32 v[12:13], v[220:221], v[92:93]
    v_pk_mul_f32 v[14:15], v[222:223], v[92:93]
    v_exp_f32 v8, v8
    v_exp_f32 v9, v9
    v_exp_f32 v10, v10
    v_exp_f32 v11, v11
    v_exp_f32 v12, v12
    v_exp_f32 v13, v13
    v_exp_f32 v14, v14
    v_exp_f32 v15, v15
    v_pk_fma_f32 v[8:9], v[8:9], v[96:97], v[96:97]
    v_pk_fma_f32 v[10:11], v[10:11], v[96:97], v[96:97]
    v_pk_fma_f32 v[12:13], v[12:13], v[96:97], v[96:97]
    v_pk_fma_f32 v[14:15], v[14:15], v[96:97], v[96:97]
    v_rcp_f32 v8, v8
    v_rcp_f32 v9, v9
    v_rcp_f32 v10, v10
    v_rcp_f32 v11, v11
    v_rcp_f32 v12, v12
    v_rcp_f32 v13, v13
    v_rcp_f32 v14, v14
    v_rcp_f32 v15, v15
    v_pk_mul_f32 v[8:9], v[8:9], v[216:217]
    v_pk_mul_f32 v[10:11], v[10:11], v[218:219]
    v_pk_mul_f32 v[12:13], v[12:13], v[220:221]
    v_pk_mul_f32 v[14:15], v[14:15], v[222:223]
    v_cvt_pk_bf16_f32 v32, v8, v9
    v_cvt_pk_bf16_f32 v33, v10, v11
    v_cvt_pk_bf16_f32 v34, v12, v13
    v_cvt_pk_bf16_f32 v35, v14, v15
    buffer_store_dwordx4 v[32:35], v251, s[48:51], s85 offen sc1
    v_pk_mul_f32 v[8:9], v[224:225], v[92:93]
    v_pk_mul_f32 v[10:11], v[226:227], v[92:93]
    v_pk_mul_f32 v[12:13], v[228:229], v[92:93]
    v_pk_mul_f32 v[14:15], v[230:231], v[92:93]
    v_exp_f32 v8, v8
    v_exp_f32 v9, v9
    v_exp_f32 v10, v10
    v_exp_f32 v11, v11
    v_exp_f32 v12, v12
    v_exp_f32 v13, v13
    v_exp_f32 v14, v14
    v_exp_f32 v15, v15
    v_pk_fma_f32 v[8:9], v[8:9], v[96:97], v[96:97]
    v_pk_fma_f32 v[10:11], v[10:11], v[96:97], v[96:97]
    v_pk_fma_f32 v[12:13], v[12:13], v[96:97], v[96:97]
    v_pk_fma_f32 v[14:15], v[14:15], v[96:97], v[96:97]
    v_rcp_f32 v8, v8
    v_rcp_f32 v9, v9
    v_rcp_f32 v10, v10
    v_rcp_f32 v11, v11
    v_rcp_f32 v12, v12
    v_rcp_f32 v13, v13
    v_rcp_f32 v14, v14
    v_rcp_f32 v15, v15
    v_pk_mul_f32 v[8:9], v[8:9], v[224:225]
    v_pk_mul_f32 v[10:11], v[10:11], v[226:227]
    v_pk_mul_f32 v[12:13], v[12:13], v[228:229]
    v_pk_mul_f32 v[14:15], v[14:15], v[230:231]
    v_cvt_pk_bf16_f32 v36, v8, v9
    v_cvt_pk_bf16_f32 v37, v10, v11
    v_cvt_pk_bf16_f32 v38, v12, v13
    v_cvt_pk_bf16_f32 v39, v14, v15
    buffer_store_dwordx4 v[36:39], v251, s[48:51], s85 offen offset:2048 sc1
    buffer_load_dwordx2 v[6:7], v62, s[12:15], s67 offen offset:704 sc1
    v_pk_mul_f32 v[8:9], v[232:233], v[94:95]
    v_pk_mul_f32 v[10:11], v[234:235], v[94:95]
    v_pk_mul_f32 v[12:13], v[236:237], v[94:95]
    v_pk_mul_f32 v[14:15], v[238:239], v[94:95]
    v_exp_f32 v8, v8
    v_exp_f32 v9, v9
    v_exp_f32 v10, v10
    v_exp_f32 v11, v11
    v_exp_f32 v12, v12
    v_exp_f32 v13, v13
    v_exp_f32 v14, v14
    v_exp_f32 v15, v15
    v_pk_fma_f32 v[8:9], v[8:9], v[98:99], v[98:99]
    v_pk_fma_f32 v[10:11], v[10:11], v[98:99], v[98:99]
    v_pk_fma_f32 v[12:13], v[12:13], v[98:99], v[98:99]
    v_pk_fma_f32 v[14:15], v[14:15], v[98:99], v[98:99]
    v_rcp_f32 v8, v8
    v_rcp_f32 v9, v9
    v_rcp_f32 v10, v10
    v_rcp_f32 v11, v11
    v_rcp_f32 v12, v12
    v_rcp_f32 v13, v13
    v_rcp_f32 v14, v14
    v_rcp_f32 v15, v15
    v_pk_mul_f32 v[8:9], v[8:9], v[232:233]
    v_pk_mul_f32 v[10:11], v[10:11], v[234:235]
    v_pk_mul_f32 v[12:13], v[12:13], v[236:237]
    v_pk_mul_f32 v[14:15], v[14:15], v[238:239]
    v_cvt_pk_bf16_f32 v40, v8, v9
    v_cvt_pk_bf16_f32 v41, v10, v11
    v_cvt_pk_bf16_f32 v42, v12, v13
    v_cvt_pk_bf16_f32 v43, v14, v15
    buffer_store_dwordx4 v[40:43], v251, s[48:51], s85 offen offset:1024 sc1
    s_waitcnt vmcnt(1)
    v_cmp_ne_u64 vcc, s[26:27], v[6:7]
    s_nop 0
    s_cbranch_vccnz L_noearly
    s_mov_b32 s25, 1
    buffer_load_dwordx4 v[124:127], v251, s[48:51], s64 offen sc1
    buffer_load_dwordx4 v[128:131], v251, s[48:51], s64 offen offset:1024 sc1
    s_add_u32 s64, s64, 2048
    s_cmp_ge_u32 s64, s83
    s_cselect_b32 s64, s82, s64
    buffer_load_dwordx4 v[132:135], v251, s[48:51], s64 offen sc1
    buffer_load_dwordx4 v[136:139], v251, s[48:51], s64 offen offset:1024 sc1
    s_add_u32 s64, s64, 2048
    s_cmp_ge_u32 s64, s83
    s_cselect_b32 s64, s82, s64
L_noearly:
    v_pk_mul_f32 v[8:9], v[240:241], v[94:95]
    v_pk_mul_f32 v[10:11], v[242:243], v[94:95]
    v_pk_mul_f32 v[12:13], v[244:245], v[94:95]
    v_pk_mul_f32 v[14:15], v[246:247], v[94:95]
    v_exp_f32 v8, v8
    v_exp_f32 v9, v9
    v_exp_f32 v10, v10
    v_exp_f32 v11, v11
    v_exp_f32 v12, v12
    v_exp_f32 v13, v13
    v_exp_f32 v14, v14
    v_exp_f32 v15, v15
    v_pk_fma_f32 v[8:9], v[8:9], v[98:99], v[98:99]
    v_pk_fma_f32 v[10:11], v[10:11], v[98:99], v[98:99]
    v_pk_fma_f32 v[12:13], v[12:13], v[98:99], v[98:99]
    v_pk_fma_f32 v[14:15], v[14:15], v[98:99], v[98:99]
    v_rcp_f32 v8, v8
    v_rcp_f32 v9, v9
    v_rcp_f32 v10, v10
    v_rcp_f32 v11, v11
    v_rcp_f32 v12, v12
    v_rcp_f32 v13, v13
    v_rcp_f32 v14, v14
    v_rcp_f32 v15, v15
    v_pk_mul_f32 v[8:9], v[8:9], v[240:241]
    v_pk_mul_f32 v[10:11], v[10:11], v[242:243]
    v_pk_mul_f32 v[12:13], v[12:13], v[244:245]
    v_pk_mul_f32 v[14:15], v[14:15], v[246:247]
    v_cvt_pk_bf16_f32 v44, v8, v9
    v_cvt_pk_bf16_f32 v45, v10, v11
    v_cvt_pk_bf16_f32 v46, v12, v13
    v_cvt_pk_bf16_f32 v47, v14, v15
    buffer_store_dwordx4 v[44:47], v251, s[48:51], s85 offen offset:3072 sc1
L_silu_done:
    s_setprio 0
    s_waitcnt vmcnt(4)
    ds_write_b32 v253, v255 offset:112
    s_cmp_eq_u32 s25, 1
    s_cbranch_scc0 L_f2late
    s_lshl_b32 s71, s89, 2
    s_add_u32 s71, s71, s86
    s_mov_b32 s2, 0
    s_cmp_lt_u32 s71, 4
    s_cbranch_scc0 L_noduty_7
    s_call_b64 s[0:1], L_duty
L_noduty_7:
    buffer_load_dwordx4 v[200:203], v251, s[48:51], s64 offen sc1
    buffer_load_dwordx4 v[204:207], v251, s[48:51], s64 offen offset:1024 sc1
    s_add_u32 s64, s64, 2048
    s_cmp_ge_u32 s64, s83
    s_cselect_b32 s64, s82, s64
    buffer_load_dwordx4 v[208:211], v251, s[48:51], s64 offen sc1
    buffer_load_dwordx4 v[212:215], v251, s[48:51], s64 offen offset:1024 sc1
    s_add_u32 s64, s64, 2048
    s_cmp_ge_u32 s64, s83
    s_cselect_b32 s64, s82, s64
    buffer_load_dwordx4 v[216:219], v251, s[48:51], s64 offen sc1
    buffer_load_dwordx4 v[220:223], v251, s[48:51], s64 offen offset:1024 sc1
    s_add_u32 s64, s64, 2048
    s_cmp_ge_u32 s64, s83
    s_cselect_b32 s64, s82, s64
    buffer_load_dwordx4 v[224:227], v251, s[48:51], s64 offen sc1
    buffer_load_dwordx4 v[228:231], v251, s[48:51], s64 offen offset:1024 sc1
    s_add_u32 s64, s64, 2048
    s_cmp_ge_u32 s64, s83
    s_cselect_b32 s64, s82, s64
    s_waitcnt vmcnt(9)
    s_cmp_eq_u32 s2, 9
    s_cbranch_scc1 L_hdrained
    s_waitcnt vmcnt(8)
L_hdrained:
    s_mov_b64 exec, 1
    buffer_store_dwordx2 v[64:65], v66, s[12:15], s87 offen sc1
    s_mov_b64 exec, -1
L_f2go:
    s_waitcnt vmcnt(15)
    ds_read_b64_tr_b16 v[232:233], v3 offset:4096
    ds_read_b64_tr_b16 v[234:235], v3 offset:4608
    ds_read_b64_tr_b16 v[236:237], v3 offset:5120
    ds_read_b64_tr_b16 v[238:239], v3 offset:5632
    s_waitcnt vmcnt(14)
    ds_read_b64_tr_b16 v[240:241], v3 offset:6144
    ds_read_b64_tr_b16 v[242:243], v3 offset:6656
    ds_read_b64_tr_b16 v[244:245], v3 offset:7168
    ds_read_b64_tr_b16 v[246:247], v3 offset:7680
    s_waitcnt vmcnt(9) lgkmcnt(4)
    v_mfma_f32_32x32x16_bf16 v[8:23], v[232:235], v[124:127], 0
    v_mfma_f32_32x32x16_bf16 v[40:55], v[232:235], v[128:131], 0
    v_mfma_f32_32x32x16_bf16 v[24:39], v[236:239], v[124:127], 0
    s_waitcnt vmcnt(13)
    ds_read_b64_tr_b16 v[232:233], v3 offset:8192
    ds_read_b64_tr_b16 v[234:235], v3 offset:8704
    s_add_u32 m0, s66, 4096
    s_add_u32 s75, s65, 16384
    buffer_load_dwordx4 v1, s[52:55], s65 offen lds
    s_add_u32 m0, s66, 5056
    s_cmp_ge_u32 s75, s81
    buffer_load_dwordx4 v1, s[52:55], s65 offen offset:64 lds
    s_cselect_b32 s65, s80, s75
    s_waitcnt vmcnt(10) lgkmcnt(4)
    v_mfma_f32_32x32x16_bf16 v[56:71], v[236:239], v[128:131], 0
    ds_read_b64_tr_b16 v[236:237], v3 offset:9216
    ds_read_b64_tr_b16 v[238:239], v3 offset:9728
    v_mfma_f32_32x32x16_bf16 v[8:23], v[240:243], v[132:135], v[8:23]
    v_mfma_f32_32x32x16_bf16 v[40:55], v[240:243], v[136:139], v[40:55]
    s_waitcnt vmcnt(14)
    ds_read_b64_tr_b16 v[240:241], v3 offset:10240
    ds_read_b64_tr_b16 v[242:243], v3 offset:10752
    s_waitcnt vmcnt(8) lgkmcnt(4)
    v_mfma_f32_32x32x16_bf16 v[24:39], v[244:247], v[132:135], v[24:39]
    v_mfma_f32_32x32x16_bf16 v[56:71], v[244:247], v[136:139], v[56:71]
    ds_read_b64_tr_b16 v[244:245], v3 offset:11264
    ds_read_b64_tr_b16 v[246:247], v3 offset:11776
    v_mfma_f32_32x32x16_bf16 v[8:23], v[232:235], v[200:203], v[8:23]
L_spin_15:
    ds_read_b32 v250, v254 offset:272
    s_waitcnt lgkmcnt(0)
    s_setprio 2
    v_cmp_ne_u32 vcc, 1, v250
    s_setprio 0
    s_cbranch_vccnz L_retry_16
    s_add_u32 m0, s66, 6144
    s_add_u32 s75, s65, 16384
    buffer_load_dwordx4 v1, s[52:55], s65 offen lds
    s_add_u32 m0, s66, 7104
    s_cmp_ge_u32 s75, s81
    buffer_load_dwordx4 v1, s[52:55], s65 offen offset:64 lds
    s_cselect_b32 s65, s80, s75
    s_waitcnt vmcnt(10) lgkmcnt(4)
    v_mfma_f32_32x32x16_bf16 v[40:55], v[232:235], v[204:207], v[40:55]
    ds_read_b64_tr_b16 v[72:73], v5
    ds_read_b64_tr_b16 v[74:75], v5 offset:512
    v_mfma_f32_32x32x16_bf16 v[24:39], v[236:239], v[200:203], v[24:39]
    ds_read_b64_tr_b16 v[76:77], v5 offset:8
    ds_read_b64_tr_b16 v[78:79], v5 offset:520
    v_mfma_f32_32x32x16_bf16 v[56:71], v[236:239], v[204:207], v[56:71]
    s_waitcnt vmcnt(15)
    ds_read_b64_tr_b16 v[232:233], v3
    ds_read_b64_tr_b16 v[234:235], v3 offset:512
    ds_read_b64_tr_b16 v[236:237], v3 offset:1024
    ds_read_b64_tr_b16 v[238:239], v3 offset:1536
    buffer_load_dwordx4 v[200:203], v251, s[48:51], s64 offen sc1
    buffer_load_dwordx4 v[204:207], v251, s[48:51], s64 offen offset:1024 sc1
    s_add_u32 s64, s64, 2048
    s_cmp_ge_u32 s64, s83
    s_cselect_b32 s64, s82, s64
    s_add_u32 m0, s66, 8192
    s_add_u32 s75, s65, 16384
    buffer_load_dwordx4 v1, s[52:55], s65 offen lds
    s_add_u32 m0, s66, 9152
    s_cmp_ge_u32 s75, s81
    buffer_load_dwordx4 v1, s[52:55], s65 offen offset:64 lds
    s_cselect_b32 s65, s80, s75
    s_waitcnt vmcnt(12) lgkmcnt(7)
    v_mfma_f32_32x32x16_bf16 v[8:23], v[240:243], v[208:211], v[8:23]
    ds_read_b64_tr_b16 v[80:81], v5 offset:2048
    ds_read_b64_tr_b16 v[82:83], v5 offset:2560
    v_mfma_f32_32x32x16_bf16 v[40:55], v[240:243], v[212:215], v[40:55]
    ds_read_b64_tr_b16 v[84:85], v5 offset:2056
    ds_read_b64_tr_b16 v[86:87], v5 offset:2568
    v_mfma_f32_32x32x16_bf16 v[24:39], v[244:247], v[208:211], v[24:39]
    s_waitcnt vmcnt(18)
    ds_read_b64_tr_b16 v[240:241], v3 offset:2048
    ds_read_b64_tr_b16 v[242:243], v3 offset:2560
    ds_read_b64_tr_b16 v[88:89], v5 offset:4096
    s_add_u32 m0, s66, 10240
    s_add_u32 s75, s65, 16384
    buffer_load_dwordx4 v1, s[52:55], s65 offen lds
    s_add_u32 m0, s66, 11200
    s_cmp_ge_u32 s75, s81
    buffer_load_dwordx4 v1, s[52:55], s65 offen offset:64 lds
    s_cselect_b32 s65, s80, s75
    s_waitcnt vmcnt(12) lgkmcnt(7)
    v_mfma_f32_32x32x16_bf16 v[56:71], v[244:247], v[212:215], v[56:71]
    ds_read_b64_tr_b16 v[244:245], v3 offset:3072
    ds_read_b64_tr_b16 v[246:247], v3 offset:3584
    v_mfma_f32_32x32x16_bf16 v[8:23], v[232:235], v[216:219], v[8:23]
    ds_read_b64_tr_b16 v[90:91], v5 offset:4608
    ds_read_b64_tr_b16 v[92:93], v5 offset:4104
    v_mfma_f32_32x32x16_bf16 v[40:55], v[232:235], v[220:223], v[40:55]
    s_waitcnt vmcnt(8)
    ds_read_b64_tr_b16 v[232:233], v3 offset:4096
    ds_read_b64_tr_b16 v[234:235], v3 offset:4608
    ds_read_b64_tr_b16 v[94:95], v5 offset:4616
    buffer_load_dwordx4 v[208:211], v251, s[48:51], s64 offen sc1
    buffer_load_dwordx4 v[212:215], v251, s[48:51], s64 offen offset:1024 sc1
    s_add_u32 s64, s64, 2048
    s_cmp_ge_u32 s64, s83
    s_cselect_b32 s64, s82, s64
    s_waitcnt vmcnt(12) lgkmcnt(7)
    v_mfma_f32_32x32x16_bf16 v[24:39], v[236:239], v[216:219], v[24:39]
    ds_read_b64_tr_b16 v[96:97], v5 offset:6144
    ds_read_b64_tr_b16 v[98:99], v5 offset:6656
    v_mfma_f32_32x32x16_bf16 v[56:71], v[236:239], v[220:223], v[56:71]
    ds_read_b64_tr_b16 v[236:237], v3 offset:5120
    ds_read_b64_tr_b16 v[238:239], v3 offset:5632
    v_mfma_f32_32x32x16_bf16 v[8:23], v[240:243], v[224:227], v[8:23]
    ds_read_b64_tr_b16 v[100:101], v5 offset:6152
    ds_read_b64_tr_b16 v[102:103], v5 offset:6664
    ds_read_b64_tr_b16 v[104:105], v5 offset:8192
    buffer_load_dwordx4 v[216:219], v251, s[48:51], s64 offen sc1
    buffer_load_dwordx4 v[220:223], v251, s[48:51], s64 offen offset:1024 sc1
    s_add_u32 s64, s64, 2048
    s_cmp_ge_u32 s64, s83
    s_cselect_b32 s64, s82, s64
    s_add_u32 m0, s66, 0
    s_add_u32 s75, s65, 16384
    buffer_load_dwordx4 v1, s[52:55], s65 offen lds
    s_add_u32 m0, s66, 960
    s_cmp_ge_u32 s75, s81
    buffer_load_dwordx4 v1, s[52:55], s65 offen offset:64 lds
    s_cselect_b32 s65, s80, s75
    s_waitcnt vmcnt(16) lgkmcnt(7)
    v_mfma_f32_32x32x16_bf16 v[40:55], v[240:243], v[228:231], v[40:55]
    ds_read_b64_tr_b16 v[106:107], v5 offset:8704
    ds_read_b64_tr_b16 v[108:109], v5 offset:8200
    v_mfma_f32_32x32x16_bf16 v[24:39], v[244:247], v[224:227], v[24:39]
    ds_read_b64_tr_b16 v[110:111], v5 offset:8712
    ds_read_b64_tr_b16 v[112:113], v5 offset:10240
    v_mfma_f32_32x32x16_bf16 v[56:71], v[244:247], v[228:231], v[56:71]
    s_waitcnt vmcnt(12)
    ds_read_b64_tr_b16 v[240:241], v3 offset:6144
    ds_read_b64_tr_b16 v[242:243], v3 offset:6656
    ds_read_b64_tr_b16 v[244:245], v3 offset:7168
    ds_read_b64_tr_b16 v[246:247], v3 offset:7680
    buffer_load_dwordx4 v[224:227], v251, s[48:51], s64 offen sc1
    buffer_load_dwordx4 v[228:231], v251, s[48:51], s64 offen offset:1024 sc1
    s_add_u32 s64, s64, 2048
    s_cmp_ge_u32 s64, s83
    s_cselect_b32 s64, s82, s64
    s_sub_u32 s80, s80, 720896
    s_sub_u32 s81, s81, 720896
    s_sub_u32 s65, s65, 720896
    s_add_u32 m0, s66, 2048
    s_add_u32 s75, s65, 16384
    buffer_load_dwordx4 v1, s[52:55], s65 offen lds
    s_add_u32 m0, s66, 3008
    s_cmp_ge_u32 s75, s81
    buffer_load_dwordx4 v1, s[52:55], s65 offen offset:64 lds
    s_cselect_b32 s65, s80, s75
    s_waitcnt vmcnt(14) lgkmcnt(7)
    v_mfma_f32_32x32x16_bf16 v[8:23], v[232:235], v[200:203], v[8:23]
    ds_read_b64_tr_b16 v[114:115], v5 offset:10752
    ds_read_b64_tr_b16 v[116:117], v5 offset:10248
    v_mfma_f32_32x32x16_bf16 v[40:55], v[232:235], v[204:207], v[40:55]
    ds_read_b64_tr_b16 v[118:119], v5 offset:10760
    ds_read_b64_tr_b16 v[120:121], v5 offset:12288
    v_mfma_f32_32x32x16_bf16 v[24:39], v[236:239], v[200:203], v[24:39]
    s_waitcnt vmcnt(12)
    ds_read_b64_tr_b16 v[232:233], v3 offset:8192
    ds_read_b64_tr_b16 v[234:235], v3 offset:8704
    ds_read_b64_tr_b16 v[122:123], v5 offset:12800
    buffer_load_dwordx2 v[6:7], v0, s[12:15], s67 offen sc1
    s_add_u32 m0, s66, 4096
    s_add_u32 s75, s65, 16384
    buffer_load_dwordx4 v1, s[52:55], s65 offen lds
    s_add_u32 m0, s66, 5056
    s_cmp_ge_u32 s75, s81
    buffer_load_dwordx4 v1, s[52:55], s65 offen offset:64 lds
    s_cselect_b32 s65, s80, s75
    s_waitcnt vmcnt(11) lgkmcnt(7)
    v_mfma_f32_32x32x16_bf16 v[56:71], v[236:239], v[204:207], v[56:71]
    ds_read_b64_tr_b16 v[236:237], v3 offset:9216
    ds_read_b64_tr_b16 v[238:239], v3 offset:9728
    v_mfma_f32_32x32x16_bf16 v[8:23], v[240:243], v[208:211], v[8:23]
    ds_read_b64_tr_b16 v[124:125], v5 offset:12296
    ds_read_b64_tr_b16 v[126:127], v5 offset:12808
    v_mfma_f32_32x32x16_bf16 v[40:55], v[240:243], v[212:215], v[40:55]
    s_waitcnt vmcnt(13)
    ds_read_b64_tr_b16 v[240:241], v3 offset:10240
    ds_read_b64_tr_b16 v[242:243], v3 offset:10752
    ds_read_b64_tr_b16 v[128:129], v5 offset:14336
    buffer_load_dwordx4 v[200:203], v251, s[48:51], s64 offen sc1
    buffer_load_dwordx4 v[204:207], v251, s[48:51], s64 offen offset:1024 sc1
    s_add_u32 s64, s64, 2048
    s_cmp_ge_u32 s64, s83
    s_cselect_b32 s64, s82, s64
    s_waitcnt vmcnt(11) lgkmcnt(7)
    v_mfma_f32_32x32x16_bf16 v[24:39], v[244:247], v[208:211], v[24:39]
    ds_read_b64_tr_b16 v[130:131], v5 offset:14848
    ds_read_b64_tr_b16 v[132:133], v5 offset:14344
    v_mfma_f32_32x32x16_bf16 v[56:71], v[244:247], v[212:215], v[56:71]
    ds_read_b64_tr_b16 v[244:245], v3 offset:11264
    ds_read_b64_tr_b16 v[246:247], v3 offset:11776
    v_mfma_f32_32x32x16_bf16 v[8:23], v[232:235], v[216:219], v[8:23]
    ds_read_b64_tr_b16 v[134:135], v5 offset:14856
    ds_read_b64_tr_b16 v[136:137], v5 offset:16384
    ds_read_b64_tr_b16 v[138:139], v5 offset:16896
    s_waitcnt vmcnt(4)
    s_setprio 2
    v_cmp_ne_u64 vcc, s[26:27], v[6:7]
    s_setprio 0
    s_cbranch_vccnz L_lslow
L_lok:
    s_sub_u32 s82, s82, 90112
    s_sub_u32 s83, s83, 90112
    s_sub_u32 s64, s64, 90112
    buffer_load_dwordx4 v[208:211], v251, s[48:51], s64 offen sc1
    buffer_load_dwordx4 v[212:215], v251, s[48:51], s64 offen offset:1024 sc1
    s_add_u32 s64, s64, 2048
    s_cmp_ge_u32 s64, s83
    s_cselect_b32 s64, s82, s64
    s_add_u32 m0, s66, 6144
    s_add_u32 s75, s65, 16384
    buffer_load_dwordx4 v1, s[52:55], s65 offen lds
    s_add_u32 m0, s66, 7104
    s_cmp_ge_u32 s75, s81
    buffer_load_dwordx4 v1, s[52:55], s65 offen offset:64 lds
    s_cselect_b32 s65, s80, s75
    s_waitcnt vmcnt(15) lgkmcnt(7)
    v_mfma_f32_32x32x16_bf16 v[40:55], v[232:235], v[220:223], v[40:55]
    ds_read_b64_tr_b16 v[140:141], v5 offset:16392
    ds_read_b64_tr_b16 v[142:143], v5 offset:16904
    v_mfma_f32_32x32x16_bf16 v[24:39], v[236:239], v[216:219], v[24:39]
    ds_read_b64_tr_b16 v[144:145], v5 offset:18432
    ds_read_b64_tr_b16 v[146:147], v5 offset:18944
    v_mfma_f32_32x32x16_bf16 v[56:71], v[236:239], v[220:223], v[56:71]
    s_waitcnt vmcnt(13)
    ds_read_b64_tr_b16 v[232:233], v3
    ds_read_b64_tr_b16 v[234:235], v3 offset:512
    ds_read_b64_tr_b16 v[236:237], v3 offset:1024
    ds_read_b64_tr_b16 v[238:239], v3 offset:1536
    buffer_load_dwordx4 v[216:219], v251, s[48:51], s64 offen sc1
    buffer_load_dwordx4 v[220:223], v251, s[48:51], s64 offen offset:1024 sc1
    s_add_u32 s64, s64, 2048
    s_cmp_ge_u32 s64, s83
    s_cselect_b32 s64, s82, s64
    s_add_u32 m0, s66, 8192
    s_add_u32 s75, s65, 16384
    buffer_load_dwordx4 v1, s[52:55], s65 offen lds
    s_add_u32 m0, s66, 9152
    s_cmp_ge_u32 s75, s81
    buffer_load_dwordx4 v1, s[52:55], s65 offen offset:64 lds
    s_cselect_b32 s65, s80, s75
    s_waitcnt vmcnt(15) lgkmcnt(7)
    v_mfma_f32_32x32x16_bf16 v[8:23], v[240:243], v[224:227], v[8:23]
    ds_read_b64_tr_b16 v[148:149], v5 offset:18440
    ds_read_b64_tr_b16 v[150:151], v5 offset:18952
    v_mfma_f32_32x32x16_bf16 v[40:55], v[240:243], v[228:231], v[40:55]
    ds_read_b64_tr_b16 v[152:153], v5 offset:20480
    ds_read_b64_tr_b16 v[154:155], v5 offset:20992
    v_mfma_f32_32x32x16_bf16 v[24:39], v[244:247], v[224:227], v[24:39]
    s_waitcnt vmcnt(13)
    ds_read_b64_tr_b16 v[240:241], v3 offset:2048
    ds_read_b64_tr_b16 v[242:243], v3 offset:2560
    ds_read_b64_tr_b16 v[156:157], v5 offset:20488
    s_add_u32 m0, s66, 10240
    s_add_u32 s75, s65, 16384
    buffer_load_dwordx4 v1, s[52:55], s65 offen lds
    s_add_u32 m0, s66, 11200
    s_cmp_ge_u32 s75, s81
    buffer_load_dwordx4 v1, s[52:55], s65 offen offset:64 lds
    s_cselect_b32 s65, s80, s75
    s_waitcnt vmcnt(10) lgkmcnt(7)
    v_mfma_f32_32x32x16_bf16 v[56:71], v[244:247], v[228:231], v[56:71]
    ds_read_b64_tr_b16 v[244:245], v3 offset:3072
    ds_read_b64_tr_b16 v[246:247], v3 offset:3584
    v_mfma_f32_32x32x16_bf16 v[8:23], v[232:235], v[200:203], v[8:23]
    ds_read_b64_tr_b16 v[158:159], v5 offset:21000
    v_mfma_f32_32x32x16_bf16 v[40:55], v[232:235], v[204:207], v[40:55]
    s_waitcnt vmcnt(12)
    ds_read_b64_tr_b16 v[232:233], v3 offset:4096
    ds_read_b64_tr_b16 v[234:235], v3 offset:4608
    buffer_load_dwordx4 v[224:227], v251, s[48:51], s64 offen sc1
    buffer_load_dwordx4 v[228:231], v251, s[48:51], s64 offen offset:1024 sc1
    s_add_u32 s64, s64, 2048
    s_cmp_ge_u32 s64, s83
    s_cselect_b32 s64, s82, s64
    s_waitcnt vmcnt(10) lgkmcnt(6)
    v_mfma_f32_32x32x16_bf16 v[24:39], v[236:239], v[200:203], v[24:39]
    v_mfma_f32_32x32x16_bf16 v[56:71], v[236:239], v[204:207], v[56:71]
    ds_read_b64_tr_b16 v[236:237], v3 offset:5120
    ds_read_b64_tr_b16 v[238:239], v3 offset:5632
    v_mfma_f32_32x32x16_bf16 v[8:23], v[240:243], v[208:211], v[8:23]
    buffer_load_dwordx4 v[200:203], v251, s[48:51], s64 offen sc1
    buffer_load_dwordx4 v[204:207], v251, s[48:51], s64 offen offset:1024 sc1
    s_add_u32 s64, s64, 2048
    s_cmp_ge_u32 s64, s83
    s_cselect_b32 s64, s82, s64
    s_add_u32 m0, s66, 0
    s_add_u32 s75, s65, 16384
    buffer_load_dwordx4 v1, s[52:55], s65 offen lds
    s_add_u32 m0, s66, 960
    s_cmp_ge_u32 s75, s81
    buffer_load_dwordx4 v1, s[52:55], s65 offen offset:64 lds
    s_cselect_b32 s65, s80, s75
    s_waitcnt vmcnt(14) lgkmcnt(5)
    v_mfma_f32_32x32x16_bf16 v[40:55], v[240:243], v[212:215], v[40:55]
    v_mfma_f32_32x32x16_bf16 v[24:39], v[244:247], v[208:211], v[24:39]
    v_mfma_f32_32x32x16_bf16 v[56:71], v[244:247], v[212:215], v[56:71]
    s_waitcnt vmcnt(12)
    ds_read_b64_tr_b16 v[240:241], v3 offset:6144
    ds_read_b64_tr_b16 v[242:243], v3 offset:6656
    ds_read_b64_tr_b16 v[244:245], v3 offset:7168
    ds_read_b64_tr_b16 v[246:247], v3 offset:7680
    buffer_load_dwordx4 v[208:211], v251, s[48:51], s64 offen sc1
    buffer_load_dwordx4 v[212:215], v251, s[48:51], s64 offen offset:1024 sc1
    s_add_u32 s64, s64, 2048
    s_cmp_ge_u32 s64, s83
    s_cselect_b32 s64, s82, s64
    s_add_u32 m0, s66, 2048
    s_add_u32 s75, s65, 16384
    buffer_load_dwordx4 v1, s[52:55], s65 offen lds
    s_add_u32 m0, s66, 3008
    s_cmp_ge_u32 s75, s81
    buffer_load_dwordx4 v1, s[52:55], s65 offen offset:64 lds
    s_cselect_b32 s65, s80, s75
    s_waitcnt vmcnt(14) lgkmcnt(4)
    v_mfma_f32_32x32x16_bf16 v[8:23], v[232:235], v[216:219], v[8:23]
    v_mfma_f32_32x32x16_bf16 v[40:55], v[232:235], v[220:223], v[40:55]
    v_mfma_f32_32x32x16_bf16 v[24:39], v[236:239], v[216:219], v[24:39]
    s_waitcnt vmcnt(12)
    ds_read_b64_tr_b16 v[232:233], v3 offset:8192
    ds_read_b64_tr_b16 v[234:235], v3 offset:8704
    s_add_u32 m0, s66, 4096
    s_add_u32 s75, s65, 16384
    buffer_load_dwordx4 v1, s[52:55], s65 offen lds
    s_add_u32 m0, s66, 5056
    s_cmp_ge_u32 s75, s81
    buffer_load_dwordx4 v1, s[52:55], s65 offen offset:64 lds
    s_cselect_b32 s65, s80, s75
    s_waitcnt vmcnt(10) lgkmcnt(4)
    v_mfma_f32_32x32x16_bf16 v[56:71], v[236:239], v[220:223], v[56:71]
    ds_read_b64_tr_b16 v[236:237], v3 offset:9216
    ds_read_b64_tr_b16 v[238:239], v3 offset:9728
    v_mfma_f32_32x32x16_bf16 v[8:23], v[240:243], v[224:227], v[8:23]
    v_mfma_f32_32x32x16_bf16 v[40:55], v[240:243], v[228:231], v[40:55]
    s_waitcnt vmcnt(12)
    ds_read_b64_tr_b16 v[240:241], v3 offset:10240
    ds_read_b64_tr_b16 v[242:243], v3 offset:10752
    buffer_load_dwordx4 v[216:219], v251, s[48:51], s64 offen sc1
    buffer_load_dwordx4 v[220:223], v251, s[48:51], s64 offen offset:1024 sc1
    s_add_u32 s64, s64, 2048
    s_cmp_ge_u32 s64, s83
    s_cselect_b32 s64, s82, s64
    s_waitcnt vmcnt(10) lgkmcnt(4)
    v_mfma_f32_32x32x16_bf16 v[24:39], v[244:247], v[224:227], v[24:39]
    v_mfma_f32_32x32x16_bf16 v[56:71], v[244:247], v[228:231], v[56:71]
    ds_read_b64_tr_b16 v[244:245], v3 offset:11264
    ds_read_b64_tr_b16 v[246:247], v3 offset:11776
    v_mfma_f32_32x32x16_bf16 v[8:23], v[232:235], v[200:203], v[8:23]
    buffer_load_dwordx4 v[224:227], v251, s[48:51], s64 offen sc1
    buffer_load_dwordx4 v[228:231], v251, s[48:51], s64 offen offset:1024 sc1
    s_add_u32 s64, s64, 2048
    s_cmp_ge_u32 s64, s83
    s_cselect_b32 s64, s82, s64
    s_add_u32 m0, s66, 6144
    s_add_u32 s75, s65, 16384
    buffer_load_dwordx4 v1, s[52:55], s65 offen lds
    s_add_u32 m0, s66, 7104
    s_cmp_ge_u32 s75, s81
    buffer_load_dwordx4 v1, s[52:55], s65 offen offset:64 lds
    s_cselect_b32 s65, s80, s75
    s_waitcnt vmcnt(14) lgkmcnt(4)
    v_mfma_f32_32x32x16_bf16 v[40:55], v[232:235], v[204:207], v[40:55]
    v_mfma_f32_32x32x16_bf16 v[24:39], v[236:239], v[200:203], v[24:39]
    v_mfma_f32_32x32x16_bf16 v[56:71], v[236:239], v[204:207], v[56:71]
    s_waitcnt vmcnt(12)
    ds_read_b64_tr_b16 v[232:233], v3
    ds_read_b64_tr_b16 v[234:235], v3 offset:512
    ds_read_b64_tr_b16 v[236:237], v3 offset:1024
    ds_read_b64_tr_b16 v[238:239], v3 offset:1536
    buffer_load_dwordx4 v[200:203], v251, s[48:51], s64 offen sc1
    buffer_load_dwordx4 v[204:207], v251, s[48:51], s64 offen offset:1024 sc1
    s_add_u32 s64, s64, 2048
    s_cmp_ge_u32 s64, s83
    s_cselect_b32 s64, s82, s64
    s_add_u32 m0, s66, 8192
    s_add_u32 s75, s65, 16384
    buffer_load_dwordx4 v1, s[52:55], s65 offen lds
    s_add_u32 m0, s66, 9152
    s_cmp_ge_u32 s75, s81
    buffer_load_dwordx4 v1, s[52:55], s65 offen offset:64 lds
    s_cselect_b32 s65, s80, s75
    s_waitcnt lgkmcnt(0)
    s_lshl_b32 s71, s89, 2
    s_add_u32 s71, s71, s86
    s_mov_b32 s2, 0
    s_cmp_lt_u32 s71, 7
    s_cbranch_scc0 L_noduty_19
    s_call_b64 s[0:1], L_dutyb
L_noduty_19:
    s_waitcnt vmcnt(14) lgkmcnt(4)
    v_mfma_f32_32x32x16_bf16 v[8:23], v[240:243], v[208:211], v[8:23]
    ds_read_b64_tr_b16 v[160:161], v5 offset:22528
    ds_read_b64_tr_b16 v[162:163], v5 offset:23040
    v_mfma_f32_32x32x16_bf16 v[40:55], v[240:243], v[212:215], v[40:55]
    ds_read_b64_tr_b16 v[164:165], v5 offset:22536
    ds_read_b64_tr_b16 v[166:167], v5 offset:23048
    v_mfma_f32_32x32x16_bf16 v[24:39], v[244:247], v[208:211], v[24:39]
    s_waitcnt vmcnt(12)
    ds_read_b64_tr_b16 v[240:241], v3 offset:2048
    ds_read_b64_tr_b16 v[242:243], v3 offset:2560
    ds_read_b64_tr_b16 v[168:169], v5 offset:24576
    s_add_u32 m0, s66, 10240
    s_add_u32 s75, s65, 16384
    buffer_load_dwordx4 v1, s[52:55], s65 offen lds
    s_add_u32 m0, s66, 11200
    s_cmp_ge_u32 s75, s81
    buffer_load_dwordx4 v1, s[52:55], s65 offen offset:64 lds
    s_cselect_b32 s65, s80, s75
    s_waitcnt vmcnt(10) lgkmcnt(7)
    v_mfma_f32_32x32x16_bf16 v[56:71], v[244:247], v[212:215], v[56:71]
    ds_read_b64_tr_b16 v[244:245], v3 offset:3072
    ds_read_b64_tr_b16 v[246:247], v3 offset:3584
    v_mfma_f32_32x32x16_bf16 v[8:23], v[232:235], v[216:219], v[8:23]
    ds_read_b64_tr_b16 v[170:171], v5 offset:25088
    ds_read_b64_tr_b16 v[172:173], v5 offset:24584
    v_mfma_f32_32x32x16_bf16 v[40:55], v[232:235], v[220:223], v[40:55]
    s_waitcnt vmcnt(12)
    ds_read_b64_tr_b16 v[232:233], v3 offset:4096
    ds_read_b64_tr_b16 v[234:235], v3 offset:4608
    ds_read_b64_tr_b16 v[174:175], v5 offset:25096
    buffer_load_dwordx4 v[208:211], v251, s[48:51], s64 offen sc1
    buffer_load_dwordx4 v[212:215], v251, s[48:51], s64 offen offset:1024 sc1
    s_add_u32 s64, s64, 2048
    s_cmp_ge_u32 s64, s83
    s_cselect_b32 s64, s82, s64
    s_waitcnt vmcnt(10) lgkmcnt(7)
    v_mfma_f32_32x32x16_bf16 v[24:39], v[236:239], v[216:219], v[24:39]
    ds_read_b64_tr_b16 v[176:177], v5 offset:26624
    ds_read_b64_tr_b16 v[178:179], v5 offset:27136
    v_mfma_f32_32x32x16_bf16 v[56:71], v[236:239], v[220:223], v[56:71]
    ds_read_b64_tr_b16 v[236:237], v3 offset:5120
    ds_read_b64_tr_b16 v[238:239], v3 offset:5632
    v_mfma_f32_32x32x16_bf16 v[8:23], v[240:243], v[224:227], v[8:23]
    ds_read_b64_tr_b16 v[180:181], v5 offset:26632
    ds_read_b64_tr_b16 v[182:183], v5 offset:27144
    ds_read_b64_tr_b16 v[184:185], v5 offset:28672
    buffer_load_dwordx4 v[216:219], v251, s[48:51], s64 offen sc1
    buffer_load_dwordx4 v[220:223], v251, s[48:51], s64 offen offset:1024 sc1
    s_add_u32 s64, s64, 2048
    s_cmp_ge_u32 s64, s83
    s_cselect_b32 s64, s82, s64
    s_waitcnt vmcnt(12) lgkmcnt(7)
    v_mfma_f32_32x32x16_bf16 v[40:55], v[240:243], v[228:231], v[40:55]
    ds_read_b64_tr_b16 v[186:187], v5 offset:29184
    ds_read_b64_tr_b16 v[188:189], v5 offset:28680
    v_mfma_f32_32x32x16_bf16 v[24:39], v[244:247], v[224:227], v[24:39]
    ds_read_b64_tr_b16 v[190:191], v5 offset:29192
    ds_read_b64_tr_b16 v[192:193], v5 offset:30720
    v_mfma_f32_32x32x16_bf16 v[56:71], v[244:247], v[228:231], v[56:71]
    s_waitcnt vmcnt(10)
    ds_read_b64_tr_b16 v[240:241], v3 offset:6144
    ds_read_b64_tr_b16 v[242:243], v3 offset:6656
    ds_read_b64_tr_b16 v[244:245], v3 offset:7168
    ds_read_b64_tr_b16 v[246:247], v3 offset:7680
    buffer_load_dwordx4 v[224:227], v251, s[48:51], s64 offen sc1
    buffer_load_dwordx4 v[228:231], v251, s[48:51], s64 offen offset:1024 sc1
    s_add_u32 s64, s64, 2048
    s_cmp_ge_u32 s64, s83
    s_cselect_b32 s64, s82, s64
    s_waitcnt vmcnt(10) lgkmcnt(7)
    v_mfma_f32_32x32x16_bf16 v[8:23], v[232:235], v[200:203], v[8:23]
    ds_read_b64_tr_b16 v[194:195], v5 offset:31232
    ds_read_b64_tr_b16 v[196:197], v5 offset:30728
    v_mfma_f32_32x32x16_bf16 v[40:55], v[232:235], v[204:207], v[40:55]
    ds_read_b64_tr_b16 v[198:199], v5 offset:31240
    s_waitcnt lgkmcnt(8)
    ds_write_b32 v253, v255 offset:288
    v_mfma_f32_32x32x16_bf16 v[24:39], v[236:239], v[200:203], v[24:39]
    s_waitcnt vmcnt(8)
    ds_read_b64_tr_b16 v[232:233], v3 offset:8192
    ds_read_b64_tr_b16 v[234:235], v3 offset:8704
    s_waitcnt vmcnt(4) lgkmcnt(7)
    v_mfma_f32_32x32x16_bf16 v[56:71], v[236:239], v[204:207], v[56:71]
    ds_read_b64_tr_b16 v[236:237], v3 offset:9216
    ds_read_b64_tr_b16 v[238:239], v3 offset:9728
    v_mfma_f32_32x32x16_bf16 v[8:23], v[240:243], v[208:211], v[8:23]
    v_mfma_f32_32x32x16_bf16 v[40:55], v[240:243], v[212:215], v[40:55]
    s_waitcnt vmcnt(6)
    ds_read_b64_tr_b16 v[240:241], v3 offset:10240
    ds_read_b64_tr_b16 v[242:243], v3 offset:10752
    s_waitcnt vmcnt(2) lgkmcnt(4)
    v_mfma_f32_32x32x16_bf16 v[24:39], v[244:247], v[208:211], v[24:39]
    v_mfma_f32_32x32x16_bf16 v[56:71], v[244:247], v[212:215], v[56:71]
    ds_read_b64_tr_b16 v[244:245], v3 offset:11264
    ds_read_b64_tr_b16 v[246:247], v3 offset:11776
    v_mfma_f32_32x32x16_bf16 v[8:23], v[232:235], v[216:219], v[8:23]
    s_waitcnt vmcnt(2) lgkmcnt(4)
    v_mfma_f32_32x32x16_bf16 v[40:55], v[232:235], v[220:223], v[40:55]
    v_mfma_f32_32x32x16_bf16 v[24:39], v[236:239], v[216:219], v[24:39]
    v_mfma_f32_32x32x16_bf16 v[56:71], v[236:239], v[220:223], v[56:71]
    s_waitcnt vmcnt(0) lgkmcnt(0)
    v_mfma_f32_32x32x16_bf16 v[8:23], v[240:243], v[224:227], v[8:23]
    v_mfma_f32_32x32x16_bf16 v[40:55], v[240:243], v[228:231], v[40:55]
    v_mfma_f32_32x32x16_bf16 v[24:39], v[244:247], v[224:227], v[24:39]
    s_waitcnt vmcnt(0) lgkmcnt(0)
    v_mfma_f32_32x32x16_bf16 v[56:71], v[244:247], v[228:231], v[56:71]
    s_waitcnt lgkmcnt(0)
    s_lshl_b32 s71, s89, 2
    s_add_u32 s71, s71, s86
    s_mov_b32 s2, 2
    s_cmp_lt_u32 s71, 4
    s_cbranch_scc0 L_noduty_20
    s_call_b64 s[0:1], L_duty
L_noduty_20:
    s_lshl_b32 s71, s89, 2
    s_add_u32 s71, s71, s86
    s_mov_b32 s2, 0
    s_cmp_lt_u32 s71, 7
    s_cbranch_scc0 L_noduty_21
    s_call_b64 s[0:1], L_duty
L_noduty_21:
    s_lshl_b32 s71, s88, 13
    s_add_u32 s71, s71, 114688
    s_setprio 2
    v_add_u32 v5, s71, v251
    v_add_u32 v7, 114688, v248
    v_add_u32 v6, s66, v251
L_spin_22:
    ds_read_b32 v250, v254 offset:288
    s_waitcnt lgkmcnt(0)
    s_setprio 2
    v_cmp_ne_u32 vcc, 1, v250
    s_setprio 0
    s_cbranch_vccnz L_retry_23
    buffer_load_dwordx4 v[240:243], v249, s[8:11], s22 offen
    buffer_load_dwordx4 v[244:247], v249, s[8:11], s23 offen
    ds_write_b128 v5, v[8:11]
    ds_write_b128 v5, v[12:15] offset:1024
    ds_write_b128 v5, v[16:19] offset:2048
    ds_write_b128 v5, v[20:23] offset:3072
    ds_write_b128 v5, v[24:27] offset:4096
    ds_write_b128 v5, v[28:31] offset:5120
    ds_write_b128 v5, v[32:35] offset:6144
    ds_write_b128 v5, v[36:39] offset:7168
    s_waitcnt lgkmcnt(6)
    ds_write_b128 v6, v[40:43]
    ds_write_b128 v6, v[44:47] offset:1024
    ds_write_b128 v6, v[48:51] offset:2048
    ds_write_b128 v6, v[52:55] offset:3072
    ds_write_b128 v6, v[56:59] offset:4096
    ds_write_b128 v6, v[60:63] offset:5120
    ds_write_b128 v6, v[64:67] offset:6144
    ds_write_b128 v6, v[68:71] offset:7168
    ds_write_b32 v253, v255 offset:96
    s_waitcnt lgkmcnt(0)
    s_add_u32 s80, s16, 32768
    s_add_u32 s81, s17, 32768
    s_add_u32 s82, s18, 32768
    s_add_u32 s83, s19, 32768
    buffer_load_dwordx4 v[24:27], v252, s[12:15], s16 offen sc1
    buffer_load_dwordx4 v[28:31], v252, s[12:15], s17 offen sc1
    buffer_load_dwordx4 v[32:35], v252, s[12:15], s18 offen sc1
    buffer_load_dwordx4 v[36:39], v252, s[12:15], s19 offen sc1
    buffer_load_dwordx4 v[40:43], v252, s[12:15], s16 offen offset:1024 sc1
    buffer_load_dwordx4 v[44:47], v252, s[12:15], s17 offen offset:1024 sc1
    buffer_load_dwordx4 v[48:51], v252, s[12:15], s18 offen offset:1024 sc1
    buffer_load_dwordx4 v[52:55], v252, s[12:15], s19 offen offset:1024 sc1
    buffer_load_dwordx4 v[56:59], v252, s[12:15], s16 offen offset:2048 sc1
    buffer_load_dwordx4 v[60:63], v252, s[12:15], s17 offen offset:2048 sc1
    buffer_load_dwordx4 v[64:67], v252, s[12:15], s18 offen offset:2048 sc1
    buffer_load_dwordx4 v[68:71], v252, s[12:15], s19 offen offset:2048 sc1
L_spin_24:
    ds_read_b32 v232, v254 offset:96
    s_waitcnt lgkmcnt(0)
    s_setprio 2
    v_cmp_ne_u32 vcc, 1, v232
    s_setprio 0
    s_cbranch_vccnz L_retry_25
    ds_read_b128 v[200:203], v7
    ds_read_b128 v[204:207], v7 offset:512
    ds_read_b128 v[208:211], v7 offset:8192
    ds_read_b128 v[212:215], v7 offset:8704
    ds_read_b128 v[216:219], v7 offset:16384
    ds_read_b128 v[220:223], v7 offset:16896
    ds_read_b128 v[224:227], v7 offset:24576
    ds_read_b128 v[228:231], v7 offset:25088
    s_waitcnt vmcnt(12) lgkmcnt(4)
    s_setprio 2
    v_pk_add_f32 v[200:201], v[200:201], v[208:209]
    v_pk_add_f32 v[202:203], v[202:203], v[210:211]
    v_pk_add_f32 v[204:205], v[204:205], v[212:213]
    v_pk_add_f32 v[206:207], v[206:207], v[214:215]
    s_waitcnt lgkmcnt(0)
    v_pk_add_f32 v[216:217], v[216:217], v[224:225]
    v_pk_add_f32 v[218:219], v[218:219], v[226:227]
    v_pk_add_f32 v[220:221], v[220:221], v[228:229]
    v_pk_add_f32 v[222:223], v[222:223], v[230:231]
    v_pk_add_f32 v[200:201], v[200:201], v[216:217]
    v_pk_add_f32 v[202:203], v[202:203], v[218:219]
    v_pk_add_f32 v[204:205], v[204:205], v[220:221]
    v_pk_add_f32 v[206:207], v[206:207], v[222:223]
    v_dot2_f32_bf16 v8, v240, s68, v200
    v_dot2_f32_bf16 v9, v240, s69, v201
    v_dot2_f32_bf16 v10, v241, s68, v202
    v_dot2_f32_bf16 v11, v241, s69, v203
    v_dot2_f32_bf16 v12, v242, s68, v204
    v_dot2_f32_bf16 v13, v242, s69, v205
    v_dot2_f32_bf16 v14, v243, s68, v206
    v_dot2_f32_bf16 v15, v243, s69, v207
    s_setprio 0
L_wd_26:
    ds_read_b32 v232, v254 offset:144
    ds_read_b32 v233, v254 offset:176
    s_waitcnt lgkmcnt(0)
    s_setprio 2
    v_lshl_or_b32 v232, v233, 1, v232
    v_cmp_gt_u32 vcc, 2, v232
    s_setprio 0
    s_nop 0
    s_mov_b32 s76, vcc_lo
    s_and_b64 vcc, vcc, 0
    s_and_b32 s71, s76, 7
    s_cbranch_scc1 L_early
    s_setprio 2
    s_waitcnt vmcnt(8)
    v_max3_u32 v250, v24, v27, v28
    v_max3_u32 v250, v31, v32, v250
    v_max3_u32 v250, v35, v36, v250
    v_max_u32 v250, v39, v250
    v_cmp_eq_u32 vcc, -1, v250
    s_nop 0
    s_cbranch_vccnz L_again_28
L_ok_27:
    v_mfma_f32_16x16x32_bf16 v[8:11], v[72:75], v[24:27], v[8:11]
    v_mfma_f32_16x16x32_bf16 v[12:15], v[76:79], v[24:27], v[12:15]
    buffer_load_dwordx4 v[24:27], v252, s[12:15], s16 offen offset:3072 sc1
    v_mfma_f32_16x16x32_bf16 v[8:11], v[80:83], v[28:31], v[8:11]
    v_mfma_f32_16x16x32_bf16 v[12:15], v[84:87], v[28:31], v[12:15]
    buffer_load_dwordx4 v[28:31], v252, s[12:15], s17 offen offset:3072 sc1
    v_mfma_f32_16x16x32_bf16 v[8:11], v[88:91], v[32:35], v[8:11]
    s_waitcnt vmcnt(6)
    v_max3_u32 v250, v40, v43, v44
    v_max3_u32 v250, v47, v48, v250
    v_mfma_f32_16x16x32_bf16 v[12:15], v[92:95], v[32:35], v[12:15]
    buffer_load_dwordx4 v[32:35], v252, s[12:15], s18 offen offset:3072 sc1
    v_mfma_f32_16x16x32_bf16 v[8:11], v[96:99], v[36:39], v[8:11]
    v_max3_u32 v250, v51, v52, v250
    v_max_u32 v250, v55, v250
    v_cmp_eq_u32 vcc, -1, v250
    v_mfma_f32_16x16x32_bf16 v[12:15], v[100:103], v[36:39], v[12:15]
    buffer_load_dwordx4 v[36:39], v252, s[12:15], s19 offen offset:3072 sc1
    s_cbranch_vccnz L_again_30
L_ok_29:
    v_mfma_f32_16x16x32_bf16 v[8:11], v[104:107], v[40:43], v[8:11]
    v_mfma_f32_16x16x32_bf16 v[12:15], v[108:111], v[40:43], v[12:15]
    buffer_load_dwordx4 v[40:43], v252, s[12:15], s80 offen sc1
    v_mfma_f32_16x16x32_bf16 v[8:11], v[112:115], v[44:47], v[8:11]
    v_mfma_f32_16x16x32_bf16 v[12:15], v[116:119], v[44:47], v[12:15]
    buffer_load_dwordx4 v[44:47], v252, s[12:15], s81 offen sc1
    v_mfma_f32_16x16x32_bf16 v[8:11], v[120:123], v[48:51], v[8:11]
    s_waitcnt vmcnt(6)
    v_max3_u32 v250, v56, v59, v60
    v_max3_u32 v250, v63, v64, v250
    v_mfma_f32_16x16x32_bf16 v[12:15], v[124:127], v[48:51], v[12:15]
    buffer_load_dwordx4 v[48:51], v252, s[12:15], s82 offen sc1
    v_mfma_f32_16x16x32_bf16 v[8:11], v[128:131], v[52:55], v[8:11]
    v_max3_u32 v250, v67, v68, v250
    v_max_u32 v250, v71, v250
    v_cmp_eq_u32 vcc, -1, v250
    v_mfma_f32_16x16x32_bf16 v[12:15], v[132:135], v[52:55], v[12:15]
    buffer_load_dwordx4 v[52:55], v252, s[12:15], s83 offen sc1
    s_cbranch_vccnz L_again_32
L_ok_31:
    v_mfma_f32_16x16x32_bf16 v[8:11], v[136:139], v[56:59], v[8:11]
    v_mfma_f32_16x16x32_bf16 v[12:15], v[140:143], v[56:59], v[12:15]
    buffer_load_dwordx4 v[56:59], v252, s[12:15], s80 offen offset:1024 sc1
    v_mfma_f32_16x16x32_bf16 v[8:11], v[144:147], v[60:63], v[8:11]
    v_mfma_f32_16x16x32_bf16 v[12:15], v[148:151], v[60:63], v[12:15]
    buffer_load_dwordx4 v[60:63], v252, s[12:15], s81 offen offset:1024 sc1
    v_mfma_f32_16x16x32_bf16 v[8:11], v[152:155], v[64:67], v[8:11]
    s_waitcnt vmcnt(6)
    v_max3_u32 v250, v24, v27, v28
    v_max3_u32 v250, v31, v32, v250
    v_mfma_f32_16x16x32_bf16 v[12:15], v[156:159], v[64:67], v[12:15]
    buffer_load_dwordx4 v[64:67], v252, s[12:15], s82 offen offset:1024 sc1
    v_mfma_f32_16x16x32_bf16 v[8:11], v[160:163], v[68:71], v[8:11]
    v_max3_u32 v250, v35, v36, v250
    v_max_u32 v250, v39, v250
    v_cmp_eq_u32 vcc, -1, v250
    v_mfma_f32_16x16x32_bf16 v[12:15], v[164:167], v[68:71], v[12:15]
    buffer_load_dwordx4 v[68:71], v252, s[12:15], s83 offen offset:1024 sc1
    s_cbranch_vccnz L_again_34
L_ok_33:
L_wd_35:
    ds_read_b32 v232, v254 offset:144
    ds_read_b32 v233, v254 offset:176
    s_waitcnt lgkmcnt(0)
    s_setprio 2
    v_lshl_or_b32 v232, v233, 1, v232
    v_cmp_gt_u32 vcc, 2, v232
    s_setprio 0
    s_nop 0
    s_mov_b32 s76, vcc_lo
    s_and_b64 vcc, vcc, 0
    s_setprio 2
    v_mfma_f32_16x16x32_bf16 v[8:11], v[168:171], v[24:27], v[8:11]
    v_mfma_f32_16x16x32_bf16 v[12:15], v[172:175], v[24:27], v[12:15]
    buffer_load_dwordx4 v[24:27], v252, s[12:15], s80 offen offset:2048 sc1
    v_mfma_f32_16x16x32_bf16 v[8:11], v[176:179], v[28:31], v[8:11]
    v_mfma_f32_16x16x32_bf16 v[12:15], v[180:183], v[28:31], v[12:15]
    buffer_load_dwordx4 v[28:31], v252, s[12:15], s81 offen offset:2048 sc1
    v_mfma_f32_16x16x32_bf16 v[8:11], v[184:187], v[32:35], v[8:11]
    v_mfma_f32_16x16x32_bf16 v[12:15], v[188:191], v[32:35], v[12:15]
    buffer_load_dwordx4 v[32:35], v252, s[12:15], s82 offen offset:2048 sc1
    v_mfma_f32_16x16x32_bf16 v[8:11], v[192:195], v[36:39], v[8:11]
    v_mfma_f32_16x16x32_bf16 v[12:15], v[196:199], v[36:39], v[12:15]
    buffer_load_dwordx4 v[36:39], v252, s[12:15], s83 offen offset:2048 sc1
    s_nop 5
    s_setprio 2
    v_cvt_pk_bf16_f32 v240, v8, v9
    v_cvt_pk_bf16_f32 v241, v10, v11
    v_cvt_pk_bf16_f32 v242, v12, v13
    v_cvt_pk_bf16_f32 v243, v14, v15
    buffer_store_dwordx4 v[240:243], v249, s[60:63], s22 offen
    s_bitcmp1_b32 s76, 3
    s_cbranch_scc1 L_mid
    ds_read_b128 v[200:203], v248
    ds_read_b128 v[204:207], v248 offset:512
    ds_read_b128 v[208:211], v248 offset:12288
    ds_read_b128 v[212:215], v248 offset:12800
    ds_read_b128 v[216:219], v248 offset:24576
    ds_read_b128 v[220:223], v248 offset:25088
    ds_read_b128 v[224:227], v248 offset:36864
    ds_read_b128 v[228:231], v248 offset:37376
    s_waitcnt vmcnt(12) lgkmcnt(4)
    s_setprio 2
    v_pk_add_f32 v[200:201], v[200:201], v[208:209]
    v_pk_add_f32 v[202:203], v[202:203], v[210:211]
    v_pk_add_f32 v[204:205], v[204:205], v[212:213]
    v_pk_add_f32 v[206:207], v[206:207], v[214:215]
    s_waitcnt lgkmcnt(0)
    v_pk_add_f32 v[216:217], v[216:217], v[224:225]
    v_pk_add_f32 v[218:219], v[218:219], v[226:227]
    v_pk_add_f32 v[220:221], v[220:221], v[228:229]
    v_pk_add_f32 v[222:223], v[222:223], v[230:231]
    v_pk_add_f32 v[200:201], v[200:201], v[216:217]
    v_pk_add_f32 v[202:203], v[202:203], v[218:219]
    v_pk_add_f32 v[204:205], v[204:205], v[220:221]
    v_pk_add_f32 v[206:207], v[206:207], v[222:223]
    v_dot2_f32_bf16 v16, v244, s68, v200
    v_dot2_f32_bf16 v17, v244, s69, v201
    v_dot2_f32_bf16 v18, v245, s68, v202
    v_dot2_f32_bf16 v19, v245, s69, v203
    v_dot2_f32_bf16 v20, v246, s68, v204
    v_dot2_f32_bf16 v21, v246, s69, v205
    v_dot2_f32_bf16 v22, v247, s68, v206
    v_dot2_f32_bf16 v23, v247, s69, v207
    s_setprio 0
    s_setprio 2
    s_waitcnt vmcnt(9)
    v_max3_u32 v250, v40, v43, v44
    v_max3_u32 v250, v47, v48, v250
    v_max3_u32 v250, v51, v52, v250
    v_max_u32 v250, v55, v250
    v_cmp_eq_u32 vcc, -1, v250
    s_nop 0
    s_cbranch_vccnz L_again_37
L_ok_36:
    v_mfma_f32_16x16x32_bf16 v[16:19], v[72:75], v[40:43], v[16:19]
    v_mfma_f32_16x16x32_bf16 v[20:23], v[76:79], v[40:43], v[20:23]
    buffer_load_dwordx4 v[40:43], v252, s[12:15], s80 offen offset:3072 sc1
    v_mfma_f32_16x16x32_bf16 v[16:19], v[80:83], v[44:47], v[16:19]
    v_mfma_f32_16x16x32_bf16 v[20:23], v[84:87], v[44:47], v[20:23]
    buffer_load_dwordx4 v[44:47], v252, s[12:15], s81 offen offset:3072 sc1
    v_mfma_f32_16x16x32_bf16 v[16:19], v[88:91], v[48:51], v[16:19]
    s_waitcnt vmcnt(7)
    v_max3_u32 v250, v56, v59, v60
    v_max3_u32 v250, v63, v64, v250
    v_mfma_f32_16x16x32_bf16 v[20:23], v[92:95], v[48:51], v[20:23]
    buffer_load_dwordx4 v[48:51], v252, s[12:15], s82 offen offset:3072 sc1
    v_mfma_f32_16x16x32_bf16 v[16:19], v[96:99], v[52:55], v[16:19]
    v_max3_u32 v250, v67, v68, v250
    v_max_u32 v250, v71, v250
    v_cmp_eq_u32 vcc, -1, v250
    v_mfma_f32_16x16x32_bf16 v[20:23], v[100:103], v[52:55], v[20:23]
    buffer_load_dwordx4 v[52:55], v252, s[12:15], s83 offen offset:3072 sc1
    s_cbranch_vccnz L_again_39
L_ok_38:
    v_mfma_f32_16x16x32_bf16 v[16:19], v[104:107], v[56:59], v[16:19]
    v_mfma_f32_16x16x32_bf16 v[20:23], v[108:111], v[56:59], v[20:23]
    v_mfma_f32_16x16x32_bf16 v[16:19], v[112:115], v[60:63], v[16:19]
    v_mfma_f32_16x16x32_bf16 v[20:23], v[116:119], v[60:63], v[20:23]
    v_mfma_f32_16x16x32_bf16 v[16:19], v[120:123], v[64:67], v[16:19]
    s_waitcnt vmcnt(5)
    v_max3_u32 v250, v24, v27, v28
    v_max3_u32 v250, v31, v32, v250
    v_mfma_f32_16x16x32_bf16 v[20:23], v[124:127], v[64:67], v[20:23]
    v_mfma_f32_16x16x32_bf16 v[16:19], v[128:131], v[68:71], v[16:19]
    v_max3_u32 v250, v35, v36, v250
    v_max_u32 v250, v39, v250
    v_cmp_eq_u32 vcc, -1, v250
    v_mfma_f32_16x16x32_bf16 v[20:23], v[132:135], v[68:71], v[20:23]
    s_cbranch_vccnz L_again_41
L_ok_40:
    v_mfma_f32_16x16x32_bf16 v[16:19], v[136:139], v[24:27], v[16:19]
    v_mfma_f32_16x16x32_bf16 v[20:23], v[140:143], v[24:27], v[20:23]
    v_mfma_f32_16x16x32_bf16 v[16:19], v[144:147], v[28:31], v[16:19]
    v_mfma_f32_16x16x32_bf16 v[20:23], v[148:151], v[28:31], v[20:23]
    v_mfma_f32_16x16x32_bf16 v[16:19], v[152:155], v[32:35], v[16:19]
    v_mfma_f32_16x16x32_bf16 v[20:23], v[156:159], v[32:35], v[20:23]
    v_mfma_f32_16x16x32_bf16 v[16:19], v[160:163], v[36:39], v[16:19]
    v_mfma_f32_16x16x32_bf16 v[20:23], v[164:167], v[36:39], v[20:23]
L_last:
    s_branch L_chk_42
L_again_43:
    s_sub_u32 s3, s3, 1
    s_cbranch_scc1 L_exit
    buffer_load_dwordx4 v[40:43], v252, s[12:15], s80 offen offset:3072 sc1
    buffer_load_dwordx4 v[44:47], v252, s[12:15], s81 offen offset:3072 sc1
    buffer_load_dwordx4 v[48:51], v252, s[12:15], s82 offen offset:3072 sc1
    buffer_load_dwordx4 v[52:55], v252, s[12:15], s83 offen offset:3072 sc1
L_chk_42:
    s_waitcnt vmcnt(3)
    s_setprio 2
    v_max_u32 v250, v40, v43
    s_waitcnt vmcnt(2)
    v_max3_u32 v250, v44, v47, v250
    s_waitcnt vmcnt(1)
    v_max3_u32 v250, v48, v51, v250
    s_waitcnt vmcnt(0)
    v_max3_u32 v250, v52, v55, v250
    v_cmp_eq_u32 vcc, -1, v250
    s_setprio 0
    s_cbranch_vccnz L_again_43
    v_mfma_f32_16x16x32_bf16 v[16:19], v[168:171], v[40:43], v[16:19]
    v_mfma_f32_16x16x32_bf16 v[20:23], v[172:175], v[40:43], v[20:23]
    v_mfma_f32_16x16x32_bf16 v[16:19], v[176:179], v[44:47], v[16:19]
    v_mfma_f32_16x16x32_bf16 v[20:23], v[180:183], v[44:47], v[20:23]
    v_mfma_f32_16x16x32_bf16 v[16:19], v[184:187], v[48:51], v[16:19]
    v_mfma_f32_16x16x32_bf16 v[20:23], v[188:191], v[48:51], v[20:23]
    v_mfma_f32_16x16x32_bf16 v[16:19], v[192:195], v[52:55], v[16:19]
    v_mfma_f32_16x16x32_bf16 v[20:23], v[196:199], v[52:55], v[20:23]
    s_nop 5
    s_setprio 2
    v_cvt_pk_bf16_f32 v244, v16, v17
    v_cvt_pk_bf16_f32 v245, v18, v19
    v_cvt_pk_bf16_f32 v246, v20, v21
    v_cvt_pk_bf16_f32 v247, v22, v23
    buffer_store_dwordx4 v[244:247], v249, s[60:63], s23 offen
    s_endpgm
.p2align 6
L_afront:
    s_barrier
    s_mov_b32 s12, s36
    s_mov_b32 s13, s37
    s_mov_b32 s14, 0x1000000
    s_mov_b32 s15, 0x20000
    s_mov_b32 s44, s34
    s_mov_b32 s45, s35
    s_mov_b32 s46, 0x100
    s_mov_b32 s47, 0x20000
    s_and_b32 s71, s2, 1
    s_lshl2_add_u32 s6, s71, s74
    s_and_b32 s88, s4, 3
    s_mov_b32 s3, 0x40000
    s_lshl_b32 s67, s5, 11
    s_add_u32 s67, s67, 0xe00000
    s_mov_b32 s68, 0x00003f80
    s_mov_b32 s69, 0x3f800000
    s_mov_b32 s70, 0x3f803f80
    v_mul_u32_u24 v2, 1040, v5
    v_lshl_add_u32 v2, v4, 4, v2
    v_lshlrev_b32 v4, 2, v4
    s_lshl2_add_u32 s71, s88, 161280
    v_mov_b32 v253, s71
    v_and_b32 v7, 3, v0
    v_lshlrev_b32 v254, 2, v7
    v_add_u32 v254, 161280, v254
    v_mov_b32 v255, 1
    v_lshlrev_b32 v3, 4, v0
    v_mov_b32 v48, -1
    v_mov_b32 v49, -1
    v_mov_b32 v50, -1
    v_mov_b32 v51, -1
    s_lshl_b32 s71, s4, 10
    s_add_u32 s71, s71, 156672
    v_add_u32 v6, s71, v3
    ds_write_b128 v6, v[48:51]
    v_mov_b32 v52, 0
    s_add_u32 s71, s74, 2
    s_and_b32 s71, s71, 3
    s_lshl2_add_u32 s80, s5, s71
    s_lshl_b32 s80, s80, 14
    s_lshl_b32 s72, s71, 8
    s_add_u32 s72, s72, 81920
    v_add_u32 v200, s72, v2
    s_lshl_b32 s72, s71, 6
    s_add_u32 s72, s72, 160768
    v_add_u32 v204, s72, v4
    s_add_u32 s71, s74, 3
    s_and_b32 s71, s71, 3
    s_lshl2_add_u32 s81, s5, s71
    s_lshl_b32 s81, s81, 14
    s_lshl_b32 s72, s71, 8
    s_add_u32 s72, s72, 81920
    v_add_u32 v201, s72, v2
    s_lshl_b32 s72, s71, 6
    s_add_u32 s72, s72, 160768
    v_add_u32 v205, s72, v4
    s_cmp_eq_u32 s4, 0
    s_cbranch_scc1 L_kv
    v_add_u32 v40, 65536, v1
    s_waitcnt vmcnt(3)
    ds_write_b128 v40, v[8:11]
    s_waitcnt vmcnt(2)
    ds_write_b128 v40, v[12:15] offset:256
    s_waitcnt vmcnt(1)
    ds_write_b128 v40, v[16:19] offset:512
    s_waitcnt vmcnt(0)
    ds_write_b128 v40, v[20:23] offset:768
    ds_write_b32 v253, v255 offset:224
    v_mov_b32 v42, 0
    s_mov_b32 exec_lo, 0x00110000
    s_mov_b32 exec_hi, 0x00110000
    v_mov_b32 v42, s70
    s_mov_b64 exec, -1
    v_mov_b32 v43, v42
    v_mov_b64 v[72:73], v[42:43]
    v_mov_b64 v[74:75], v[42:43]
    v_mov_b64 v[76:77], v[42:43]
    v_mov_b64 v[78:79], v[42:43]
    v_mov_b64 v[80:81], v[42:43]
    v_mov_b64 v[82:83], v[42:43]
    v_mov_b64 v[84:85], v[42:43]
    v_mov_b64 v[86:87], v[42:43]
    v_mov_b64 v[88:89], v[42:43]
    v_mov_b64 v[90:91], v[42:43]
    v_mov_b64 v[92:93], v[42:43]
    v_mov_b64 v[94:95], v[42:43]
    v_mov_b64 v[96:97], v[42:43]
    v_mov_b64 v[98:99], v[42:43]
    v_mov_b64 v[100:101], v[42:43]
    v_mov_b64 v[102:103], v[42:43]
    v_mov_b64 v[104:105], v[42:43]
    v_mov_b64 v[106:107], v[42:43]
    v_mov_b64 v[108:109], v[42:43]
    v_mov_b64 v[110:111], v[42:43]
    v_mov_b64 v[112:113], v[42:43]
    v_mov_b64 v[114:115], v[42:43]
    v_mov_b64 v[116:117], v[42:43]
    v_mov_b64 v[118:119], v[42:43]
    v_mov_b64 v[120:121], v[42:43]
    v_mov_b64 v[122:123], v[42:43]
    v_mov_b64 v[124:125], v[42:43]
    v_mov_b64 v[126:127], v[42:43]
    v_mov_b64 v[128:129], v[42:43]
    v_mov_b64 v[130:131], v[42:43]
    v_mov_b64 v[132:133], v[42:43]
    v_mov_b64 v[134:135], v[42:43]
    v_mov_b64 v[136:137], v[42:43]
    v_mov_b64 v[138:139], v[42:43]
    v_mov_b64 v[140:141], v[42:43]
    v_mov_b64 v[142:143], v[42:43]
    v_mov_b64 v[144:145], v[42:43]
    v_mov_b64 v[146:147], v[42:43]
    v_mov_b64 v[148:149], v[42:43]
    v_mov_b64 v[150:151], v[42:43]
    v_mov_b64 v[152:153], v[42:43]
    v_mov_b64 v[154:155], v[42:43]
    v_mov_b64 v[156:157], v[42:43]
    v_mov_b64 v[158:159], v[42:43]
    v_mov_b64 v[160:161], v[42:43]
    v_mov_b64 v[162:163], v[42:43]
    v_mov_b64 v[164:165], v[42:43]
    v_mov_b64 v[166:167], v[42:43]
    v_mov_b64 v[168:169], v[42:43]
    v_mov_b64 v[170:171], v[42:43]
    v_mov_b64 v[172:173], v[42:43]
    v_mov_b64 v[174:175], v[42:43]
    v_mov_b64 v[176:177], v[42:43]
    v_mov_b64 v[178:179], v[42:43]
    v_mov_b64 v[180:181], v[42:43]
    v_mov_b64 v[182:183], v[42:43]
    v_mov_b64 v[184:185], v[42:43]
    v_mov_b64 v[186:187], v[42:43]
    v_mov_b64 v[188:189], v[42:43]
    v_mov_b64 v[190:191], v[42:43]
    v_mov_b64 v[192:193], v[42:43]
    v_mov_b64 v[194:195], v[42:43]
    v_mov_b64 v[196:197], v[42:43]
    v_mov_b64 v[198:199], v[42:43]
    s_lshl_b32 s71, s4, 3
    s_xor_b32 s71, s71, 8
    s_or_b32 s71, s71, s2
    s_cmp_lt_u32 s71, 8
    s_cbranch_scc0 L_notag
    s_memrealtime s[72:73]
    v_mov_b32 v46, 0
    v_mov_b32 v47, 0
    s_waitcnt lgkmcnt(0)
    s_or_b32 s72, s72, 1
    v_mov_b32 v44, s72
    v_mov_b32 v45, s73
    s_mov_b64 exec, 1
    buffer_atomic_cmpswap_x2 v[44:47], v46, s[44:47], 0 offen sc1
    s_mov_b64 exec, -1
L_notag:
    v_mov_b32 v226, v1
    v_lshlrev_b32 v1, 4, v0
    v_and_b32 v4, 15, v0
    v_lshlrev_b32 v4, 4, v4
    v_lshrrev_b32 v6, 5, v0
    v_lshl_add_u32 v4, v6, 8, v4
    v_bfe_u32 v6, v0, 4, 1
    v_lshl_add_u32 v2, v6, 9, v4
    s_lshl_b32 s73, s4, 13
    s_add_u32 s73, s73, 49152
    v_add_u32 v5, s73, v1
    v_and_b32 v6, 31, v0
    s_lshl_b32 s73, s4, 7
    s_add_u32 s73, s73, 156672
    v_lshl_add_u32 v6, v6, 2, s73
    v_mov_b32 v7, v254
    v_add_u32 v252, 148480, v1
    s_lshl_b32 s71, s4, 15
    s_mov_b32 s78, 0x0000ffff
    s_mov_b32 s79, 0x0000ffff
    s_lshl_b32 s73, s4, 11
    s_add_u32 s22, s73, 49152
    s_mul_i32 s73, s4, 384
    s_add_u32 s23, s73, 2048
    s_lshl4_add_u32 s73, s5, s6
    s_lshl2_add_u32 s73, s73, s4
    s_lshl_b32 s73, s73, 10
    s_add_u32 s20, s73, 0x40000
    s_add_u32 s21, s20, 32768
    s_movk_i32 s24, 0x207
    s_mov_b32 s38, 0x07060302
    s_add_u32 s73, s77, 0
    s_and_b32 s73, s73, 15
    s_lshl_b32 s73, s73, 11
    s_add_u32 s48, s73, s71
    s_add_u32 s73, s77, 1
    s_and_b32 s73, s73, 15
    s_lshl_b32 s73, s73, 11
    s_add_u32 s49, s73, s71
    s_add_u32 s73, s77, 2
    s_and_b32 s73, s73, 15
    s_lshl_b32 s73, s73, 11
    s_add_u32 s50, s73, s71
    s_add_u32 s73, s77, 3
    s_and_b32 s73, s73, 15
    s_lshl_b32 s73, s73, 11
    s_add_u32 s51, s73, s71
    s_add_u32 s73, s77, 4
    s_and_b32 s73, s73, 15
    s_lshl_b32 s73, s73, 11
    s_add_u32 s52, s73, s71
    s_add_u32 s73, s77, 5
    s_and_b32 s73, s73, 15
    s_lshl_b32 s73, s73, 11
    s_add_u32 s53, s73, s71
    s_add_u32 s73, s77, 6
    s_and_b32 s73, s73, 15
    s_lshl_b32 s73, s73, 11
    s_add_u32 s54, s73, s71
    s_add_u32 s73, s77, 7
    s_and_b32 s73, s73, 15
    s_lshl_b32 s73, s73, 11
    s_add_u32 s55, s73, s71
    s_add_u32 s73, s77, 8
    s_and_b32 s73, s73, 15
    s_lshl_b32 s73, s73, 11
    s_add_u32 s56, s73, s71
    s_add_u32 s73, s77, 9
    s_and_b32 s73, s73, 15
    s_lshl_b32 s73, s73, 11
    s_add_u32 s57, s73, s71
    s_add_u32 s73, s77, 10
    s_and_b32 s73, s73, 15
    s_lshl_b32 s73, s73, 11
    s_add_u32 s58, s73, s71
    s_add_u32 s73, s77, 11
    s_and_b32 s73, s73, 15
    s_lshl_b32 s73, s73, 11
    s_add_u32 s59, s73, s71
    s_add_u32 s73, s77, 12
    s_and_b32 s73, s73, 15
    s_lshl_b32 s73, s73, 11
    s_add_u32 s60, s73, s71
    s_add_u32 s73, s77, 13
    s_and_b32 s73, s73, 15
    s_lshl_b32 s73, s73, 11
    s_add_u32 s61, s73, s71
    s_add_u32 s73, s77, 14
    s_and_b32 s73, s73, 15
    s_lshl_b32 s73, s73, 11
    s_add_u32 s62, s73, s71
    s_add_u32 s73, s77, 15
    s_and_b32 s73, s73, 15
    s_lshl_b32 s73, s73, 11
    s_add_u32 s63, s73, s71
    s_mov_b32 s40, s18
    s_mov_b32 s41, s19
    s_mov_b32 s42, 0x80000
    s_mov_b32 s43, 0x20000
    v_lshrrev_b32 v224, 3, v0
    v_lshlrev_b32 v224, 10, v224
    v_and_b32 v225, 7, v0
    v_lshl_add_u32 v224, v225, 6, v224
    s_lshl1_add_u32 s71, s77, s4
    s_sub_u32 s71, s71, 2
    s_lshl_b32 s71, s71, 13
    s_and_b32 s72, s6, 4
    s_lshl_b32 s72, s72, 7
    s_add_u32 s71, s71, s72
    s_cmp_eq_u32 s4, 1
    s_cselect_b32 s71, 0x1000000, s71
    buffer_load_dwordx4 v[8:11], v226, s[8:11], s80 offen
    buffer_load_dwordx4 v[12:15], v226, s[8:11], s80 offen offset:256
    buffer_load_dwordx4 v[16:19], v226, s[8:11], s80 offen offset:512
    buffer_load_dwordx4 v[20:23], v226, s[8:11], s80 offen offset:768
    buffer_load_dwordx4 v[24:27], v226, s[8:11], s81 offen
    buffer_load_dwordx4 v[28:31], v226, s[8:11], s81 offen offset:256
    buffer_load_dwordx4 v[32:35], v226, s[8:11], s81 offen offset:512
    buffer_load_dwordx4 v[36:39], v226, s[8:11], s81 offen offset:768
    buffer_load_dword v225, v224, s[40:43], s71 offen
    s_waitcnt vmcnt(5)
    v_dot2_f32_bf16 v56, v8, s70, 0
    v_dot2_f32_bf16 v56, v9, s70, v56
    v_dot2_f32_bf16 v56, v10, s70, v56
    v_dot2_f32_bf16 v56, v11, s70, v56
    v_dot2_f32_bf16 v56, v12, s70, v56
    v_dot2_f32_bf16 v56, v13, s70, v56
    v_dot2_f32_bf16 v56, v14, s70, v56
    v_dot2_f32_bf16 v56, v15, s70, v56
    v_dot2_f32_bf16 v56, v16, s70, v56
    v_dot2_f32_bf16 v56, v17, s70, v56
    v_dot2_f32_bf16 v56, v18, s70, v56
    v_dot2_f32_bf16 v56, v19, s70, v56
    v_dot2_f32_bf16 v56, v20, s70, v56
    v_dot2_f32_bf16 v56, v21, s70, v56
    v_dot2_f32_bf16 v56, v22, s70, v56
    v_dot2_f32_bf16 v56, v23, s70, v56
    s_waitcnt vmcnt(1)
    v_dot2_f32_bf16 v57, v24, s70, 0
    v_dot2_f32_bf16 v57, v25, s70, v57
    v_dot2_f32_bf16 v57, v26, s70, v57
    v_dot2_f32_bf16 v57, v27, s70, v57
    v_dot2_f32_bf16 v57, v28, s70, v57
    v_dot2_f32_bf16 v57, v29, s70, v57
    v_dot2_f32_bf16 v57, v30, s70, v57
    v_dot2_f32_bf16 v57, v31, s70, v57
    v_dot2_f32_bf16 v57, v32, s70, v57
    v_dot2_f32_bf16 v57, v33, s70, v57
    v_dot2_f32_bf16 v57, v34, s70, v57
    v_dot2_f32_bf16 v57, v35, s70, v57
    v_dot2_f32_bf16 v57, v36, s70, v57
    v_dot2_f32_bf16 v57, v37, s70, v57
    v_dot2_f32_bf16 v57, v38, s70, v57
    v_dot2_f32_bf16 v57, v39, s70, v57
    s_nop 1
    v_add_f32_dpp v56, v56, v56 row_ror:8 row_mask:0xf bank_mask:0xf
    v_add_f32_dpp v57, v57, v57 row_ror:8 row_mask:0xf bank_mask:0xf
    s_nop 0
    v_add_f32_dpp v56, v56, v56 row_ror:4 row_mask:0xf bank_mask:0xf
    v_add_f32_dpp v57, v57, v57 row_ror:4 row_mask:0xf bank_mask:0xf
    s_nop 0
    v_add_f32_dpp v56, v56, v56 row_ror:2 row_mask:0xf bank_mask:0xf
    v_add_f32_dpp v57, v57, v57 row_ror:2 row_mask:0xf bank_mask:0xf
    s_nop 0
    v_add_f32_dpp v56, v56, v56 row_ror:1 row_mask:0xf bank_mask:0xf
    v_add_f32_dpp v57, v57, v57 row_ror:1 row_mask:0xf bank_mask:0xf
    v_mul_f32 v56, 0xbb000000, v56
    v_mul_f32 v57, 0xbb000000, v57
    v_dot2_f32_bf16 v60, v8, s68, v56
    v_dot2_f32_bf16 v61, v8, s69, v56
    v_dot2_f32_bf16 v62, v9, s68, v56
    v_dot2_f32_bf16 v63, v9, s69, v56
    v_dot2_f32_bf16 v64, v10, s68, v56
    v_dot2_f32_bf16 v65, v10, s69, v56
    v_dot2_f32_bf16 v66, v11, s68, v56
    v_dot2_f32_bf16 v67, v11, s69, v56
    v_cvt_pk_bf16_f32 v8, v60, v61
    v_cvt_pk_bf16_f32 v9, v62, v63
    v_cvt_pk_bf16_f32 v10, v64, v65
    v_cvt_pk_bf16_f32 v11, v66, v67
    ds_write_b128 v200, v[8:11]
    v_dot2_f32_bf16 v58, v8, v8, 0
    v_dot2_f32_bf16 v58, v9, v9, v58
    v_dot2_f32_bf16 v58, v10, v10, v58
    v_dot2_f32_bf16 v58, v11, v11, v58
    v_dot2_f32_bf16 v60, v12, s68, v56
    v_dot2_f32_bf16 v61, v12, s69, v56
    v_dot2_f32_bf16 v62, v13, s68, v56
    v_dot2_f32_bf16 v63, v13, s69, v56
    v_dot2_f32_bf16 v64, v14, s68, v56
    v_dot2_f32_bf16 v65, v14, s69, v56
    v_dot2_f32_bf16 v66, v15, s68, v56
    v_dot2_f32_bf16 v67, v15, s69, v56
    v_cvt_pk_bf16_f32 v12, v60, v61
    v_cvt_pk_bf16_f32 v13, v62, v63
    v_cvt_pk_bf16_f32 v14, v64, v65
    v_cvt_pk_bf16_f32 v15, v66, v67
    ds_write_b128 v200, v[12:15] offset:16640
    v_dot2_f32_bf16 v58, v12, v12, v58
    v_dot2_f32_bf16 v58, v13, v13, v58
    v_dot2_f32_bf16 v58, v14, v14, v58
    v_dot2_f32_bf16 v58, v15, v15, v58
    v_dot2_f32_bf16 v60, v16, s68, v56
    v_dot2_f32_bf16 v61, v16, s69, v56
    v_dot2_f32_bf16 v62, v17, s68, v56
    v_dot2_f32_bf16 v63, v17, s69, v56
    v_dot2_f32_bf16 v64, v18, s68, v56
    v_dot2_f32_bf16 v65, v18, s69, v56
    v_dot2_f32_bf16 v66, v19, s68, v56
    v_dot2_f32_bf16 v67, v19, s69, v56
    v_cvt_pk_bf16_f32 v16, v60, v61
    v_cvt_pk_bf16_f32 v17, v62, v63
    v_cvt_pk_bf16_f32 v18, v64, v65
    v_cvt_pk_bf16_f32 v19, v66, v67
    ds_write_b128 v200, v[16:19] offset:33280
    v_dot2_f32_bf16 v58, v16, v16, v58
    v_dot2_f32_bf16 v58, v17, v17, v58
    v_dot2_f32_bf16 v58, v18, v18, v58
    v_dot2_f32_bf16 v58, v19, v19, v58
    v_dot2_f32_bf16 v60, v20, s68, v56
    v_dot2_f32_bf16 v61, v20, s69, v56
    v_dot2_f32_bf16 v62, v21, s68, v56
    v_dot2_f32_bf16 v63, v21, s69, v56
    v_dot2_f32_bf16 v64, v22, s68, v56
    v_dot2_f32_bf16 v65, v22, s69, v56
    v_dot2_f32_bf16 v66, v23, s68, v56
    v_dot2_f32_bf16 v67, v23, s69, v56
    v_cvt_pk_bf16_f32 v20, v60, v61
    v_cvt_pk_bf16_f32 v21, v62, v63
    v_cvt_pk_bf16_f32 v22, v64, v65
    v_cvt_pk_bf16_f32 v23, v66, v67
    ds_write_b128 v200, v[20:23] offset:49920
    v_dot2_f32_bf16 v58, v20, v20, v58
    v_dot2_f32_bf16 v58, v21, v21, v58
    v_dot2_f32_bf16 v58, v22, v22, v58
    v_dot2_f32_bf16 v58, v23, v23, v58
    v_dot2_f32_bf16 v60, v24, s68, v57
    v_dot2_f32_bf16 v61, v24, s69, v57
    v_dot2_f32_bf16 v62, v25, s68, v57
    v_dot2_f32_bf16 v63, v25, s69, v57
    v_dot2_f32_bf16 v64, v26, s68, v57
    v_dot2_f32_bf16 v65, v26, s69, v57
    v_dot2_f32_bf16 v66, v27, s68, v57
    v_dot2_f32_bf16 v67, v27, s69, v57
    v_cvt_pk_bf16_f32 v24, v60, v61
    v_cvt_pk_bf16_f32 v25, v62, v63
    v_cvt_pk_bf16_f32 v26, v64, v65
    v_cvt_pk_bf16_f32 v27, v66, v67
    ds_write_b128 v201, v[24:27]
    v_dot2_f32_bf16 v59, v24, v24, 0
    v_dot2_f32_bf16 v59, v25, v25, v59
    v_dot2_f32_bf16 v59, v26, v26, v59
    v_dot2_f32_bf16 v59, v27, v27, v59
    v_dot2_f32_bf16 v60, v28, s68, v57
    v_dot2_f32_bf16 v61, v28, s69, v57
    v_dot2_f32_bf16 v62, v29, s68, v57
    v_dot2_f32_bf16 v63, v29, s69, v57
    v_dot2_f32_bf16 v64, v30, s68, v57
    v_dot2_f32_bf16 v65, v30, s69, v57
    v_dot2_f32_bf16 v66, v31, s68, v57
    v_dot2_f32_bf16 v67, v31, s69, v57
    v_cvt_pk_bf16_f32 v28, v60, v61
    v_cvt_pk_bf16_f32 v29, v62, v63
    v_cvt_pk_bf16_f32 v30, v64, v65
    v_cvt_pk_bf16_f32 v31, v66, v67
    ds_write_b128 v201, v[28:31] offset:16640
    v_dot2_f32_bf16 v59, v28, v28, v59
    v_dot2_f32_bf16 v59, v29, v29, v59
    v_dot2_f32_bf16 v59, v30, v30, v59
    v_dot2_f32_bf16 v59, v31, v31, v59
    v_dot2_f32_bf16 v60, v32, s68, v57
    v_dot2_f32_bf16 v61, v32, s69, v57
    v_dot2_f32_bf16 v62, v33, s68, v57
    v_dot2_f32_bf16 v63, v33, s69, v57
    v_dot2_f32_bf16 v64, v34, s68, v57
    v_dot2_f32_bf16 v65, v34, s69, v57
    v_dot2_f32_bf16 v66, v35, s68, v57
    v_dot2_f32_bf16 v67, v35, s69, v57
    v_cvt_pk_bf16_f32 v32, v60, v61
    v_cvt_pk_bf16_f32 v33, v62, v63
    v_cvt_pk_bf16_f32 v34, v64, v65
    v_cvt_pk_bf16_f32 v35, v66, v67
    ds_write_b128 v201, v[32:35] offset:33280
    v_dot2_f32_bf16 v59, v32, v32, v59
    v_dot2_f32_bf16 v59, v33, v33, v59
    v_dot2_f32_bf16 v59, v34, v34, v59
    v_dot2_f32_bf16 v59, v35, v35, v59
    v_dot2_f32_bf16 v60, v36, s68, v57
    v_dot2_f32_bf16 v61, v36, s69, v57
    v_dot2_f32_bf16 v62, v37, s68, v57
    v_dot2_f32_bf16 v63, v37, s69, v57
    v_dot2_f32_bf16 v64, v38, s68, v57
    v_dot2_f32_bf16 v65, v38, s69, v57
    v_dot2_f32_bf16 v66, v39, s68, v57
    v_dot2_f32_bf16 v67, v39, s69, v57
    v_cvt_pk_bf16_f32 v36, v60, v61
    v_cvt_pk_bf16_f32 v37, v62, v63
    v_cvt_pk_bf16_f32 v38, v64, v65
    v_cvt_pk_bf16_f32 v39, v66, v67
    ds_write_b128 v201, v[36:39] offset:49920
    v_dot2_f32_bf16 v59, v36, v36, v59
    v_dot2_f32_bf16 v59, v37, v37, v59
    v_dot2_f32_bf16 v59, v38, v38, v59
    v_dot2_f32_bf16 v59, v39, v39, v59
    s_nop 1
    v_add_f32_dpp v58, v58, v58 row_ror:8 row_mask:0xf bank_mask:0xf
    v_add_f32_dpp v59, v59, v59 row_ror:8 row_mask:0xf bank_mask:0xf
    s_nop 0
    v_add_f32_dpp v58, v58, v58 row_ror:4 row_mask:0xf bank_mask:0xf
    v_add_f32_dpp v59, v59, v59 row_ror:4 row_mask:0xf bank_mask:0xf
    s_nop 0
    v_add_f32_dpp v58, v58, v58 row_ror:2 row_mask:0xf bank_mask:0xf
    v_add_f32_dpp v59, v59, v59 row_ror:2 row_mask:0xf bank_mask:0xf
    s_nop 0
    v_add_f32_dpp v58, v58, v58 row_ror:1 row_mask:0xf bank_mask:0xf
    v_add_f32_dpp v59, v59, v59 row_ror:1 row_mask:0xf bank_mask:0xf
    v_mov_b32 v56, 0x3727c5ac
    v_fmac_f32 v56, 0x3b000000, v58
    v_mov_b32 v57, 0x3727c5ac
    v_fmac_f32 v57, 0x3b000000, v59
    v_rsq_f32 v58, v56
    v_rsq_f32 v59, v57
    s_waitcnt lgkmcnt(5)
    v_mul_f32 v56, v56, v58
    ds_write_b32 v204, v58
    ds_write_b32 v204, v56 offset:256
    v_mul_f32 v57, v57, v59
    ds_write_b32 v205, v59
    ds_write_b32 v205, v57 offset:256
    ds_write_b32 v253, v255 offset:16
    s_branch L_kvwait
L_kv:
    s_setprio 3
    ds_write_b32 v253, v255 offset:16
    v_lshlrev_b32 v43, 3, v7
    v_bfe_u32 v42, v0, 2, 2
    v_lshl_add_u32 v43, v42, 5, v43
    v_lshrrev_b32 v42, 4, v0
    v_lshl_add_u32 v43, v42, 8, v43
    v_add_u32 v43, 65536, v43
    v_mul_u32_u24 v44, 1040, v42
    v_lshl_add_u32 v44, v5, 4, v44
    s_lshl_b32 s71, s74, 8
    s_add_u32 s71, s71, 81920
    v_add_u32 v44, s71, v44
    s_lshl_b32 s71, s74, 6
    s_add_u32 s71, s71, 160768
    v_lshl_add_u32 v45, v5, 2, s71
    v_lshl_add_u32 v46, v42, 4, s71
    v_mov_b32 v47, 161536
    v_lshrrev_b32 v41, 5, v0
    v_lshlrev_b32 v41, 8, v41
    v_lshl_add_u32 v41, v5, 4, v41
    s_lshr_b32 s72, s74, 1
    s_lshl1_add_u32 s71, s5, s72
    s_lshr_b32 s72, s6, 2
    s_lshl1_add_u32 s71, s71, s72
    s_and_b32 s72, s74, 1
    s_lshl1_add_u32 s71, s71, s72
    s_lshl_b32 s76, s71, 9
    s_lshl_b32 s75, s6, 6
    s_add_u32 s75, s75, s67
    v_add_u32 v40, 65536, v1
    s_waitcnt vmcnt(3)
    ds_write_b128 v40, v[8:11]
    s_waitcnt vmcnt(2)
    ds_write_b128 v40, v[12:15] offset:256
    s_waitcnt vmcnt(1)
    ds_write_b128 v40, v[16:19] offset:512
    s_waitcnt vmcnt(0)
    ds_write_b128 v40, v[20:23] offset:768
    ds_write_b32 v253, v255 offset:224
L_spin_67:
    ds_read_b32 v53, v254 offset:224
    s_waitcnt lgkmcnt(0)
    v_cmp_ne_u32 vcc, 1, v53
    s_nop 0
    s_cbranch_vccnz L_retry_68
    ds_read_b64_tr_b16 v[72:73], v43
    ds_read_b64_tr_b16 v[74:75], v43 offset:128
    ds_read_b64_tr_b16 v[76:77], v43 offset:1024
    ds_read_b64_tr_b16 v[78:79], v43 offset:1152
    ds_read_b64_tr_b16 v[80:81], v43 offset:2048
    ds_read_b64_tr_b16 v[82:83], v43 offset:2176
    ds_read_b64_tr_b16 v[84:85], v43 offset:3072
    ds_read_b64_tr_b16 v[86:87], v43 offset:3200
    s_waitcnt lgkmcnt(6)
    ds_read_b64_tr_b16 v[88:89], v43 offset:4096
    ds_read_b64_tr_b16 v[90:91], v43 offset:4224
    ds_read_b64_tr_b16 v[92:93], v43 offset:5120
    ds_read_b64_tr_b16 v[94:95], v43 offset:5248
    ds_read_b64_tr_b16 v[96:97], v43 offset:6144
    ds_read_b64_tr_b16 v[98:99], v43 offset:6272
    ds_read_b64_tr_b16 v[100:101], v43 offset:7168
    ds_read_b64_tr_b16 v[102:103], v43 offset:7296
    s_waitcnt lgkmcnt(6)
    ds_read_b64_tr_b16 v[104:105], v43 offset:8192
    ds_read_b64_tr_b16 v[106:107], v43 offset:8320
    ds_read_b64_tr_b16 v[108:109], v43 offset:9216
    ds_read_b64_tr_b16 v[110:111], v43 offset:9344
    ds_read_b64_tr_b16 v[112:113], v43 offset:10240
    ds_read_b64_tr_b16 v[114:115], v43 offset:10368
    ds_read_b64_tr_b16 v[116:117], v43 offset:11264
    ds_read_b64_tr_b16 v[118:119], v43 offset:11392
    s_waitcnt lgkmcnt(6)
    ds_read_b64_tr_b16 v[120:121], v43 offset:12288
    ds_read_b64_tr_b16 v[122:123], v43 offset:12416
    ds_read_b64_tr_b16 v[124:125], v43 offset:13312
    ds_read_b64_tr_b16 v[126:127], v43 offset:13440
    ds_read_b64_tr_b16 v[128:129], v43 offset:14336
    ds_read_b64_tr_b16 v[130:131], v43 offset:14464
    ds_read_b64_tr_b16 v[132:133], v43 offset:15360
    ds_read_b64_tr_b16 v[134:135], v43 offset:15488
    s_bitcmp1_b32 s6, 2
    s_cbranch_scc1 L_kv_v
L_lnp_71:
    s_sub_u32 s3, s3, 1
    s_cbranch_scc1 L_exit
    ds_read_b32 v53, v254 offset:208
    s_waitcnt lgkmcnt(0)
    v_cmp_ne_u32 vcc, 1, v53
    s_nop 0
    s_cbranch_vccnz L_lnp_71
    ds_read_b128 v[136:139], v44
    ds_read_b128 v[140:143], v44 offset:4160
    ds_read_b128 v[144:147], v44 offset:8320
    ds_read_b128 v[148:151], v44 offset:12480
    ds_read_b128 v[152:155], v44 offset:16640
    ds_read_b128 v[156:159], v44 offset:20800
    ds_read_b128 v[160:163], v44 offset:24960
    ds_read_b128 v[164:167], v44 offset:29120
    ds_read_b128 v[168:171], v44 offset:33280
    s_waitcnt lgkmcnt(8)
    v_mfma_f32_16x16x32_bf16 v[208:211], v[72:75], v[136:139], 0
    ds_read_b128 v[172:175], v44 offset:37440
    s_waitcnt lgkmcnt(8)
    v_mfma_f32_16x16x32_bf16 v[208:211], v[76:79], v[140:143], v[208:211]
    ds_read_b128 v[176:179], v44 offset:41600
    s_waitcnt lgkmcnt(8)
    v_mfma_f32_16x16x32_bf16 v[208:211], v[80:83], v[144:147], v[208:211]
    ds_read_b128 v[180:183], v44 offset:45760
    s_waitcnt lgkmcnt(8)
    v_mfma_f32_16x16x32_bf16 v[208:211], v[84:87], v[148:151], v[208:211]
    ds_read_b128 v[184:187], v44 offset:49920
    s_waitcnt lgkmcnt(8)
    v_mfma_f32_16x16x32_bf16 v[208:211], v[88:91], v[152:155], v[208:211]
    ds_read_b128 v[188:191], v44 offset:54080
    s_waitcnt lgkmcnt(8)
    v_mfma_f32_16x16x32_bf16 v[208:211], v[92:95], v[156:159], v[208:211]
    ds_read_b128 v[192:195], v44 offset:58240
    s_waitcnt lgkmcnt(8)
    v_mfma_f32_16x16x32_bf16 v[208:211], v[96:99], v[160:163], v[208:211]
    ds_read_b128 v[196:199], v44 offset:62400
    s_waitcnt lgkmcnt(8)
    v_mfma_f32_16x16x32_bf16 v[208:211], v[100:103], v[164:167], v[208:211]
    s_waitcnt lgkmcnt(7)
    v_mfma_f32_16x16x32_bf16 v[208:211], v[104:107], v[168:171], v[208:211]
    s_waitcnt lgkmcnt(6)
    v_mfma_f32_16x16x32_bf16 v[208:211], v[108:111], v[172:175], v[208:211]
    s_waitcnt lgkmcnt(5)
    v_mfma_f32_16x16x32_bf16 v[208:211], v[112:115], v[176:179], v[208:211]
    s_waitcnt lgkmcnt(4)
    v_mfma_f32_16x16x32_bf16 v[208:211], v[116:119], v[180:183], v[208:211]
    ds_read_b32 v53, v254 offset:128
    ds_read_b32 v68, v45
    s_waitcnt lgkmcnt(5)
    v_mfma_f32_16x16x32_bf16 v[208:211], v[120:123], v[184:187], v[208:211]
    s_waitcnt lgkmcnt(4)
    v_mfma_f32_16x16x32_bf16 v[208:211], v[124:127], v[188:191], v[208:211]
    s_waitcnt lgkmcnt(3)
    v_mfma_f32_16x16x32_bf16 v[208:211], v[128:131], v[192:195], v[208:211]
    s_waitcnt lgkmcnt(2)
    v_mfma_f32_16x16x32_bf16 v[208:211], v[132:135], v[196:199], v[208:211]
L_rsok_70:
    s_waitcnt lgkmcnt(0)
    v_cmp_ne_u32 vcc, 1, v53
    s_nop 4
    s_cbranch_vccnz L_rs_69
    v_mul_f32 v208, v208, v68
    v_mul_f32 v209, v209, v68
    v_mul_f32 v210, v210, v68
    v_mul_f32 v211, v211, v68
    v_cvt_pk_bf16_f32 v48, v208, v209
    v_cvt_pk_bf16_f32 v49, v210, v211
    s_nop 1
    v_permlane32_swap_b32 v48, v50
    v_permlane32_swap_b32 v49, v51
    s_mov_b32 exec_lo, -1
    s_mov_b32 exec_hi, 0
    buffer_store_dwordx4 v[48:51], v3, s[12:15], s76 offen sc1
    s_mov_b64 exec, -1
    s_branch L_kv_done
L_kv_v:
L_lnp_74:
    s_sub_u32 s3, s3, 1
    s_cbranch_scc1 L_exit
    ds_read_b32 v53, v254 offset:208
    s_waitcnt lgkmcnt(0)
    v_cmp_ne_u32 vcc, 1, v53
    s_nop 0
    s_cbranch_vccnz L_lnp_74
    ds_read_b128 v[136:139], v44
    ds_read_b128 v[140:143], v44 offset:4160
    ds_read_b128 v[144:147], v44 offset:8320
    ds_read_b128 v[148:151], v44 offset:12480
    ds_read_b128 v[152:155], v44 offset:16640
    ds_read_b128 v[156:159], v44 offset:20800
    ds_read_b128 v[160:163], v44 offset:24960
    ds_read_b128 v[164:167], v44 offset:29120
    ds_read_b128 v[168:171], v44 offset:33280
    s_waitcnt lgkmcnt(8)
    v_mfma_f32_16x16x32_bf16 v[208:211], v[136:139], v[72:75], 0
    ds_read_b128 v[172:175], v44 offset:37440
    s_waitcnt lgkmcnt(8)
    v_mfma_f32_16x16x32_bf16 v[208:211], v[140:143], v[76:79], v[208:211]
    ds_read_b128 v[176:179], v44 offset:41600
    s_waitcnt lgkmcnt(8)
    v_mfma_f32_16x16x32_bf16 v[208:211], v[144:147], v[80:83], v[208:211]
    ds_read_b128 v[180:183], v44 offset:45760
    s_waitcnt lgkmcnt(8)
    v_mfma_f32_16x16x32_bf16 v[208:211], v[148:151], v[84:87], v[208:211]
    ds_read_b128 v[184:187], v44 offset:49920
    s_waitcnt lgkmcnt(8)
    v_mfma_f32_16x16x32_bf16 v[208:211], v[152:155], v[88:91], v[208:211]
    ds_read_b128 v[188:191], v44 offset:54080
    s_waitcnt lgkmcnt(8)
    v_mfma_f32_16x16x32_bf16 v[208:211], v[156:159], v[92:95], v[208:211]
    ds_read_b128 v[192:195], v44 offset:58240
    s_waitcnt lgkmcnt(8)
    v_mfma_f32_16x16x32_bf16 v[208:211], v[160:163], v[96:99], v[208:211]
    ds_read_b128 v[196:199], v44 offset:62400
    s_waitcnt lgkmcnt(8)
    v_mfma_f32_16x16x32_bf16 v[208:211], v[164:167], v[100:103], v[208:211]
    s_waitcnt lgkmcnt(7)
    v_mfma_f32_16x16x32_bf16 v[208:211], v[168:171], v[104:107], v[208:211]
    s_waitcnt lgkmcnt(6)
    v_mfma_f32_16x16x32_bf16 v[208:211], v[172:175], v[108:111], v[208:211]
    s_waitcnt lgkmcnt(5)
    v_mfma_f32_16x16x32_bf16 v[208:211], v[176:179], v[112:115], v[208:211]
    s_waitcnt lgkmcnt(4)
    v_mfma_f32_16x16x32_bf16 v[208:211], v[180:183], v[116:119], v[208:211]
    ds_read_b32 v53, v254 offset:128
    ds_read_b128 v[68:71], v46
    s_waitcnt lgkmcnt(5)
    v_mfma_f32_16x16x32_bf16 v[208:211], v[184:187], v[120:123], v[208:211]
    s_waitcnt lgkmcnt(4)
    v_mfma_f32_16x16x32_bf16 v[208:211], v[188:191], v[124:127], v[208:211]
    s_waitcnt lgkmcnt(3)
    v_mfma_f32_16x16x32_bf16 v[208:211], v[192:195], v[128:131], v[208:211]
    s_waitcnt lgkmcnt(2)
    v_mfma_f32_16x16x32_bf16 v[208:211], v[196:199], v[132:135], v[208:211]
L_rsok_73:
    s_waitcnt lgkmcnt(0)
    v_cmp_ne_u32 vcc, 1, v53
    s_nop 4
    s_cbranch_vccnz L_rs_72
    v_mul_f32 v208, v208, v68
    v_mul_f32 v209, v209, v69
    v_mul_f32 v210, v210, v70
    v_mul_f32 v211, v211, v71
    v_cvt_pk_bf16_f32 v48, v208, v209
    v_cvt_pk_bf16_f32 v49, v210, v211
    s_nop 1
    v_permlane16_swap_b32 v48, v50
    v_permlane16_swap_b32 v49, v51
    s_mov_b32 exec_lo, 0xffff
    s_mov_b32 exec_hi, 0xffff
    buffer_store_dwordx4 v[48:51], v41, s[12:15], s76 offen sc1
    s_mov_b64 exec, -1
L_kv_done:
    buffer_load_dwordx2 v[54:55], v52, s[44:47], 0 offen sc1
    v_mov_b32 v42, 0
    s_mov_b32 exec_lo, 0x00110000
    s_mov_b32 exec_hi, 0x00110000
    v_mov_b32 v42, s70
    s_mov_b64 exec, -1
    v_mov_b32 v43, v42
    v_mov_b64 v[72:73], v[42:43]
    v_mov_b64 v[74:75], v[42:43]
    v_mov_b64 v[76:77], v[42:43]
    v_mov_b64 v[78:79], v[42:43]
    v_mov_b64 v[80:81], v[42:43]
    v_mov_b64 v[82:83], v[42:43]
    v_mov_b64 v[84:85], v[42:43]
    v_mov_b64 v[86:87], v[42:43]
    v_mov_b64 v[88:89], v[42:43]
    v_mov_b64 v[90:91], v[42:43]
    v_mov_b64 v[92:93], v[42:43]
    v_mov_b64 v[94:95], v[42:43]
    v_mov_b64 v[96:97], v[42:43]
    v_mov_b64 v[98:99], v[42:43]
    v_mov_b64 v[100:101], v[42:43]
    v_mov_b64 v[102:103], v[42:43]
    v_mov_b64 v[104:105], v[42:43]
    v_mov_b64 v[106:107], v[42:43]
    v_mov_b64 v[108:109], v[42:43]
    v_mov_b64 v[110:111], v[42:43]
    v_mov_b64 v[112:113], v[42:43]
    v_mov_b64 v[114:115], v[42:43]
    v_mov_b64 v[116:117], v[42:43]
    v_mov_b64 v[118:119], v[42:43]
    v_mov_b64 v[120:121], v[42:43]
    v_mov_b64 v[122:123], v[42:43]
    v_mov_b64 v[124:125], v[42:43]
    v_mov_b64 v[126:127], v[42:43]
    v_mov_b64 v[128:129], v[42:43]
    v_mov_b64 v[130:131], v[42:43]
    v_mov_b64 v[132:133], v[42:43]
    v_mov_b64 v[134:135], v[42:43]
    v_mov_b64 v[136:137], v[42:43]
    v_mov_b64 v[138:139], v[42:43]
    v_mov_b64 v[140:141], v[42:43]
    v_mov_b64 v[142:143], v[42:43]
    v_mov_b64 v[144:145], v[42:43]
    v_mov_b64 v[146:147], v[42:43]
    v_mov_b64 v[148:149], v[42:43]
    v_mov_b64 v[150:151], v[42:43]
    v_mov_b64 v[152:153], v[42:43]
    v_mov_b64 v[154:155], v[42:43]
    v_mov_b64 v[156:157], v[42:43]
    v_mov_b64 v[158:159], v[42:43]
    v_mov_b64 v[160:161], v[42:43]
    v_mov_b64 v[162:163], v[42:43]
    v_mov_b64 v[164:165], v[42:43]
    v_mov_b64 v[166:167], v[42:43]
    v_mov_b64 v[168:169], v[42:43]
    v_mov_b64 v[170:171], v[42:43]
    v_mov_b64 v[172:173], v[42:43]
    v_mov_b64 v[174:175], v[42:43]
    v_mov_b64 v[176:177], v[42:43]
    v_mov_b64 v[178:179], v[42:43]
    v_mov_b64 v[180:181], v[42:43]
    v_mov_b64 v[182:183], v[42:43]
    v_mov_b64 v[184:185], v[42:43]
    v_mov_b64 v[186:187], v[42:43]
    v_mov_b64 v[188:189], v[42:43]
    v_mov_b64 v[190:191], v[42:43]
    v_mov_b64 v[192:193], v[42:43]
    v_mov_b64 v[194:195], v[42:43]
    v_mov_b64 v[196:197], v[42:43]
    v_mov_b64 v[198:199], v[42:43]
    v_lshlrev_b32 v1, 4, v0
    v_and_b32 v4, 15, v0
    v_lshlrev_b32 v4, 4, v4
    v_lshrrev_b32 v6, 5, v0
    v_lshl_add_u32 v4, v6, 8, v4
    v_bfe_u32 v6, v0, 4, 1
    v_lshl_add_u32 v2, v6, 9, v4
    s_lshl_b32 s73, s4, 13
    s_add_u32 s73, s73, 49152
    v_add_u32 v5, s73, v1
    v_and_b32 v6, 31, v0
    s_lshl_b32 s73, s4, 7
    s_add_u32 s73, s73, 156672
    v_lshl_add_u32 v6, v6, 2, s73
    v_mov_b32 v7, v254
    v_add_u32 v252, 148480, v1
    s_lshl_b32 s71, s4, 15
    s_mov_b32 s78, 0x0000ffff
    s_mov_b32 s79, 0x0000ffff
    s_lshl_b32 s73, s4, 11
    s_add_u32 s22, s73, 49152
    s_mul_i32 s73, s4, 384
    s_add_u32 s23, s73, 2048
    s_lshl4_add_u32 s73, s5, s6
    s_lshl2_add_u32 s73, s73, s4
    s_lshl_b32 s73, s73, 10
    s_add_u32 s20, s73, 0x40000
    s_add_u32 s21, s20, 32768
    s_movk_i32 s24, 0x207
    s_mov_b32 s38, 0x07060302
    s_add_u32 s73, s77, 0
    s_and_b32 s73, s73, 15
    s_lshl_b32 s73, s73, 11
    s_add_u32 s48, s73, s71
    s_add_u32 s73, s77, 1
    s_and_b32 s73, s73, 15
    s_lshl_b32 s73, s73, 11
    s_add_u32 s49, s73, s71
    s_add_u32 s73, s77, 2
    s_and_b32 s73, s73, 15
    s_lshl_b32 s73, s73, 11
    s_add_u32 s50, s73, s71
    s_add_u32 s73, s77, 3
    s_and_b32 s73, s73, 15
    s_lshl_b32 s73, s73, 11
    s_add_u32 s51, s73, s71
    s_add_u32 s73, s77, 4
    s_and_b32 s73, s73, 15
    s_lshl_b32 s73, s73, 11
    s_add_u32 s52, s73, s71
    s_add_u32 s73, s77, 5
    s_and_b32 s73, s73, 15
    s_lshl_b32 s73, s73, 11
    s_add_u32 s53, s73, s71
    s_add_u32 s73, s77, 6
    s_and_b32 s73, s73, 15
    s_lshl_b32 s73, s73, 11
    s_add_u32 s54, s73, s71
    s_add_u32 s73, s77, 7
    s_and_b32 s73, s73, 15
    s_lshl_b32 s73, s73, 11
    s_add_u32 s55, s73, s71
    s_add_u32 s73, s77, 8
    s_and_b32 s73, s73, 15
    s_lshl_b32 s73, s73, 11
    s_add_u32 s56, s73, s71
    s_add_u32 s73, s77, 9
    s_and_b32 s73, s73, 15
    s_lshl_b32 s73, s73, 11
    s_add_u32 s57, s73, s71
    s_add_u32 s73, s77, 10
    s_and_b32 s73, s73, 15
    s_lshl_b32 s73, s73, 11
    s_add_u32 s58, s73, s71
    s_add_u32 s73, s77, 11
    s_and_b32 s73, s73, 15
    s_lshl_b32 s73, s73, 11
    s_add_u32 s59, s73, s71
    s_add_u32 s73, s77, 12
    s_and_b32 s73, s73, 15
    s_lshl_b32 s73, s73, 11
    s_add_u32 s60, s73, s71
    s_add_u32 s73, s77, 13
    s_and_b32 s73, s73, 15
    s_lshl_b32 s73, s73, 11
    s_add_u32 s61, s73, s71
    s_add_u32 s73, s77, 14
    s_and_b32 s73, s73, 15
    s_lshl_b32 s73, s73, 11
    s_add_u32 s62, s73, s71
    s_add_u32 s73, s77, 15
    s_and_b32 s73, s73, 15
    s_lshl_b32 s73, s73, 11
    s_add_u32 s63, s73, s71
L_tagchk:
    s_waitcnt vmcnt(0)
    v_cmp_eq_u32 vcc, 0, v54
    s_nop 0
    s_cbranch_vccnz L_tag
    s_mov_b64 exec, 1
    buffer_store_dwordx2 v[54:55], v52, s[12:15], s75 offen sc1
    s_mov_b64 exec, -1
    ds_write_b64 v47, v[54:55]
    ds_write_b32 v254, v255 offset:320
    s_setprio 0
    v_readfirstlane_b32 s26, v54
    v_readfirstlane_b32 s27, v55
    v_lshrrev_b32 v3, 3, v0
    v_lshlrev_b32 v3, 11, v3
    v_and_b32 v8, 7, v0
    v_lshl_add_u32 v3, v8, 6, v3
    s_mov_b32 s80, 0xe00000
    s_mov_b32 s81, 0xe04000
    s_mov_b32 s82, 0xe08000
    s_mov_b32 s83, 0xe0c000
L_spin_75:
    ds_read_b32 v8, v7 offset:336
    s_waitcnt lgkmcnt(0)
    v_cmp_ne_u32 vcc, 1, v8
    s_nop 0
    s_cbranch_vccnz L_retry_76
L_kvpoll:
    buffer_load_dwordx2 v[8:9], v3, s[12:15], s80 offen sc1
    buffer_load_dwordx2 v[10:11], v3, s[12:15], s81 offen sc1
    buffer_load_dwordx2 v[12:13], v3, s[12:15], s82 offen sc1
    buffer_load_dwordx2 v[14:15], v3, s[12:15], s83 offen sc1
    s_waitcnt vmcnt(3)
    v_cmp_ne_u64 vcc, s[26:27], v[8:9]
    s_waitcnt vmcnt(2)
    v_cmp_ne_u64 s[84:85], s[26:27], v[10:11]
    s_waitcnt vmcnt(1)
    v_cmp_ne_u64 s[86:87], s[26:27], v[12:13]
    s_waitcnt vmcnt(0)
    v_cmp_ne_u64 s[88:89], s[26:27], v[14:15]
    s_or_b64 vcc, vcc, s[84:85]
    s_or_b64 vcc, vcc, s[86:87]
    s_or_b64 vcc, vcc, s[88:89]
    s_cbranch_vccnz L_retry_77
    s_mov_b64 exec, -1
    ds_write_b32 v7, v255 offset:240
    s_branch L_kvok
L_kvwait:
    s_sub_u32 s3, s3, 1
    s_cbranch_scc1 L_exit
    ds_read_b32 v8, v7 offset:240
    s_waitcnt lgkmcnt(0)
    v_cmp_ne_u32 vcc, 1, v8
    s_nop 0
    s_cbranch_vccnz L_kvwait
L_kvok:
    buffer_load_dwordx4 v[8:11], v2, s[12:15], s48 offen sc1
    s_mov_b64 exec, s[78:79]
    buffer_load_dwordx4 v[72:75], v4, s[12:15], s48 offen offset:1024 sc1
    buffer_load_dwordx4 v[76:79], v4, s[12:15], s48 offen offset:1536 sc1
    s_mov_b64 exec, -1
    buffer_load_dwordx4 v[12:15], v2, s[12:15], s49 offen sc1
    s_mov_b64 exec, s[78:79]
    buffer_load_dwordx4 v[80:83], v4, s[12:15], s49 offen offset:1024 sc1
    buffer_load_dwordx4 v[84:87], v4, s[12:15], s49 offen offset:1536 sc1
    s_mov_b64 exec, -1
    buffer_load_dwordx4 v[16:19], v2, s[12:15], s50 offen sc1
    s_mov_b64 exec, s[78:79]
    buffer_load_dwordx4 v[88:91], v4, s[12:15], s50 offen offset:1024 sc1
    buffer_load_dwordx4 v[92:95], v4, s[12:15], s50 offen offset:1536 sc1
    s_mov_b64 exec, -1
    buffer_load_dwordx4 v[20:23], v2, s[12:15], s51 offen sc1
    s_mov_b64 exec, s[78:79]
    buffer_load_dwordx4 v[96:99], v4, s[12:15], s51 offen offset:1024 sc1
    buffer_load_dwordx4 v[100:103], v4, s[12:15], s51 offen offset:1536 sc1
    s_mov_b64 exec, -1
    buffer_load_dwordx4 v[24:27], v2, s[12:15], s52 offen sc1
    s_mov_b64 exec, s[78:79]
    buffer_load_dwordx4 v[104:107], v4, s[12:15], s52 offen offset:1024 sc1
    buffer_load_dwordx4 v[108:111], v4, s[12:15], s52 offen offset:1536 sc1
    s_mov_b64 exec, -1
    buffer_load_dwordx4 v[28:31], v2, s[12:15], s53 offen sc1
    s_mov_b64 exec, s[78:79]
    buffer_load_dwordx4 v[112:115], v4, s[12:15], s53 offen offset:1024 sc1
    buffer_load_dwordx4 v[116:119], v4, s[12:15], s53 offen offset:1536 sc1
    s_mov_b64 exec, -1
    v_mov_b32 v254, 161284
L_spin_78:
    ds_read_b32 v3, v254 offset:48
    s_waitcnt lgkmcnt(0)
    v_cmp_ne_u32 vcc, 1, v3
    s_nop 0
    s_cbranch_vccnz L_retry_79
    ds_read_b128 v[248:251], v252
    s_setprio 1
    s_waitcnt vmcnt(17) lgkmcnt(0)
    v_mfma_f32_32x32x16_bf16 v[200:215], v[8:11], v[248:251], 0
    v_mov_b32 v254, 0xdddddddd
    v_mov_b64 v[232:233], 0
    v_mov_b64 v[234:235], 0
    v_mov_b64 v[236:237], 0
    v_mov_b64 v[238:239], 0
    v_mov_b64 v[240:241], 0
    v_mov_b64 v[242:243], 0
    v_mov_b64 v[244:245], 0
    v_mov_b64 v[246:247], 0
    s_nop 2
    buffer_load_dwordx4 v[32:35], v2, s[12:15], s54 offen sc1
    v_exp_f32 v200, v200
    v_exp_f32 v201, v201
    v_exp_f32 v202, v202
    s_waitcnt vmcnt(15)
    v_exp_f32 v203, v203
    v_exp_f32 v204, v204
    v_exp_f32 v205, v205
    v_mfma_f32_32x32x16_bf16 v[216:231], v[12:15], v[248:251], 0
    s_mov_b64 exec, s[78:79]
    buffer_load_dwordx4 v[120:123], v4, s[12:15], s54 offen offset:1024 sc1
    buffer_load_dwordx4 v[124:127], v4, s[12:15], s54 offen offset:1536 sc1
    s_mov_b64 exec, -1
    v_exp_f32 v206, v206
    v_exp_f32 v207, v207
    v_exp_f32 v208, v208
    v_exp_f32 v209, v209
    v_exp_f32 v210, v210
    v_exp_f32 v211, v211
    v_exp_f32 v212, v212
    v_exp_f32 v213, v213
    v_exp_f32 v214, v214
    v_exp_f32 v215, v215
    v_smfmac_f32_32x32x32_bf16 v[232:247], v[72:75], v[200:207], v254
    buffer_load_dwordx4 v[36:39], v2, s[12:15], s55 offen sc1
    v_exp_f32 v216, v216
    v_exp_f32 v217, v217
    v_exp_f32 v218, v218
    v_smfmac_f32_32x32x32_bf16 v[232:247], v[76:79], v[208:215], v254
    s_waitcnt vmcnt(15)
    v_exp_f32 v219, v219
    v_exp_f32 v220, v220
    v_exp_f32 v221, v221
    v_mfma_f32_32x32x16_bf16 v[200:215], v[16:19], v[248:251], 0
    s_mov_b64 exec, s[78:79]
    buffer_load_dwordx4 v[128:131], v4, s[12:15], s55 offen offset:1024 sc1
    buffer_load_dwordx4 v[132:135], v4, s[12:15], s55 offen offset:1536 sc1
    s_mov_b64 exec, -1
    v_exp_f32 v222, v222
    v_exp_f32 v223, v223
    v_exp_f32 v224, v224
    v_exp_f32 v225, v225
    v_exp_f32 v226, v226
    v_exp_f32 v227, v227
    v_exp_f32 v228, v228
    v_exp_f32 v229, v229
    v_exp_f32 v230, v230
    v_exp_f32 v231, v231
    v_smfmac_f32_32x32x32_bf16 v[232:247], v[80:83], v[216:223], v254
    buffer_load_dwordx4 v[40:43], v2, s[12:15], s56 offen sc1
    v_exp_f32 v200, v200
    v_exp_f32 v201, v201
    v_exp_f32 v202, v202
    v_smfmac_f32_32x32x32_bf16 v[232:247], v[84:87], v[224:231], v254
    s_waitcnt vmcnt(15)
    v_exp_f32 v203, v203
    v_exp_f32 v204, v204
    v_exp_f32 v205, v205
    v_mfma_f32_32x32x16_bf16 v[216:231], v[20:23], v[248:251], 0
    s_mov_b64 exec, s[78:79]
    buffer_load_dwordx4 v[136:139], v4, s[12:15], s56 offen offset:1024 sc1
    buffer_load_dwordx4 v[140:143], v4, s[12:15], s56 offen offset:1536 sc1
    s_mov_b64 exec, -1
    v_exp_f32 v206, v206
    v_exp_f32 v207, v207
    v_exp_f32 v208, v208
    v_exp_f32 v209, v209
    v_exp_f32 v210, v210
    v_exp_f32 v211, v211
    v_exp_f32 v212, v212
    v_exp_f32 v213, v213
    v_exp_f32 v214, v214
    v_exp_f32 v215, v215
    v_smfmac_f32_32x32x32_bf16 v[232:247], v[88:91], v[200:207], v254
    buffer_load_dwordx4 v[44:47], v2, s[12:15], s57 offen sc1
    v_exp_f32 v216, v216
    v_exp_f32 v217, v217
    v_exp_f32 v218, v218
    v_smfmac_f32_32x32x32_bf16 v[232:247], v[92:95], v[208:215], v254
    s_waitcnt vmcnt(15)
    v_exp_f32 v219, v219
    v_exp_f32 v220, v220
    v_exp_f32 v221, v221
    v_mfma_f32_32x32x16_bf16 v[200:215], v[24:27], v[248:251], 0
    s_mov_b64 exec, s[78:79]
    buffer_load_dwordx4 v[144:147], v4, s[12:15], s57 offen offset:1024 sc1
    buffer_load_dwordx4 v[148:151], v4, s[12:15], s57 offen offset:1536 sc1
    s_mov_b64 exec, -1
    v_exp_f32 v222, v222
    v_exp_f32 v223, v223
    v_exp_f32 v224, v224
    v_exp_f32 v225, v225
    v_exp_f32 v226, v226
    v_exp_f32 v227, v227
    v_exp_f32 v228, v228
    v_exp_f32 v229, v229
    v_exp_f32 v230, v230
    v_exp_f32 v231, v231
    v_smfmac_f32_32x32x32_bf16 v[232:247], v[96:99], v[216:223], v254
    buffer_load_dwordx4 v[48:51], v2, s[12:15], s58 offen sc1
    v_exp_f32 v200, v200
    v_exp_f32 v201, v201
    v_exp_f32 v202, v202
    v_smfmac_f32_32x32x32_bf16 v[232:247], v[100:103], v[224:231], v254
    s_waitcnt vmcnt(15)
    v_exp_f32 v203, v203
    v_exp_f32 v204, v204
    v_exp_f32 v205, v205
    v_mfma_f32_32x32x16_bf16 v[216:231], v[28:31], v[248:251], 0
    s_mov_b64 exec, s[78:79]
    buffer_load_dwordx4 v[152:155], v4, s[12:15], s58 offen offset:1024 sc1
    buffer_load_dwordx4 v[156:159], v4, s[12:15], s58 offen offset:1536 sc1
    s_mov_b64 exec, -1
    v_exp_f32 v206, v206
    v_exp_f32 v207, v207
    v_exp_f32 v208, v208
    v_exp_f32 v209, v209
    v_exp_f32 v210, v210
    v_exp_f32 v211, v211
    v_exp_f32 v212, v212
    v_exp_f32 v213, v213
    v_exp_f32 v214, v214
    v_exp_f32 v215, v215
    v_smfmac_f32_32x32x32_bf16 v[232:247], v[104:107], v[200:207], v254
    buffer_load_dwordx4 v[52:55], v2, s[12:15], s59 offen sc1
    v_exp_f32 v216, v216
    v_exp_f32 v217, v217
    v_exp_f32 v218, v218
    v_smfmac_f32_32x32x32_bf16 v[232:247], v[108:111], v[208:215], v254
    s_waitcnt vmcnt(15)
    v_exp_f32 v219, v219
    v_exp_f32 v220, v220
    v_exp_f32 v221, v221
    v_mfma_f32_32x32x16_bf16 v[200:215], v[32:35], v[248:251], 0
    s_mov_b64 exec, s[78:79]
    buffer_load_dwordx4 v[160:163], v4, s[12:15], s59 offen offset:1024 sc1
    buffer_load_dwordx4 v[164:167], v4, s[12:15], s59 offen offset:1536 sc1
    s_mov_b64 exec, -1
    v_exp_f32 v222, v222
    v_exp_f32 v223, v223
    v_exp_f32 v224, v224
    v_exp_f32 v225, v225
    v_exp_f32 v226, v226
    v_exp_f32 v227, v227
    v_exp_f32 v228, v228
    v_exp_f32 v229, v229
    v_exp_f32 v230, v230
    v_exp_f32 v231, v231
    v_smfmac_f32_32x32x32_bf16 v[232:247], v[112:115], v[216:223], v254
    buffer_load_dwordx4 v[56:59], v2, s[12:15], s60 offen sc1
    v_exp_f32 v200, v200
    v_exp_f32 v201, v201
    v_exp_f32 v202, v202
    v_smfmac_f32_32x32x32_bf16 v[232:247], v[116:119], v[224:231], v254
    s_waitcnt vmcnt(15)
    v_exp_f32 v203, v203
    v_exp_f32 v204, v204
    v_exp_f32 v205, v205
    v_mfma_f32_32x32x16_bf16 v[216:231], v[36:39], v[248:251], 0
    s_mov_b64 exec, s[78:79]
    buffer_load_dwordx4 v[168:171], v4, s[12:15], s60 offen offset:1024 sc1
    buffer_load_dwordx4 v[172:175], v4, s[12:15], s60 offen offset:1536 sc1
    s_mov_b64 exec, -1
    v_exp_f32 v206, v206
    v_exp_f32 v207, v207
    v_exp_f32 v208, v208
    v_exp_f32 v209, v209
    v_exp_f32 v210, v210
    v_exp_f32 v211, v211
    v_exp_f32 v212, v212
    v_exp_f32 v213, v213
    v_exp_f32 v214, v214
    v_exp_f32 v215, v215
    v_smfmac_f32_32x32x32_bf16 v[232:247], v[120:123], v[200:207], v254
    buffer_load_dwordx4 v[60:63], v2, s[12:15], s61 offen sc1
    v_exp_f32 v216, v216
    v_exp_f32 v217, v217
    v_exp_f32 v218, v218
    v_smfmac_f32_32x32x32_bf16 v[232:247], v[124:127], v[208:215], v254
    s_waitcnt vmcnt(15)
    v_exp_f32 v219, v219
    v_exp_f32 v220, v220
    v_exp_f32 v221, v221
    v_mfma_f32_32x32x16_bf16 v[200:215], v[40:43], v[248:251], 0
    s_mov_b64 exec, s[78:79]
    buffer_load_dwordx4 v[176:179], v4, s[12:15], s61 offen offset:1024 sc1
    buffer_load_dwordx4 v[180:183], v4, s[12:15], s61 offen offset:1536 sc1
    s_mov_b64 exec, -1
    v_exp_f32 v222, v222
    v_exp_f32 v223, v223
    v_exp_f32 v224, v224
    v_exp_f32 v225, v225
    v_exp_f32 v226, v226
    v_exp_f32 v227, v227
    v_exp_f32 v228, v228
    v_exp_f32 v229, v229
    v_exp_f32 v230, v230
    v_exp_f32 v231, v231
    v_smfmac_f32_32x32x32_bf16 v[232:247], v[128:131], v[216:223], v254
    buffer_load_dwordx4 v[64:67], v2, s[12:15], s62 offen sc1
    v_exp_f32 v200, v200
    v_exp_f32 v201, v201
    v_exp_f32 v202, v202
    v_smfmac_f32_32x32x32_bf16 v[232:247], v[132:135], v[224:231], v254
    s_waitcnt vmcnt(15)
    v_exp_f32 v203, v203
    v_exp_f32 v204, v204
    v_exp_f32 v205, v205
    v_mfma_f32_32x32x16_bf16 v[216:231], v[44:47], v[248:251], 0
    s_mov_b64 exec, s[78:79]
    buffer_load_dwordx4 v[184:187], v4, s[12:15], s62 offen offset:1024 sc1
    buffer_load_dwordx4 v[188:191], v4, s[12:15], s62 offen offset:1536 sc1
    s_mov_b64 exec, -1
    v_exp_f32 v206, v206
    v_exp_f32 v207, v207
    v_exp_f32 v208, v208
    v_exp_f32 v209, v209
    v_exp_f32 v210, v210
    v_exp_f32 v211, v211
    v_exp_f32 v212, v212
    v_exp_f32 v213, v213
    v_exp_f32 v214, v214
    v_exp_f32 v215, v215
    v_smfmac_f32_32x32x32_bf16 v[232:247], v[136:139], v[200:207], v254
    buffer_load_dwordx4 v[68:71], v2, s[12:15], s63 offen sc1
    v_exp_f32 v216, v216
    v_exp_f32 v217, v217
    v_exp_f32 v218, v218
    v_smfmac_f32_32x32x32_bf16 v[232:247], v[140:143], v[208:215], v254
    s_waitcnt vmcnt(15)
    v_exp_f32 v219, v219
    v_exp_f32 v220, v220
    v_exp_f32 v221, v221
    v_mfma_f32_32x32x16_bf16 v[200:215], v[48:51], v[248:251], 0
    s_mov_b64 exec, s[78:79]
    buffer_load_dwordx4 v[192:195], v4, s[12:15], s63 offen offset:1024 sc1
    buffer_load_dwordx4 v[196:199], v4, s[12:15], s63 offen offset:1536 sc1
    s_mov_b64 exec, -1
    v_exp_f32 v222, v222
    v_exp_f32 v223, v223
    v_exp_f32 v224, v224
    v_exp_f32 v225, v225
    v_exp_f32 v226, v226
    v_exp_f32 v227, v227
    v_exp_f32 v228, v228
    v_exp_f32 v229, v229
    v_exp_f32 v230, v230
    ds_write_b32 v253, v255 offset:64
    v_exp_f32 v231, v231
    v_smfmac_f32_32x32x32_bf16 v[232:247], v[144:147], v[216:223], v254
    v_exp_f32 v200, v200
    v_exp_f32 v201, v201
    v_exp_f32 v202, v202
    v_smfmac_f32_32x32x32_bf16 v[232:247], v[148:151], v[224:231], v254
    s_waitcnt vmcnt(14)
    v_exp_f32 v203, v203
    v_exp_f32 v204, v204
    v_exp_f32 v205, v205
    v_mfma_f32_32x32x16_bf16 v[216:231], v[52:55], v[248:251], 0
    s_nop 0
    v_exp_f32 v206, v206
    v_exp_f32 v207, v207
    v_exp_f32 v208, v208
    v_exp_f32 v209, v209
    v_exp_f32 v210, v210
    v_exp_f32 v211, v211
    v_exp_f32 v212, v212
    v_exp_f32 v213, v213
    v_exp_f32 v214, v214
    v_exp_f32 v215, v215
    v_smfmac_f32_32x32x32_bf16 v[232:247], v[152:155], v[200:207], v254
    v_exp_f32 v216, v216
    v_exp_f32 v217, v217
    v_exp_f32 v218, v218
    v_smfmac_f32_32x32x32_bf16 v[232:247], v[156:159], v[208:215], v254
    s_waitcnt vmcnt(11)
    v_exp_f32 v219, v219
    v_exp_f32 v220, v220
    v_exp_f32 v221, v221
    v_mfma_f32_32x32x16_bf16 v[200:215], v[56:59], v[248:251], 0
    s_nop 0
    v_exp_f32 v222, v222
    v_exp_f32 v223, v223
    v_exp_f32 v224, v224
    v_exp_f32 v225, v225
    v_exp_f32 v226, v226
    v_exp_f32 v227, v227
    v_exp_f32 v228, v228
    v_exp_f32 v229, v229
    v_exp_f32 v230, v230
    v_exp_f32 v231, v231
    v_smfmac_f32_32x32x32_bf16 v[232:247], v[160:163], v[216:223], v254
    v_exp_f32 v200, v200
    v_exp_f32 v201, v201
    v_exp_f32 v202, v202
    v_smfmac_f32_32x32x32_bf16 v[232:247], v[164:167], v[224:231], v254
    s_waitcnt vmcnt(8)
    v_exp_f32 v203, v203
    v_exp_f32 v204, v204
    v_exp_f32 v205, v205
    v_mfma_f32_32x32x16_bf16 v[216:231], v[60:63], v[248:251], 0
    ds_read_b32 v3, v7 offset:48
    v_exp_f32 v206, v206
    v_exp_f32 v207, v207
    v_exp_f32 v208, v208
    v_exp_f32 v209, v209
    v_exp_f32 v210, v210
    v_exp_f32 v211, v211
    v_exp_f32 v212, v212
    v_exp_f32 v213, v213
    v_exp_f32 v214, v214
    v_exp_f32 v215, v215
    v_smfmac_f32_32x32x32_bf16 v[232:247], v[168:171], v[200:207], v254
    v_exp_f32 v216, v216
    v_exp_f32 v217, v217
    v_exp_f32 v218, v218
    v_smfmac_f32_32x32x32_bf16 v[232:247], v[172:175], v[208:215], v254
    s_waitcnt vmcnt(5)
    v_exp_f32 v219, v219
    v_exp_f32 v220, v220
    v_exp_f32 v221, v221
    v_mfma_f32_32x32x16_bf16 v[200:215], v[64:67], v[248:251], 0
    s_waitcnt lgkmcnt(0)
    v_exp_f32 v222, v222
    v_exp_f32 v223, v223
    v_exp_f32 v224, v224
    v_exp_f32 v225, v225
    v_exp_f32 v226, v226
    v_exp_f32 v227, v227
    v_exp_f32 v228, v228
    v_cmp_ne_u32 vcc, 1, v3
    v_exp_f32 v229, v229
    v_exp_f32 v230, v230
    s_cbranch_vccnz L_qslow
L_qok:
    v_exp_f32 v231, v231
    v_smfmac_f32_32x32x32_bf16 v[232:247], v[176:179], v[216:223], v254
    v_exp_f32 v200, v200
    v_exp_f32 v201, v201
    v_exp_f32 v202, v202
    v_smfmac_f32_32x32x32_bf16 v[232:247], v[180:183], v[224:231], v254
    s_waitcnt vmcnt(2)
    v_exp_f32 v203, v203
    v_exp_f32 v204, v204
    v_exp_f32 v205, v205
    v_mfma_f32_32x32x16_bf16 v[216:231], v[68:71], v[248:251], 0
    ds_read_b128 v[248:251], v252 offset:1024
    v_exp_f32 v206, v206
    v_exp_f32 v207, v207
    v_exp_f32 v208, v208
    v_exp_f32 v209, v209
    v_exp_f32 v210, v210
    v_exp_f32 v211, v211
    v_exp_f32 v212, v212
    v_exp_f32 v213, v213
    v_exp_f32 v214, v214
    v_exp_f32 v215, v215
    v_smfmac_f32_32x32x32_bf16 v[232:247], v[184:187], v[200:207], v254
    v_exp_f32 v216, v216
    v_exp_f32 v217, v217
    v_exp_f32 v218, v218
    v_smfmac_f32_32x32x32_bf16 v[232:247], v[188:191], v[208:215], v254
    s_waitcnt vmcnt(0) lgkmcnt(0)
    v_exp_f32 v219, v219
    v_exp_f32 v220, v220
    v_exp_f32 v221, v221
    v_mfma_f32_32x32x16_bf16 v[200:215], v[8:11], v[248:251], 0
    s_nop 0
    v_exp_f32 v222, v222
    v_exp_f32 v223, v223
    v_exp_f32 v224, v224
    v_exp_f32 v225, v225
    v_exp_f32 v226, v226
    v_exp_f32 v227, v227
    v_exp_f32 v228, v228
    v_exp_f32 v229, v229
    v_exp_f32 v230, v230
    v_exp_f32 v231, v231
    v_smfmac_f32_32x32x32_bf16 v[232:247], v[192:195], v[216:223], v254
    v_exp_f32 v200, v200
    v_exp_f32 v201, v201
    v_exp_f32 v202, v202
    v_smfmac_f32_32x32x32_bf16 v[232:247], v[196:199], v[224:231], v254
    v_exp_f32 v203, v203
    v_exp_f32 v204, v204
    v_exp_f32 v205, v205
    v_mfma_f32_32x32x16_bf16 v[216:231], v[12:15], v[248:251], 0
    s_nop 0
    v_exp_f32 v206, v206
    v_exp_f32 v207, v207
    v_exp_f32 v208, v208
    v_exp_f32 v209, v209
    v_exp_f32 v210, v210
    v_exp_f32 v211, v211
    v_exp_f32 v212, v212
    ds_write_b128 v5, v[232:235]
    ds_write_b128 v5, v[236:239] offset:1024
    ds_write_b32 v6, v240
    v_mov_b64 v[232:233], 0
    v_mov_b64 v[234:235], 0
    v_mov_b64 v[236:237], 0
    v_mov_b64 v[238:239], 0
    v_mov_b64 v[240:241], 0
    v_exp_f32 v213, v213
    v_exp_f32 v214, v214
    v_exp_f32 v215, v215
    v_smfmac_f32_32x32x32_bf16 v[232:247], v[72:75], v[200:207], v254
    v_exp_f32 v216, v216
    v_exp_f32 v217, v217
    v_exp_f32 v218, v218
    v_smfmac_f32_32x32x32_bf16 v[232:247], v[76:79], v[208:215], v254
    v_exp_f32 v219, v219
    v_exp_f32 v220, v220
    v_exp_f32 v221, v221
    v_mfma_f32_32x32x16_bf16 v[200:215], v[16:19], v[248:251], 0
    s_nop 0
    v_exp_f32 v222, v222
    v_exp_f32 v223, v223
    v_exp_f32 v224, v224
    v_exp_f32 v225, v225
    v_exp_f32 v226, v226
    v_exp_f32 v227, v227
    v_exp_f32 v228, v228
    v_exp_f32 v229, v229
    v_exp_f32 v230, v230
    v_exp_f32 v231, v231
    v_smfmac_f32_32x32x32_bf16 v[232:247], v[80:83], v[216:223], v254
    v_exp_f32 v200, v200
    v_exp_f32 v201, v201
    v_exp_f32 v202, v202
    v_smfmac_f32_32x32x32_bf16 v[232:247], v[84:87], v[224:231], v254
    v_exp_f32 v203, v203
    v_exp_f32 v204, v204
    v_exp_f32 v205, v205
    v_mfma_f32_32x32x16_bf16 v[216:231], v[20:23], v[248:251], 0
    s_nop 0
    v_exp_f32 v206, v206
    v_exp_f32 v207, v207
    v_exp_f32 v208, v208
    v_exp_f32 v209, v209
    v_exp_f32 v210, v210
    v_exp_f32 v211, v211
    v_exp_f32 v212, v212
    v_exp_f32 v213, v213
    v_exp_f32 v214, v214
    v_exp_f32 v215, v215
    v_smfmac_f32_32x32x32_bf16 v[232:247], v[88:91], v[200:207], v254
    v_exp_f32 v216, v216
    v_exp_f32 v217, v217
    v_exp_f32 v218, v218
    v_smfmac_f32_32x32x32_bf16 v[232:247], v[92:95], v[208:215], v254
    v_exp_f32 v219, v219
    v_exp_f32 v220, v220
    v_exp_f32 v221, v221
    v_mfma_f32_32x32x16_bf16 v[200:215], v[24:27], v[248:251], 0
    s_nop 0
    v_exp_f32 v222, v222
    v_exp_f32 v223, v223
    v_exp_f32 v224, v224
    v_exp_f32 v225, v225
    v_exp_f32 v226, v226
    v_exp_f32 v227, v227
    v_exp_f32 v228, v228
    v_exp_f32 v229, v229
    v_exp_f32 v230, v230
    v_exp_f32 v231, v231
    v_smfmac_f32_32x32x32_bf16 v[232:247], v[96:99], v[216:223], v254
    v_exp_f32 v200, v200
    v_exp_f32 v201, v201
    v_exp_f32 v202, v202
    v_smfmac_f32_32x32x32_bf16 v[232:247], v[100:103], v[224:231], v254
    v_exp_f32 v203, v203
    v_exp_f32 v204, v204
    v_exp_f32 v205, v205
    v_mfma_f32_32x32x16_bf16 v[216:231], v[28:31], v[248:251], 0
    s_nop 0
    v_exp_f32 v206, v206
    v_exp_f32 v207, v207
    v_exp_f32 v208, v208
    v_exp_f32 v209, v209
    v_exp_f32 v210, v210
    v_exp_f32 v211, v211
    v_exp_f32 v212, v212
    v_exp_f32 v213, v213
    v_exp_f32 v214, v214
    v_exp_f32 v215, v215
    v_smfmac_f32_32x32x32_bf16 v[232:247], v[104:107], v[200:207], v254
    v_exp_f32 v216, v216
    v_exp_f32 v217, v217
    v_exp_f32 v218, v218
    v_smfmac_f32_32x32x32_bf16 v[232:247], v[108:111], v[208:215], v254
    v_exp_f32 v219, v219
    v_exp_f32 v220, v220
    v_exp_f32 v221, v221
    v_mfma_f32_32x32x16_bf16 v[200:215], v[32:35], v[248:251], 0
    s_nop 0
    v_exp_f32 v222, v222
    v_exp_f32 v223, v223
    v_exp_f32 v224, v224
    v_exp_f32 v225, v225
    v_exp_f32 v226, v226
    v_exp_f32 v227, v227
    v_exp_f32 v228, v228
    v_exp_f32 v229, v229
    v_exp_f32 v230, v230
    v_exp_f32 v231, v231
    v_smfmac_f32_32x32x32_bf16 v[232:247], v[112:115], v[216:223], v254
    v_exp_f32 v200, v200
    v_exp_f32 v201, v201
    v_exp_f32 v202, v202
    v_smfmac_f32_32x32x32_bf16 v[232:247], v[116:119], v[224:231], v254
    v_exp_f32 v203, v203
    v_exp_f32 v204, v204
    v_exp_f32 v205, v205
    v_mfma_f32_32x32x16_bf16 v[216:231], v[36:39], v[248:251], 0
    s_nop 0
    v_exp_f32 v206, v206
    v_exp_f32 v207, v207
    v_exp_f32 v208, v208
    v_exp_f32 v209, v209
    v_exp_f32 v210, v210
    v_exp_f32 v211, v211
    v_exp_f32 v212, v212
    v_exp_f32 v213, v213
    v_exp_f32 v214, v214
    v_exp_f32 v215, v215
    v_smfmac_f32_32x32x32_bf16 v[232:247], v[120:123], v[200:207], v254
    v_exp_f32 v216, v216
    v_exp_f32 v217, v217
    v_exp_f32 v218, v218
    v_smfmac_f32_32x32x32_bf16 v[232:247], v[124:127], v[208:215], v254
    v_exp_f32 v219, v219
    v_exp_f32 v220, v220
    v_exp_f32 v221, v221
    v_mfma_f32_32x32x16_bf16 v[200:215], v[40:43], v[248:251], 0
    s_nop 0
    v_exp_f32 v222, v222
    v_exp_f32 v223, v223
    v_exp_f32 v224, v224
    v_exp_f32 v225, v225
    v_exp_f32 v226, v226
    v_exp_f32 v227, v227
    v_exp_f32 v228, v228
    v_exp_f32 v229, v229
    v_exp_f32 v230, v230
    v_exp_f32 v231, v231
    v_smfmac_f32_32x32x32_bf16 v[232:247], v[128:131], v[216:223], v254
    v_exp_f32 v200, v200
    v_exp_f32 v201, v201
    v_exp_f32 v202, v202
    v_smfmac_f32_32x32x32_bf16 v[232:247], v[132:135], v[224:231], v254
    v_exp_f32 v203, v203
    v_exp_f32 v204, v204
    v_exp_f32 v205, v205
    v_mfma_f32_32x32x16_bf16 v[216:231], v[44:47], v[248:251], 0
    s_nop 0
    v_exp_f32 v206, v206
    v_exp_f32 v207, v207
    v_exp_f32 v208, v208
    v_exp_f32 v209, v209
    v_exp_f32 v210, v210
    v_exp_f32 v211, v211
    v_exp_f32 v212, v212
    v_exp_f32 v213, v213
    v_exp_f32 v214, v214
    v_exp_f32 v215, v215
    v_smfmac_f32_32x32x32_bf16 v[232:247], v[136:139], v[200:207], v254
    v_exp_f32 v216, v216
    v_exp_f32 v217, v217
    v_exp_f32 v218, v218
    v_smfmac_f32_32x32x32_bf16 v[232:247], v[140:143], v[208:215], v254
    v_exp_f32 v219, v219
    v_exp_f32 v220, v220
    v_exp_f32 v221, v221
    v_mfma_f32_32x32x16_bf16 v[200:215], v[48:51], v[248:251], 0
    s_nop 0
    v_exp_f32 v222, v222
    v_exp_f32 v223, v223
    v_exp_f32 v224, v224
    v_exp_f32 v225, v225
    v_exp_f32 v226, v226
    v_exp_f32 v227, v227
    v_exp_f32 v228, v228
    v_exp_f32 v229, v229
    v_exp_f32 v230, v230
    v_exp_f32 v231, v231
    v_smfmac_f32_32x32x32_bf16 v[232:247], v[144:147], v[216:223], v254
    v_exp_f32 v200, v200
    v_exp_f32 v201, v201
    v_exp_f32 v202, v202
    v_smfmac_f32_32x32x32_bf16 v[232:247], v[148:151], v[224:231], v254
    v_exp_f32 v203, v203
    v_exp_f32 v204, v204
    v_exp_f32 v205, v205
    v_mfma_f32_32x32x16_bf16 v[216:231], v[52:55], v[248:251], 0
    s_nop 0
    v_exp_f32 v206, v206
    v_exp_f32 v207, v207
    v_exp_f32 v208, v208
    v_exp_f32 v209, v209
    v_exp_f32 v210, v210
    v_exp_f32 v211, v211
    v_exp_f32 v212, v212
    v_exp_f32 v213, v213
    v_exp_f32 v214, v214
    v_exp_f32 v215, v215
    v_smfmac_f32_32x32x32_bf16 v[232:247], v[152:155], v[200:207], v254
    v_exp_f32 v216, v216
    v_exp_f32 v217, v217
    v_exp_f32 v218, v218
    v_smfmac_f32_32x32x32_bf16 v[232:247], v[156:159], v[208:215], v254
    v_exp_f32 v219, v219
    v_exp_f32 v220, v220
    v_exp_f32 v221, v221
    v_mfma_f32_32x32x16_bf16 v[200:215], v[56:59], v[248:251], 0
    s_nop 0
    v_exp_f32 v222, v222
    v_exp_f32 v223, v223
    v_exp_f32 v224, v224
    v_exp_f32 v225, v225
    v_exp_f32 v226, v226
    v_exp_f32 v227, v227
    v_exp_f32 v228, v228
    v_exp_f32 v229, v229
    v_exp_f32 v230, v230
    v_exp_f32 v231, v231
    v_smfmac_f32_32x32x32_bf16 v[232:247], v[160:163], v[216:223], v254
    v_exp_f32 v200, v200
    v_exp_f32 v201, v201
    v_exp_f32 v202, v202
    v_smfmac_f32_32x32x32_bf16 v[232:247], v[164:167], v[224:231], v254
    v_exp_f32 v203, v203
    v_exp_f32 v204, v204
    v_exp_f32 v205, v205
    v_mfma_f32_32x32x16_bf16 v[216:231], v[60:63], v[248:251], 0
    s_nop 0
    v_exp_f32 v206, v206
    v_exp_f32 v207, v207
    v_exp_f32 v208, v208
    v_exp_f32 v209, v209
    v_exp_f32 v210, v210
    v_exp_f32 v211, v211
    v_exp_f32 v212, v212
    v_exp_f32 v213, v213
    v_exp_f32 v214, v214
    v_exp_f32 v215, v215
    v_smfmac_f32_32x32x32_bf16 v[232:247], v[168:171], v[200:207], v254
    v_exp_f32 v216, v216
    v_exp_f32 v217, v217
    v_exp_f32 v218, v218
    v_smfmac_f32_32x32x32_bf16 v[232:247], v[172:175], v[208:215], v254
    v_exp_f32 v219, v219
    v_exp_f32 v220, v220
    v_exp_f32 v221, v221
    v_mfma_f32_32x32x16_bf16 v[200:215], v[64:67], v[248:251], 0
    s_nop 0
    v_exp_f32 v222, v222
    v_exp_f32 v223, v223
    v_exp_f32 v224, v224
    v_exp_f32 v225, v225
    v_exp_f32 v226, v226
    v_exp_f32 v227, v227
    v_exp_f32 v228, v228
    v_exp_f32 v229, v229
    v_exp_f32 v230, v230
    v_exp_f32 v231, v231
    v_smfmac_f32_32x32x32_bf16 v[232:247], v[176:179], v[216:223], v254
    v_exp_f32 v200, v200
    v_exp_f32 v201, v201
    v_exp_f32 v202, v202
    v_smfmac_f32_32x32x32_bf16 v[232:247], v[180:183], v[224:231], v254
    v_exp_f32 v203, v203
    v_exp_f32 v204, v204
    v_exp_f32 v205, v205
    v_mfma_f32_32x32x16_bf16 v[216:231], v[68:71], v[248:251], 0
    ds_read_b128 v[248:251], v252 offset:2048
    v_exp_f32 v206, v206
    v_exp_f32 v207, v207
    v_exp_f32 v208, v208
    v_exp_f32 v209, v209
    v_exp_f32 v210, v210
    v_exp_f32 v211, v211
    v_exp_f32 v212, v212
    v_exp_f32 v213, v213
    v_exp_f32 v214, v214
    v_exp_f32 v215, v215
    v_smfmac_f32_32x32x32_bf16 v[232:247], v[184:187], v[200:207], v254
    v_exp_f32 v216, v216
    v_exp_f32 v217, v217
    v_exp_f32 v218, v218
    v_smfmac_f32_32x32x32_bf16 v[232:247], v[188:191], v[208:215], v254
    s_waitcnt lgkmcnt(0)
    v_exp_f32 v219, v219
    v_exp_f32 v220, v220
    v_exp_f32 v221, v221
    v_mfma_f32_32x32x16_bf16 v[200:215], v[8:11], v[248:251], 0
    s_nop 0
    v_exp_f32 v222, v222
    v_exp_f32 v223, v223
    v_exp_f32 v224, v224
    v_exp_f32 v225, v225
    v_exp_f32 v226, v226
    v_exp_f32 v227, v227
    v_exp_f32 v228, v228
    v_exp_f32 v229, v229
    v_exp_f32 v230, v230
    v_exp_f32 v231, v231
    v_smfmac_f32_32x32x32_bf16 v[232:247], v[192:195], v[216:223], v254
    v_exp_f32 v200, v200
    v_exp_f32 v201, v201
    v_exp_f32 v202, v202
    v_smfmac_f32_32x32x32_bf16 v[232:247], v[196:199], v[224:231], v254
    v_exp_f32 v203, v203
    v_exp_f32 v204, v204
    v_exp_f32 v205, v205
    v_mfma_f32_32x32x16_bf16 v[216:231], v[12:15], v[248:251], 0
    s_nop 0
    v_exp_f32 v206, v206
    v_exp_f32 v207, v207
    v_exp_f32 v208, v208
    v_exp_f32 v209, v209
    v_exp_f32 v210, v210
    v_exp_f32 v211, v211
    v_exp_f32 v212, v212
    ds_write_b128 v5, v[232:235] offset:2048
    ds_write_b128 v5, v[236:239] offset:3072
    ds_write_b32 v6, v240 offset:512
    v_mov_b64 v[232:233], 0
    v_mov_b64 v[234:235], 0
    v_mov_b64 v[236:237], 0
    v_mov_b64 v[238:239], 0
    v_mov_b64 v[240:241], 0
    v_exp_f32 v213, v213
    v_exp_f32 v214, v214
    v_exp_f32 v215, v215
    v_smfmac_f32_32x32x32_bf16 v[232:247], v[72:75], v[200:207], v254
    v_exp_f32 v216, v216
    v_exp_f32 v217, v217
    v_exp_f32 v218, v218
    v_smfmac_f32_32x32x32_bf16 v[232:247], v[76:79], v[208:215], v254
    v_exp_f32 v219, v219
    v_exp_f32 v220, v220
    v_exp_f32 v221, v221
    v_mfma_f32_32x32x16_bf16 v[200:215], v[16:19], v[248:251], 0
    s_nop 0
    v_exp_f32 v222, v222
    v_exp_f32 v223, v223
    v_exp_f32 v224, v224
    v_exp_f32 v225, v225
    v_exp_f32 v226, v226
    v_exp_f32 v227, v227
    v_exp_f32 v228, v228
    v_exp_f32 v229, v229
    v_exp_f32 v230, v230
    v_exp_f32 v231, v231
    v_smfmac_f32_32x32x32_bf16 v[232:247], v[80:83], v[216:223], v254
    v_exp_f32 v200, v200
    v_exp_f32 v201, v201
    v_exp_f32 v202, v202
    v_smfmac_f32_32x32x32_bf16 v[232:247], v[84:87], v[224:231], v254
    v_exp_f32 v203, v203
    v_exp_f32 v204, v204
    v_exp_f32 v205, v205
    v_mfma_f32_32x32x16_bf16 v[216:231], v[20:23], v[248:251], 0
    s_nop 0
    v_exp_f32 v206, v206
    v_exp_f32 v207, v207
    v_exp_f32 v208, v208
    v_exp_f32 v209, v209
    v_exp_f32 v210, v210
    v_exp_f32 v211, v211
    v_exp_f32 v212, v212
    v_exp_f32 v213, v213
    v_exp_f32 v214, v214
    v_exp_f32 v215, v215
    v_smfmac_f32_32x32x32_bf16 v[232:247], v[88:91], v[200:207], v254
    v_exp_f32 v216, v216
    v_exp_f32 v217, v217
    v_exp_f32 v218, v218
    v_smfmac_f32_32x32x32_bf16 v[232:247], v[92:95], v[208:215], v254
    v_exp_f32 v219, v219
    v_exp_f32 v220, v220
    v_exp_f32 v221, v221
    v_mfma_f32_32x32x16_bf16 v[200:215], v[24:27], v[248:251], 0
    s_nop 0
    v_exp_f32 v222, v222
    v_exp_f32 v223, v223
    v_exp_f32 v224, v224
    v_exp_f32 v225, v225
    v_exp_f32 v226, v226
    v_exp_f32 v227, v227
    v_exp_f32 v228, v228
    v_exp_f32 v229, v229
    v_exp_f32 v230, v230
    v_exp_f32 v231, v231
    v_smfmac_f32_32x32x32_bf16 v[232:247], v[96:99], v[216:223], v254
    v_exp_f32 v200, v200
    v_exp_f32 v201, v201
    v_exp_f32 v202, v202
    v_smfmac_f32_32x32x32_bf16 v[232:247], v[100:103], v[224:231], v254
    v_exp_f32 v203, v203
    v_exp_f32 v204, v204
    v_exp_f32 v205, v205
    v_mfma_f32_32x32x16_bf16 v[216:231], v[28:31], v[248:251], 0
    s_nop 0
    v_exp_f32 v206, v206
    v_exp_f32 v207, v207
    v_exp_f32 v208, v208
    v_exp_f32 v209, v209
    v_exp_f32 v210, v210
    v_exp_f32 v211, v211
    v_exp_f32 v212, v212
    v_exp_f32 v213, v213
    v_exp_f32 v214, v214
    v_exp_f32 v215, v215
    v_smfmac_f32_32x32x32_bf16 v[232:247], v[104:107], v[200:207], v254
    v_exp_f32 v216, v216
    v_exp_f32 v217, v217
    v_exp_f32 v218, v218
    v_smfmac_f32_32x32x32_bf16 v[232:247], v[108:111], v[208:215], v254
    v_exp_f32 v219, v219
    v_exp_f32 v220, v220
    v_exp_f32 v221, v221
    v_mfma_f32_32x32x16_bf16 v[200:215], v[32:35], v[248:251], 0
    s_nop 0
    v_exp_f32 v222, v222
    v_exp_f32 v223, v223
    v_exp_f32 v224, v224
    v_exp_f32 v225, v225
    v_exp_f32 v226, v226
    v_exp_f32 v227, v227
    v_exp_f32 v228, v228
    v_exp_f32 v229, v229
    v_exp_f32 v230, v230
    v_exp_f32 v231, v231
    v_smfmac_f32_32x32x32_bf16 v[232:247], v[112:115], v[216:223], v254
    v_exp_f32 v200, v200
    v_exp_f32 v201, v201
    v_exp_f32 v202, v202
    v_smfmac_f32_32x32x32_bf16 v[232:247], v[116:119], v[224:231], v254
    v_exp_f32 v203, v203
    v_exp_f32 v204, v204
    v_exp_f32 v205, v205
    v_mfma_f32_32x32x16_bf16 v[216:231], v[36:39], v[248:251], 0
    s_nop 0
    v_exp_f32 v206, v206
    v_exp_f32 v207, v207
    v_exp_f32 v208, v208
    v_exp_f32 v209, v209
    v_exp_f32 v210, v210
    v_exp_f32 v211, v211
    v_exp_f32 v212, v212
    v_exp_f32 v213, v213
    v_exp_f32 v214, v214
    v_exp_f32 v215, v215
    v_smfmac_f32_32x32x32_bf16 v[232:247], v[120:123], v[200:207], v254
    v_exp_f32 v216, v216
    v_exp_f32 v217, v217
    v_exp_f32 v218, v218
    v_smfmac_f32_32x32x32_bf16 v[232:247], v[124:127], v[208:215], v254
    v_exp_f32 v219, v219
    v_exp_f32 v220, v220
    v_exp_f32 v221, v221
    v_mfma_f32_32x32x16_bf16 v[200:215], v[40:43], v[248:251], 0
    s_nop 0
    v_exp_f32 v222, v222
    v_exp_f32 v223, v223
    v_exp_f32 v224, v224
    v_exp_f32 v225, v225
    v_exp_f32 v226, v226
    v_exp_f32 v227, v227
    v_exp_f32 v228, v228
    v_exp_f32 v229, v229
    v_exp_f32 v230, v230
    v_exp_f32 v231, v231
    v_smfmac_f32_32x32x32_bf16 v[232:247], v[128:131], v[216:223], v254
    v_exp_f32 v200, v200
    v_exp_f32 v201, v201
    v_exp_f32 v202, v202
    v_smfmac_f32_32x32x32_bf16 v[232:247], v[132:135], v[224:231], v254
    v_exp_f32 v203, v203
    v_exp_f32 v204, v204
    v_exp_f32 v205, v205
    v_mfma_f32_32x32x16_bf16 v[216:231], v[44:47], v[248:251], 0
    s_nop 0
    v_exp_f32 v206, v206
    v_exp_f32 v207, v207
    v_exp_f32 v208, v208
    v_exp_f32 v209, v209
    v_exp_f32 v210, v210
    v_exp_f32 v211, v211
    v_exp_f32 v212, v212
    v_exp_f32 v213, v213
    v_exp_f32 v214, v214
    v_exp_f32 v215, v215
    v_smfmac_f32_32x32x32_bf16 v[232:247], v[136:139], v[200:207], v254
    v_exp_f32 v216, v216
    v_exp_f32 v217, v217
    v_exp_f32 v218, v218
    v_smfmac_f32_32x32x32_bf16 v[232:247], v[140:143], v[208:215], v254
    v_exp_f32 v219, v219
    v_exp_f32 v220, v220
    v_exp_f32 v221, v221
    v_mfma_f32_32x32x16_bf16 v[200:215], v[48:51], v[248:251], 0
    s_nop 0
    v_exp_f32 v222, v222
    v_exp_f32 v223, v223
    v_exp_f32 v224, v224
    v_exp_f32 v225, v225
    v_exp_f32 v226, v226
    v_exp_f32 v227, v227
    v_exp_f32 v228, v228
    v_exp_f32 v229, v229
    v_exp_f32 v230, v230
    v_exp_f32 v231, v231
    v_smfmac_f32_32x32x32_bf16 v[232:247], v[144:147], v[216:223], v254
    v_exp_f32 v200, v200
    v_exp_f32 v201, v201
    v_exp_f32 v202, v202
    v_smfmac_f32_32x32x32_bf16 v[232:247], v[148:151], v[224:231], v254
    v_exp_f32 v203, v203
    v_exp_f32 v204, v204
    v_exp_f32 v205, v205
    v_mfma_f32_32x32x16_bf16 v[216:231], v[52:55], v[248:251], 0
    s_nop 0
    v_exp_f32 v206, v206
    v_exp_f32 v207, v207
    v_exp_f32 v208, v208
    v_exp_f32 v209, v209
    v_exp_f32 v210, v210
    v_exp_f32 v211, v211
    v_exp_f32 v212, v212
    v_exp_f32 v213, v213
    v_exp_f32 v214, v214
    v_exp_f32 v215, v215
    v_smfmac_f32_32x32x32_bf16 v[232:247], v[152:155], v[200:207], v254
    v_exp_f32 v216, v216
    v_exp_f32 v217, v217
    v_exp_f32 v218, v218
    v_smfmac_f32_32x32x32_bf16 v[232:247], v[156:159], v[208:215], v254
    v_exp_f32 v219, v219
    v_exp_f32 v220, v220
    v_exp_f32 v221, v221
    v_mfma_f32_32x32x16_bf16 v[200:215], v[56:59], v[248:251], 0
    s_nop 0
    v_exp_f32 v222, v222
    v_exp_f32 v223, v223
    v_exp_f32 v224, v224
    v_exp_f32 v225, v225
    v_exp_f32 v226, v226
    v_exp_f32 v227, v227
    v_exp_f32 v228, v228
    v_exp_f32 v229, v229
    v_exp_f32 v230, v230
    v_exp_f32 v231, v231
    v_smfmac_f32_32x32x32_bf16 v[232:247], v[160:163], v[216:223], v254
    v_exp_f32 v200, v200
    v_exp_f32 v201, v201
    v_exp_f32 v202, v202
    v_smfmac_f32_32x32x32_bf16 v[232:247], v[164:167], v[224:231], v254
    v_exp_f32 v203, v203
    v_exp_f32 v204, v204
    v_exp_f32 v205, v205
    v_mfma_f32_32x32x16_bf16 v[216:231], v[60:63], v[248:251], 0
    s_nop 0
    v_exp_f32 v206, v206
    v_exp_f32 v207, v207
    v_exp_f32 v208, v208
    v_exp_f32 v209, v209
    v_exp_f32 v210, v210
    v_exp_f32 v211, v211
    v_exp_f32 v212, v212
    v_exp_f32 v213, v213
    v_exp_f32 v214, v214
    v_exp_f32 v215, v215
    v_smfmac_f32_32x32x32_bf16 v[232:247], v[168:171], v[200:207], v254
    v_exp_f32 v216, v216
    v_exp_f32 v217, v217
    v_exp_f32 v218, v218
    v_smfmac_f32_32x32x32_bf16 v[232:247], v[172:175], v[208:215], v254
    v_exp_f32 v219, v219
    v_exp_f32 v220, v220
    v_exp_f32 v221, v221
    v_mfma_f32_32x32x16_bf16 v[200:215], v[64:67], v[248:251], 0
    s_nop 0
    v_exp_f32 v222, v222
    v_exp_f32 v223, v223
    v_exp_f32 v224, v224
    v_exp_f32 v225, v225
    v_exp_f32 v226, v226
    v_exp_f32 v227, v227
    v_exp_f32 v228, v228
    v_exp_f32 v229, v229
    v_exp_f32 v230, v230
    v_exp_f32 v231, v231
    v_smfmac_f32_32x32x32_bf16 v[232:247], v[176:179], v[216:223], v254
    v_exp_f32 v200, v200
    v_exp_f32 v201, v201
    v_exp_f32 v202, v202
    v_smfmac_f32_32x32x32_bf16 v[232:247], v[180:183], v[224:231], v254
    v_exp_f32 v203, v203
    v_exp_f32 v204, v204
    v_exp_f32 v205, v205
    v_mfma_f32_32x32x16_bf16 v[216:231], v[68:71], v[248:251], 0
    ds_read_b128 v[248:251], v252 offset:3072
    v_exp_f32 v206, v206
    v_exp_f32 v207, v207
    v_exp_f32 v208, v208
    v_exp_f32 v209, v209
    v_exp_f32 v210, v210
    v_exp_f32 v211, v211
    v_exp_f32 v212, v212
    v_exp_f32 v213, v213
    v_exp_f32 v214, v214
    v_exp_f32 v215, v215
    v_smfmac_f32_32x32x32_bf16 v[232:247], v[184:187], v[200:207], v254
    v_exp_f32 v216, v216
    v_exp_f32 v217, v217
    v_exp_f32 v218, v218
    v_smfmac_f32_32x32x32_bf16 v[232:247], v[188:191], v[208:215], v254
    s_waitcnt lgkmcnt(0)
    v_exp_f32 v219, v219
    v_exp_f32 v220, v220
    v_exp_f32 v221, v221
    v_mfma_f32_32x32x16_bf16 v[200:215], v[8:11], v[248:251], 0
    s_nop 0
    v_exp_f32 v222, v222
    v_exp_f32 v223, v223
    v_exp_f32 v224, v224
    v_exp_f32 v225, v225
    v_exp_f32 v226, v226
    v_exp_f32 v227, v227
    v_exp_f32 v228, v228
    v_exp_f32 v229, v229
    v_exp_f32 v230, v230
    v_exp_f32 v231, v231
    v_smfmac_f32_32x32x32_bf16 v[232:247], v[192:195], v[216:223], v254
    v_exp_f32 v200, v200
    v_exp_f32 v201, v201
    v_exp_f32 v202, v202
    v_smfmac_f32_32x32x32_bf16 v[232:247], v[196:199], v[224:231], v254
    v_exp_f32 v203, v203
    v_exp_f32 v204, v204
    v_exp_f32 v205, v205
    v_mfma_f32_32x32x16_bf16 v[216:231], v[12:15], v[248:251], 0
    s_nop 0
    v_exp_f32 v206, v206
    v_exp_f32 v207, v207
    v_exp_f32 v208, v208
    v_exp_f32 v209, v209
    v_exp_f32 v210, v210
    v_exp_f32 v211, v211
    v_exp_f32 v212, v212
    ds_write_b128 v5, v[232:235] offset:4096
    ds_write_b128 v5, v[236:239] offset:5120
    ds_write_b32 v6, v240 offset:1024
    v_mov_b64 v[232:233], 0
    v_mov_b64 v[234:235], 0
    v_mov_b64 v[236:237], 0
    v_mov_b64 v[238:239], 0
    v_mov_b64 v[240:241], 0
    v_exp_f32 v213, v213
    v_exp_f32 v214, v214
    v_exp_f32 v215, v215
    v_smfmac_f32_32x32x32_bf16 v[232:247], v[72:75], v[200:207], v254
    v_exp_f32 v216, v216
    v_exp_f32 v217, v217
    v_exp_f32 v218, v218
    v_smfmac_f32_32x32x32_bf16 v[232:247], v[76:79], v[208:215], v254
    v_exp_f32 v219, v219
    v_exp_f32 v220, v220
    v_exp_f32 v221, v221
    v_mfma_f32_32x32x16_bf16 v[200:215], v[16:19], v[248:251], 0
    s_nop 0
    v_exp_f32 v222, v222
    v_exp_f32 v223, v223
    v_exp_f32 v224, v224
    v_exp_f32 v225, v225
    v_exp_f32 v226, v226
    v_exp_f32 v227, v227
    v_exp_f32 v228, v228
    v_exp_f32 v229, v229
    v_exp_f32 v230, v230
    v_exp_f32 v231, v231
    v_smfmac_f32_32x32x32_bf16 v[232:247], v[80:83], v[216:223], v254
    v_exp_f32 v200, v200
    v_exp_f32 v201, v201
    v_exp_f32 v202, v202
    v_smfmac_f32_32x32x32_bf16 v[232:247], v[84:87], v[224:231], v254
    v_exp_f32 v203, v203
    v_exp_f32 v204, v204
    v_exp_f32 v205, v205
    v_mfma_f32_32x32x16_bf16 v[216:231], v[20:23], v[248:251], 0
    s_nop 0
    v_exp_f32 v206, v206
    v_exp_f32 v207, v207
    v_exp_f32 v208, v208
    v_exp_f32 v209, v209
    v_exp_f32 v210, v210
    v_exp_f32 v211, v211
    v_exp_f32 v212, v212
    v_exp_f32 v213, v213
    v_exp_f32 v214, v214
    v_exp_f32 v215, v215
    v_smfmac_f32_32x32x32_bf16 v[232:247], v[88:91], v[200:207], v254
    v_exp_f32 v216, v216
    v_exp_f32 v217, v217
    v_exp_f32 v218, v218
    v_smfmac_f32_32x32x32_bf16 v[232:247], v[92:95], v[208:215], v254
    v_exp_f32 v219, v219
    v_exp_f32 v220, v220
    v_exp_f32 v221, v221
    v_mfma_f32_32x32x16_bf16 v[200:215], v[24:27], v[248:251], 0
    s_nop 0
    v_exp_f32 v222, v222
    v_exp_f32 v223, v223
    v_exp_f32 v224, v224
    v_exp_f32 v225, v225
    v_exp_f32 v226, v226
    v_exp_f32 v227, v227
    v_exp_f32 v228, v228
    v_exp_f32 v229, v229
    v_exp_f32 v230, v230
    v_exp_f32 v231, v231
    v_smfmac_f32_32x32x32_bf16 v[232:247], v[96:99], v[216:223], v254
    v_exp_f32 v200, v200
    v_exp_f32 v201, v201
    v_exp_f32 v202, v202
    v_smfmac_f32_32x32x32_bf16 v[232:247], v[100:103], v[224:231], v254
    v_exp_f32 v203, v203
    v_exp_f32 v204, v204
    v_exp_f32 v205, v205
    v_mfma_f32_32x32x16_bf16 v[216:231], v[28:31], v[248:251], 0
    s_nop 0
    v_exp_f32 v206, v206
    v_exp_f32 v207, v207
    v_exp_f32 v208, v208
    v_exp_f32 v209, v209
    v_exp_f32 v210, v210
    v_exp_f32 v211, v211
    v_exp_f32 v212, v212
    v_exp_f32 v213, v213
    v_exp_f32 v214, v214
    v_exp_f32 v215, v215
    v_smfmac_f32_32x32x32_bf16 v[232:247], v[104:107], v[200:207], v254
    v_exp_f32 v216, v216
    v_exp_f32 v217, v217
    v_exp_f32 v218, v218
    v_smfmac_f32_32x32x32_bf16 v[232:247], v[108:111], v[208:215], v254
    v_exp_f32 v219, v219
    v_exp_f32 v220, v220
    v_exp_f32 v221, v221
    v_mfma_f32_32x32x16_bf16 v[200:215], v[32:35], v[248:251], 0
    s_nop 0
    v_exp_f32 v222, v222
    v_exp_f32 v223, v223
    v_exp_f32 v224, v224
    v_exp_f32 v225, v225
    v_exp_f32 v226, v226
    v_exp_f32 v227, v227
    v_exp_f32 v228, v228
    v_exp_f32 v229, v229
    v_exp_f32 v230, v230
    v_exp_f32 v231, v231
    v_smfmac_f32_32x32x32_bf16 v[232:247], v[112:115], v[216:223], v254
    v_exp_f32 v200, v200
    v_exp_f32 v201, v201
    v_exp_f32 v202, v202
    v_smfmac_f32_32x32x32_bf16 v[232:247], v[116:119], v[224:231], v254
    v_exp_f32 v203, v203
    v_exp_f32 v204, v204
    v_exp_f32 v205, v205
    v_mfma_f32_32x32x16_bf16 v[216:231], v[36:39], v[248:251], 0
    s_nop 0
    v_exp_f32 v206, v206
    v_exp_f32 v207, v207
    v_exp_f32 v208, v208
    v_exp_f32 v209, v209
    v_exp_f32 v210, v210
    v_exp_f32 v211, v211
    v_exp_f32 v212, v212
    v_exp_f32 v213, v213
    v_exp_f32 v214, v214
    v_exp_f32 v215, v215
    v_smfmac_f32_32x32x32_bf16 v[232:247], v[120:123], v[200:207], v254
    v_exp_f32 v216, v216
    v_exp_f32 v217, v217
    v_exp_f32 v218, v218
    v_smfmac_f32_32x32x32_bf16 v[232:247], v[124:127], v[208:215], v254
    v_exp_f32 v219, v219
    v_exp_f32 v220, v220
    v_exp_f32 v221, v221
    v_mfma_f32_32x32x16_bf16 v[200:215], v[40:43], v[248:251], 0
    s_nop 0
    v_exp_f32 v222, v222
    v_exp_f32 v223, v223
    v_exp_f32 v224, v224
    v_exp_f32 v225, v225
    v_exp_f32 v226, v226
    v_exp_f32 v227, v227
    v_exp_f32 v228, v228
    v_exp_f32 v229, v229
    v_exp_f32 v230, v230
    v_exp_f32 v231, v231
    v_smfmac_f32_32x32x32_bf16 v[232:247], v[128:131], v[216:223], v254
    v_exp_f32 v200, v200
    v_exp_f32 v201, v201
    v_exp_f32 v202, v202
    v_smfmac_f32_32x32x32_bf16 v[232:247], v[132:135], v[224:231], v254
    v_exp_f32 v203, v203
    v_exp_f32 v204, v204
    v_exp_f32 v205, v205
    v_mfma_f32_32x32x16_bf16 v[216:231], v[44:47], v[248:251], 0
    s_nop 0
    v_exp_f32 v206, v206
    v_exp_f32 v207, v207
    v_exp_f32 v208, v208
    v_exp_f32 v209, v209
    v_exp_f32 v210, v210
    v_exp_f32 v211, v211
    v_exp_f32 v212, v212
    v_exp_f32 v213, v213
    v_exp_f32 v214, v214
    v_exp_f32 v215, v215
    v_smfmac_f32_32x32x32_bf16 v[232:247], v[136:139], v[200:207], v254
    v_exp_f32 v216, v216
    v_exp_f32 v217, v217
    v_exp_f32 v218, v218
    v_smfmac_f32_32x32x32_bf16 v[232:247], v[140:143], v[208:215], v254
    v_exp_f32 v219, v219
    v_exp_f32 v220, v220
    v_exp_f32 v221, v221
    v_mfma_f32_32x32x16_bf16 v[200:215], v[48:51], v[248:251], 0
    s_nop 0
    v_exp_f32 v222, v222
    v_exp_f32 v223, v223
    v_exp_f32 v224, v224
    v_exp_f32 v225, v225
    v_exp_f32 v226, v226
    v_exp_f32 v227, v227
    v_exp_f32 v228, v228
    v_exp_f32 v229, v229
    v_exp_f32 v230, v230
    v_exp_f32 v231, v231
    v_smfmac_f32_32x32x32_bf16 v[232:247], v[144:147], v[216:223], v254
    v_exp_f32 v200, v200
    v_exp_f32 v201, v201
    v_exp_f32 v202, v202
    v_smfmac_f32_32x32x32_bf16 v[232:247], v[148:151], v[224:231], v254
    v_exp_f32 v203, v203
    v_exp_f32 v204, v204
    v_exp_f32 v205, v205
    v_mfma_f32_32x32x16_bf16 v[216:231], v[52:55], v[248:251], 0
    s_nop 0
    v_exp_f32 v206, v206
    v_exp_f32 v207, v207
    v_exp_f32 v208, v208
    v_exp_f32 v209, v209
    v_exp_f32 v210, v210
    v_exp_f32 v211, v211
    v_exp_f32 v212, v212
    v_exp_f32 v213, v213
    v_exp_f32 v214, v214
    v_exp_f32 v215, v215
    v_smfmac_f32_32x32x32_bf16 v[232:247], v[152:155], v[200:207], v254
    v_exp_f32 v216, v216
    v_exp_f32 v217, v217
    v_exp_f32 v218, v218
    v_smfmac_f32_32x32x32_bf16 v[232:247], v[156:159], v[208:215], v254
    v_exp_f32 v219, v219
    v_exp_f32 v220, v220
    v_exp_f32 v221, v221
    v_mfma_f32_32x32x16_bf16 v[200:215], v[56:59], v[248:251], 0
    s_nop 0
    v_exp_f32 v222, v222
    v_exp_f32 v223, v223
    v_exp_f32 v224, v224
    v_exp_f32 v225, v225
    v_exp_f32 v226, v226
    v_exp_f32 v227, v227
    v_exp_f32 v228, v228
    v_exp_f32 v229, v229
    v_exp_f32 v230, v230
    v_exp_f32 v231, v231
    v_smfmac_f32_32x32x32_bf16 v[232:247], v[160:163], v[216:223], v254
    v_exp_f32 v200, v200
    v_exp_f32 v201, v201
    v_exp_f32 v202, v202
    v_smfmac_f32_32x32x32_bf16 v[232:247], v[164:167], v[224:231], v254
    v_exp_f32 v203, v203
    v_exp_f32 v204, v204
    v_exp_f32 v205, v205
    v_mfma_f32_32x32x16_bf16 v[216:231], v[60:63], v[248:251], 0
    s_nop 0
    v_exp_f32 v206, v206
    v_exp_f32 v207, v207
    v_exp_f32 v208, v208
    v_exp_f32 v209, v209
    v_exp_f32 v210, v210
    v_exp_f32 v211, v211
    v_exp_f32 v212, v212
    v_exp_f32 v213, v213
    v_exp_f32 v214, v214
    v_exp_f32 v215, v215
    v_smfmac_f32_32x32x32_bf16 v[232:247], v[168:171], v[200:207], v254
    v_exp_f32 v216, v216
    v_exp_f32 v217, v217
    v_exp_f32 v218, v218
    v_smfmac_f32_32x32x32_bf16 v[232:247], v[172:175], v[208:215], v254
    v_exp_f32 v219, v219
    v_exp_f32 v220, v220
    v_exp_f32 v221, v221
    v_mfma_f32_32x32x16_bf16 v[200:215], v[64:67], v[248:251], 0
    s_nop 0
    v_exp_f32 v222, v222
    v_exp_f32 v223, v223
    v_exp_f32 v224, v224
    v_exp_f32 v225, v225
    v_exp_f32 v226, v226
    v_exp_f32 v227, v227
    v_exp_f32 v228, v228
    v_exp_f32 v229, v229
    v_exp_f32 v230, v230
    v_exp_f32 v231, v231
    v_smfmac_f32_32x32x32_bf16 v[232:247], v[176:179], v[216:223], v254
    v_exp_f32 v200, v200
    v_exp_f32 v201, v201
    v_exp_f32 v202, v202
    v_smfmac_f32_32x32x32_bf16 v[232:247], v[180:183], v[224:231], v254
    v_exp_f32 v203, v203
    v_exp_f32 v204, v204
    v_exp_f32 v205, v205
    v_mfma_f32_32x32x16_bf16 v[216:231], v[68:71], v[248:251], 0
    ds_read_b128 v[248:251], v252 offset:4096
    v_exp_f32 v206, v206
    v_exp_f32 v207, v207
    v_exp_f32 v208, v208
    v_exp_f32 v209, v209
    v_exp_f32 v210, v210
    v_exp_f32 v211, v211
    v_exp_f32 v212, v212
    v_exp_f32 v213, v213
    v_exp_f32 v214, v214
    v_exp_f32 v215, v215
    v_smfmac_f32_32x32x32_bf16 v[232:247], v[184:187], v[200:207], v254
    v_exp_f32 v216, v216
    v_exp_f32 v217, v217
    v_exp_f32 v218, v218
    v_smfmac_f32_32x32x32_bf16 v[232:247], v[188:191], v[208:215], v254
    s_waitcnt lgkmcnt(0)
    v_exp_f32 v219, v219
    v_exp_f32 v220, v220
    v_exp_f32 v221, v221
    v_mfma_f32_32x32x16_bf16 v[200:215], v[8:11], v[248:251], 0
    s_nop 0
    v_exp_f32 v222, v222
    v_exp_f32 v223, v223
    v_exp_f32 v224, v224
    v_exp_f32 v225, v225
    v_exp_f32 v226, v226
    v_exp_f32 v227, v227
    v_exp_f32 v228, v228
    v_exp_f32 v229, v229
    v_exp_f32 v230, v230
    v_exp_f32 v231, v231
    v_smfmac_f32_32x32x32_bf16 v[232:247], v[192:195], v[216:223], v254
    v_exp_f32 v200, v200
    v_exp_f32 v201, v201
    v_exp_f32 v202, v202
    v_smfmac_f32_32x32x32_bf16 v[232:247], v[196:199], v[224:231], v254
    v_exp_f32 v203, v203
    v_exp_f32 v204, v204
    v_exp_f32 v205, v205
    v_mfma_f32_32x32x16_bf16 v[216:231], v[12:15], v[248:251], 0
    s_nop 0
    v_exp_f32 v206, v206
    v_exp_f32 v207, v207
    v_exp_f32 v208, v208
    v_exp_f32 v209, v209
    v_exp_f32 v210, v210
    v_exp_f32 v211, v211
    v_exp_f32 v212, v212
    ds_write_b128 v5, v[232:235] offset:6144
    ds_write_b128 v5, v[236:239] offset:7168
    ds_write_b32 v6, v240 offset:1536
    v_mov_b64 v[232:233], 0
    v_mov_b64 v[234:235], 0
    v_mov_b64 v[236:237], 0
    v_mov_b64 v[238:239], 0
    v_mov_b64 v[240:241], 0
    v_exp_f32 v213, v213
    v_exp_f32 v214, v214
    v_exp_f32 v215, v215
    v_smfmac_f32_32x32x32_bf16 v[232:247], v[72:75], v[200:207], v254
    v_exp_f32 v216, v216
    v_exp_f32 v217, v217
    v_exp_f32 v218, v218
    v_smfmac_f32_32x32x32_bf16 v[232:247], v[76:79], v[208:215], v254
    v_exp_f32 v219, v219
    v_exp_f32 v220, v220
    v_exp_f32 v221, v221
    v_mfma_f32_32x32x16_bf16 v[200:215], v[16:19], v[248:251], 0
    s_nop 0
    v_exp_f32 v222, v222
    v_exp_f32 v223, v223
    v_exp_f32 v224, v224
    v_exp_f32 v225, v225
    v_exp_f32 v226, v226
    v_exp_f32 v227, v227
    v_exp_f32 v228, v228
    v_exp_f32 v229, v229
    v_exp_f32 v230, v230
    v_exp_f32 v231, v231
    v_smfmac_f32_32x32x32_bf16 v[232:247], v[80:83], v[216:223], v254
    v_exp_f32 v200, v200
    v_exp_f32 v201, v201
    v_exp_f32 v202, v202
    v_smfmac_f32_32x32x32_bf16 v[232:247], v[84:87], v[224:231], v254
    v_exp_f32 v203, v203
    v_exp_f32 v204, v204
    v_exp_f32 v205, v205
    v_mfma_f32_32x32x16_bf16 v[216:231], v[20:23], v[248:251], 0
    s_nop 0
    v_exp_f32 v206, v206
    v_exp_f32 v207, v207
    v_exp_f32 v208, v208
    v_exp_f32 v209, v209
    v_exp_f32 v210, v210
    v_exp_f32 v211, v211
    v_exp_f32 v212, v212
    v_exp_f32 v213, v213
    v_exp_f32 v214, v214
    v_exp_f32 v215, v215
    v_smfmac_f32_32x32x32_bf16 v[232:247], v[88:91], v[200:207], v254
    v_exp_f32 v216, v216
    v_exp_f32 v217, v217
    v_exp_f32 v218, v218
    v_smfmac_f32_32x32x32_bf16 v[232:247], v[92:95], v[208:215], v254
    v_exp_f32 v219, v219
    v_exp_f32 v220, v220
    v_exp_f32 v221, v221
    v_mfma_f32_32x32x16_bf16 v[200:215], v[24:27], v[248:251], 0
    s_nop 0
    v_exp_f32 v222, v222
    v_exp_f32 v223, v223
    v_exp_f32 v224, v224
    v_exp_f32 v225, v225
    v_exp_f32 v226, v226
    v_exp_f32 v227, v227
    v_exp_f32 v228, v228
    v_exp_f32 v229, v229
    v_exp_f32 v230, v230
    v_exp_f32 v231, v231
    v_smfmac_f32_32x32x32_bf16 v[232:247], v[96:99], v[216:223], v254
    v_exp_f32 v200, v200
    v_exp_f32 v201, v201
    v_exp_f32 v202, v202
    v_smfmac_f32_32x32x32_bf16 v[232:247], v[100:103], v[224:231], v254
    v_exp_f32 v203, v203
    v_exp_f32 v204, v204
    v_exp_f32 v205, v205
    v_mfma_f32_32x32x16_bf16 v[216:231], v[28:31], v[248:251], 0
    s_nop 0
    v_exp_f32 v206, v206
    v_exp_f32 v207, v207
    v_exp_f32 v208, v208
    v_exp_f32 v209, v209
    v_exp_f32 v210, v210
    v_exp_f32 v211, v211
    v_exp_f32 v212, v212
    v_exp_f32 v213, v213
    v_exp_f32 v214, v214
    v_exp_f32 v215, v215
    v_smfmac_f32_32x32x32_bf16 v[232:247], v[104:107], v[200:207], v254
    v_exp_f32 v216, v216
    v_exp_f32 v217, v217
    v_exp_f32 v218, v218
    v_smfmac_f32_32x32x32_bf16 v[232:247], v[108:111], v[208:215], v254
    v_exp_f32 v219, v219
    v_exp_f32 v220, v220
    v_exp_f32 v221, v221
    v_mfma_f32_32x32x16_bf16 v[200:215], v[32:35], v[248:251], 0
    s_nop 0
    v_exp_f32 v222, v222
    v_exp_f32 v223, v223
    v_exp_f32 v224, v224
    v_exp_f32 v225, v225
    v_exp_f32 v226, v226
    v_exp_f32 v227, v227
    v_exp_f32 v228, v228
    v_exp_f32 v229, v229
    v_exp_f32 v230, v230
    v_exp_f32 v231, v231
    v_smfmac_f32_32x32x32_bf16 v[232:247], v[112:115], v[216:223], v254
    v_exp_f32 v200, v200
    v_exp_f32 v201, v201
    v_exp_f32 v202, v202
    v_smfmac_f32_32x32x32_bf16 v[232:247], v[116:119], v[224:231], v254
    v_exp_f32 v203, v203
    v_exp_f32 v204, v204
    v_exp_f32 v205, v205
    v_mfma_f32_32x32x16_bf16 v[216:231], v[36:39], v[248:251], 0
    s_nop 0
    v_exp_f32 v206, v206
    v_exp_f32 v207, v207
    v_exp_f32 v208, v208
    v_exp_f32 v209, v209
    v_exp_f32 v210, v210
    v_exp_f32 v211, v211
    v_exp_f32 v212, v212
    v_exp_f32 v213, v213
    v_exp_f32 v214, v214
    v_exp_f32 v215, v215
    v_smfmac_f32_32x32x32_bf16 v[232:247], v[120:123], v[200:207], v254
    v_exp_f32 v216, v216
    v_exp_f32 v217, v217
    v_exp_f32 v218, v218
    v_smfmac_f32_32x32x32_bf16 v[232:247], v[124:127], v[208:215], v254
    v_exp_f32 v219, v219
    v_exp_f32 v220, v220
    v_exp_f32 v221, v221
    v_mfma_f32_32x32x16_bf16 v[200:215], v[40:43], v[248:251], 0
    s_nop 0
    v_exp_f32 v222, v222
    v_exp_f32 v223, v223
    v_exp_f32 v224, v224
    v_exp_f32 v225, v225
    v_exp_f32 v226, v226
    v_exp_f32 v227, v227
    v_exp_f32 v228, v228
    v_exp_f32 v229, v229
    v_exp_f32 v230, v230
    v_exp_f32 v231, v231
    v_smfmac_f32_32x32x32_bf16 v[232:247], v[128:131], v[216:223], v254
    v_exp_f32 v200, v200
    v_exp_f32 v201, v201
    v_exp_f32 v202, v202
    v_smfmac_f32_32x32x32_bf16 v[232:247], v[132:135], v[224:231], v254
    v_exp_f32 v203, v203
    v_exp_f32 v204, v204
    v_exp_f32 v205, v205
    v_mfma_f32_32x32x16_bf16 v[216:231], v[44:47], v[248:251], 0
    s_nop 0
    v_exp_f32 v206, v206
    v_exp_f32 v207, v207
    v_exp_f32 v208, v208
    v_exp_f32 v209, v209
    v_exp_f32 v210, v210
    v_exp_f32 v211, v211
    v_exp_f32 v212, v212
    v_exp_f32 v213, v213
    v_exp_f32 v214, v214
    v_exp_f32 v215, v215
    v_smfmac_f32_32x32x32_bf16 v[232:247], v[136:139], v[200:207], v254
    v_exp_f32 v216, v216
    v_exp_f32 v217, v217
    v_exp_f32 v218, v218
    v_smfmac_f32_32x32x32_bf16 v[232:247], v[140:143], v[208:215], v254
    v_exp_f32 v219, v219
    v_exp_f32 v220, v220
    v_exp_f32 v221, v221
    v_mfma_f32_32x32x16_bf16 v[200:215], v[48:51], v[248:251], 0
    s_nop 0
    v_exp_f32 v222, v222
    v_exp_f32 v223, v223
    v_exp_f32 v224, v224
    v_exp_f32 v225, v225
    v_exp_f32 v226, v226
    v_exp_f32 v227, v227
    v_exp_f32 v228, v228
    v_exp_f32 v229, v229
    v_exp_f32 v230, v230
    v_exp_f32 v231, v231
    v_smfmac_f32_32x32x32_bf16 v[232:247], v[144:147], v[216:223], v254
    v_exp_f32 v200, v200
    v_exp_f32 v201, v201
    v_exp_f32 v202, v202
    v_smfmac_f32_32x32x32_bf16 v[232:247], v[148:151], v[224:231], v254
    v_exp_f32 v203, v203
    v_exp_f32 v204, v204
    v_exp_f32 v205, v205
    v_mfma_f32_32x32x16_bf16 v[216:231], v[52:55], v[248:251], 0
    s_nop 0
    v_exp_f32 v206, v206
    v_exp_f32 v207, v207
    v_exp_f32 v208, v208
    v_exp_f32 v209, v209
    v_exp_f32 v210, v210
    v_exp_f32 v211, v211
    v_exp_f32 v212, v212
    v_exp_f32 v213, v213
    v_exp_f32 v214, v214
    v_exp_f32 v215, v215
    v_smfmac_f32_32x32x32_bf16 v[232:247], v[152:155], v[200:207], v254
    v_exp_f32 v216, v216
    v_exp_f32 v217, v217
    v_exp_f32 v218, v218
    v_smfmac_f32_32x32x32_bf16 v[232:247], v[156:159], v[208:215], v254
    v_exp_f32 v219, v219
    v_exp_f32 v220, v220
    v_exp_f32 v221, v221
    v_mfma_f32_32x32x16_bf16 v[200:215], v[56:59], v[248:251], 0
    s_nop 0
    v_exp_f32 v222, v222
    v_exp_f32 v223, v223
    v_exp_f32 v224, v224
    v_exp_f32 v225, v225
    v_exp_f32 v226, v226
    v_exp_f32 v227, v227
    v_exp_f32 v228, v228
    v_exp_f32 v229, v229
    v_exp_f32 v230, v230
    v_exp_f32 v231, v231
    v_smfmac_f32_32x32x32_bf16 v[232:247], v[160:163], v[216:223], v254
    v_exp_f32 v200, v200
    v_exp_f32 v201, v201
    v_exp_f32 v202, v202
    v_smfmac_f32_32x32x32_bf16 v[232:247], v[164:167], v[224:231], v254
    v_exp_f32 v203, v203
    v_exp_f32 v204, v204
    v_exp_f32 v205, v205
    v_mfma_f32_32x32x16_bf16 v[216:231], v[60:63], v[248:251], 0
    ds_read_b32 v3, v7 offset:352
    v_exp_f32 v206, v206
    v_exp_f32 v207, v207
    v_exp_f32 v208, v208
    v_exp_f32 v209, v209
    v_exp_f32 v210, v210
    v_exp_f32 v211, v211
    v_exp_f32 v212, v212
    v_exp_f32 v213, v213
    v_exp_f32 v214, v214
    v_exp_f32 v215, v215
    v_smfmac_f32_32x32x32_bf16 v[232:247], v[168:171], v[200:207], v254
    v_exp_f32 v216, v216
    v_exp_f32 v217, v217
    v_exp_f32 v218, v218
    v_smfmac_f32_32x32x32_bf16 v[232:247], v[172:175], v[208:215], v254
    v_exp_f32 v219, v219
    v_exp_f32 v220, v220
    v_exp_f32 v221, v221
    v_mfma_f32_32x32x16_bf16 v[200:215], v[64:67], v[248:251], 0
    s_waitcnt lgkmcnt(0)
    v_exp_f32 v222, v222
    v_exp_f32 v223, v223
    v_exp_f32 v224, v224
    v_exp_f32 v225, v225
    v_exp_f32 v226, v226
    v_exp_f32 v227, v227
    v_exp_f32 v228, v228
    v_cmp_ne_u32 vcc, 1, v3
    v_exp_f32 v229, v229
    v_exp_f32 v230, v230
    s_and_b64 vcc, vcc, 1
    s_cbranch_vccnz L_f0slow
L_f0ok:
    v_exp_f32 v231, v231
    v_smfmac_f32_32x32x32_bf16 v[232:247], v[176:179], v[216:223], v254
    v_exp_f32 v200, v200
    v_exp_f32 v201, v201
    v_exp_f32 v202, v202
    v_smfmac_f32_32x32x32_bf16 v[232:247], v[180:183], v[224:231], v254
    v_exp_f32 v203, v203
    v_exp_f32 v204, v204
    v_exp_f32 v205, v205
    v_mfma_f32_32x32x16_bf16 v[216:231], v[68:71], v[248:251], 0
    ds_read_b128 v[248:251], v252 offset:5120
    v_exp_f32 v206, v206
    v_exp_f32 v207, v207
    v_exp_f32 v208, v208
    v_exp_f32 v209, v209
    v_exp_f32 v210, v210
    v_exp_f32 v211, v211
    v_exp_f32 v212, v212
    v_exp_f32 v213, v213
    v_exp_f32 v214, v214
    v_exp_f32 v215, v215
    v_smfmac_f32_32x32x32_bf16 v[232:247], v[184:187], v[200:207], v254
    v_exp_f32 v216, v216
    v_exp_f32 v217, v217
    v_exp_f32 v218, v218
    v_smfmac_f32_32x32x32_bf16 v[232:247], v[188:191], v[208:215], v254
    s_waitcnt lgkmcnt(0)
    v_exp_f32 v219, v219
    v_exp_f32 v220, v220
    v_exp_f32 v221, v221
    v_mfma_f32_32x32x16_bf16 v[200:215], v[8:11], v[248:251], 0
    s_nop 0
    v_exp_f32 v222, v222
    v_exp_f32 v223, v223
    v_exp_f32 v224, v224
    v_exp_f32 v225, v225
    v_exp_f32 v226, v226
    v_exp_f32 v227, v227
    v_exp_f32 v228, v228
    v_exp_f32 v229, v229
    v_exp_f32 v230, v230
    v_exp_f32 v231, v231
    v_smfmac_f32_32x32x32_bf16 v[232:247], v[192:195], v[216:223], v254
    v_exp_f32 v200, v200
    v_exp_f32 v201, v201
    v_exp_f32 v202, v202
    v_smfmac_f32_32x32x32_bf16 v[232:247], v[196:199], v[224:231], v254
    v_exp_f32 v203, v203
    v_exp_f32 v204, v204
    v_exp_f32 v205, v205
    v_mfma_f32_32x32x16_bf16 v[216:231], v[12:15], v[248:251], 0
    s_nop 0
    v_exp_f32 v206, v206
    v_exp_f32 v207, v207
    v_exp_f32 v208, v208
    v_exp_f32 v209, v209
    v_exp_f32 v210, v210
    v_exp_f32 v211, v211
    v_exp_f32 v212, v212
    ds_write_b128 v5, v[232:235]
    ds_write_b128 v5, v[236:239] offset:1024
    ds_write_b32 v6, v240 offset:2048
    v_mov_b64 v[232:233], 0
    v_mov_b64 v[234:235], 0
    v_mov_b64 v[236:237], 0
    v_mov_b64 v[238:239], 0
    v_mov_b64 v[240:241], 0
    v_exp_f32 v213, v213
    v_exp_f32 v214, v214
    v_exp_f32 v215, v215
    v_smfmac_f32_32x32x32_bf16 v[232:247], v[72:75], v[200:207], v254
    v_exp_f32 v216, v216
    v_exp_f32 v217, v217
    v_exp_f32 v218, v218
    v_smfmac_f32_32x32x32_bf16 v[232:247], v[76:79], v[208:215], v254
    v_exp_f32 v219, v219
    v_exp_f32 v220, v220
    v_exp_f32 v221, v221
    v_mfma_f32_32x32x16_bf16 v[200:215], v[16:19], v[248:251], 0
    s_nop 0
    v_exp_f32 v222, v222
    v_exp_f32 v223, v223
    v_exp_f32 v224, v224
    v_exp_f32 v225, v225
    v_exp_f32 v226, v226
    v_exp_f32 v227, v227
    v_exp_f32 v228, v228
    v_exp_f32 v229, v229
    v_exp_f32 v230, v230
    v_exp_f32 v231, v231
    v_smfmac_f32_32x32x32_bf16 v[232:247], v[80:83], v[216:223], v254
    v_exp_f32 v200, v200
    v_exp_f32 v201, v201
    v_exp_f32 v202, v202
    v_smfmac_f32_32x32x32_bf16 v[232:247], v[84:87], v[224:231], v254
    v_exp_f32 v203, v203
    v_exp_f32 v204, v204
    v_exp_f32 v205, v205
    v_mfma_f32_32x32x16_bf16 v[216:231], v[20:23], v[248:251], 0
    s_nop 0
    v_exp_f32 v206, v206
    v_exp_f32 v207, v207
    v_exp_f32 v208, v208
    v_exp_f32 v209, v209
    v_exp_f32 v210, v210
    v_exp_f32 v211, v211
    v_exp_f32 v212, v212
    v_exp_f32 v213, v213
    v_exp_f32 v214, v214
    v_exp_f32 v215, v215
    v_smfmac_f32_32x32x32_bf16 v[232:247], v[88:91], v[200:207], v254
    v_exp_f32 v216, v216
    v_exp_f32 v217, v217
    v_exp_f32 v218, v218
    v_smfmac_f32_32x32x32_bf16 v[232:247], v[92:95], v[208:215], v254
    v_exp_f32 v219, v219
    v_exp_f32 v220, v220
    v_exp_f32 v221, v221
    v_mfma_f32_32x32x16_bf16 v[200:215], v[24:27], v[248:251], 0
    s_nop 0
    v_exp_f32 v222, v222
    v_exp_f32 v223, v223
    v_exp_f32 v224, v224
    v_exp_f32 v225, v225
    v_exp_f32 v226, v226
    v_exp_f32 v227, v227
    v_exp_f32 v228, v228
    v_exp_f32 v229, v229
    v_exp_f32 v230, v230
    v_exp_f32 v231, v231
    v_smfmac_f32_32x32x32_bf16 v[232:247], v[96:99], v[216:223], v254
    v_exp_f32 v200, v200
    v_exp_f32 v201, v201
    v_exp_f32 v202, v202
    v_smfmac_f32_32x32x32_bf16 v[232:247], v[100:103], v[224:231], v254
    v_exp_f32 v203, v203
    v_exp_f32 v204, v204
    v_exp_f32 v205, v205
    v_mfma_f32_32x32x16_bf16 v[216:231], v[28:31], v[248:251], 0
    s_nop 0
    v_exp_f32 v206, v206
    v_exp_f32 v207, v207
    v_exp_f32 v208, v208
    v_exp_f32 v209, v209
    v_exp_f32 v210, v210
    v_exp_f32 v211, v211
    v_exp_f32 v212, v212
    v_exp_f32 v213, v213
    v_exp_f32 v214, v214
    v_exp_f32 v215, v215
    v_smfmac_f32_32x32x32_bf16 v[232:247], v[104:107], v[200:207], v254
    v_exp_f32 v216, v216
    v_exp_f32 v217, v217
    v_exp_f32 v218, v218
    v_smfmac_f32_32x32x32_bf16 v[232:247], v[108:111], v[208:215], v254
    v_exp_f32 v219, v219
    v_exp_f32 v220, v220
    v_exp_f32 v221, v221
    v_mfma_f32_32x32x16_bf16 v[200:215], v[32:35], v[248:251], 0
    s_nop 0
    v_exp_f32 v222, v222
    v_exp_f32 v223, v223
    v_exp_f32 v224, v224
    v_exp_f32 v225, v225
    v_exp_f32 v226, v226
    v_exp_f32 v227, v227
    v_exp_f32 v228, v228
    v_exp_f32 v229, v229
    v_exp_f32 v230, v230
    v_exp_f32 v231, v231
    v_smfmac_f32_32x32x32_bf16 v[232:247], v[112:115], v[216:223], v254
    v_exp_f32 v200, v200
    v_exp_f32 v201, v201
    v_exp_f32 v202, v202
    v_smfmac_f32_32x32x32_bf16 v[232:247], v[116:119], v[224:231], v254
    v_exp_f32 v203, v203
    v_exp_f32 v204, v204
    v_exp_f32 v205, v205
    v_mfma_f32_32x32x16_bf16 v[216:231], v[36:39], v[248:251], 0
    s_nop 0
    v_exp_f32 v206, v206
    v_exp_f32 v207, v207
    v_exp_f32 v208, v208
    v_exp_f32 v209, v209
    v_exp_f32 v210, v210
    v_exp_f32 v211, v211
    v_exp_f32 v212, v212
    v_exp_f32 v213, v213
    v_exp_f32 v214, v214
    v_exp_f32 v215, v215
    v_smfmac_f32_32x32x32_bf16 v[232:247], v[120:123], v[200:207], v254
    v_exp_f32 v216, v216
    v_exp_f32 v217, v217
    v_exp_f32 v218, v218
    v_smfmac_f32_32x32x32_bf16 v[232:247], v[124:127], v[208:215], v254
    v_exp_f32 v219, v219
    v_exp_f32 v220, v220
    v_exp_f32 v221, v221
    v_mfma_f32_32x32x16_bf16 v[200:215], v[40:43], v[248:251], 0
    s_nop 0
    v_exp_f32 v222, v222
    v_exp_f32 v223, v223
    v_exp_f32 v224, v224
    v_exp_f32 v225, v225
    v_exp_f32 v226, v226
    v_exp_f32 v227, v227
    v_exp_f32 v228, v228
    v_exp_f32 v229, v229
    v_exp_f32 v230, v230
    v_exp_f32 v231, v231
    v_smfmac_f32_32x32x32_bf16 v[232:247], v[128:131], v[216:223], v254
    v_exp_f32 v200, v200
    v_exp_f32 v201, v201
    v_exp_f32 v202, v202
    v_smfmac_f32_32x32x32_bf16 v[232:247], v[132:135], v[224:231], v254
    v_exp_f32 v203, v203
    v_exp_f32 v204, v204
    v_exp_f32 v205, v205
    v_mfma_f32_32x32x16_bf16 v[216:231], v[44:47], v[248:251], 0
    s_nop 0
    v_exp_f32 v206, v206
    v_exp_f32 v207, v207
    v_exp_f32 v208, v208
    v_exp_f32 v209, v209
    v_exp_f32 v210, v210
    v_exp_f32 v211, v211
    v_exp_f32 v212, v212
    v_exp_f32 v213, v213
    v_exp_f32 v214, v214
    v_exp_f32 v215, v215
    v_smfmac_f32_32x32x32_bf16 v[232:247], v[136:139], v[200:207], v254
    v_exp_f32 v216, v216
    v_exp_f32 v217, v217
    v_exp_f32 v218, v218
    v_smfmac_f32_32x32x32_bf16 v[232:247], v[140:143], v[208:215], v254
    v_exp_f32 v219, v219
    v_exp_f32 v220, v220
    v_exp_f32 v221, v221
    v_mfma_f32_32x32x16_bf16 v[200:215], v[48:51], v[248:251], 0
    s_nop 0
    v_exp_f32 v222, v222
    v_exp_f32 v223, v223
    v_exp_f32 v224, v224
    v_exp_f32 v225, v225
    v_exp_f32 v226, v226
    v_exp_f32 v227, v227
    v_exp_f32 v228, v228
    v_exp_f32 v229, v229
    v_exp_f32 v230, v230
    v_exp_f32 v231, v231
    v_smfmac_f32_32x32x32_bf16 v[232:247], v[144:147], v[216:223], v254
    v_exp_f32 v200, v200
    v_exp_f32 v201, v201
    v_exp_f32 v202, v202
    v_smfmac_f32_32x32x32_bf16 v[232:247], v[148:151], v[224:231], v254
    v_exp_f32 v203, v203
    v_exp_f32 v204, v204
    v_exp_f32 v205, v205
    v_mfma_f32_32x32x16_bf16 v[216:231], v[52:55], v[248:251], 0
    s_nop 0
    v_exp_f32 v206, v206
    v_exp_f32 v207, v207
    v_exp_f32 v208, v208
    v_exp_f32 v209, v209
    v_exp_f32 v210, v210
    v_exp_f32 v211, v211
    v_exp_f32 v212, v212
    v_exp_f32 v213, v213
    v_exp_f32 v214, v214
    v_exp_f32 v215, v215
    v_smfmac_f32_32x32x32_bf16 v[232:247], v[152:155], v[200:207], v254
    v_exp_f32 v216, v216
    v_exp_f32 v217, v217
    v_exp_f32 v218, v218
    v_smfmac_f32_32x32x32_bf16 v[232:247], v[156:159], v[208:215], v254
    v_exp_f32 v219, v219
    v_exp_f32 v220, v220
    v_exp_f32 v221, v221
    v_mfma_f32_32x32x16_bf16 v[200:215], v[56:59], v[248:251], 0
    s_nop 0
    v_exp_f32 v222, v222
    v_exp_f32 v223, v223
    v_exp_f32 v224, v224
    v_exp_f32 v225, v225
    v_exp_f32 v226, v226
    v_exp_f32 v227, v227
    v_exp_f32 v228, v228
    v_exp_f32 v229, v229
    v_exp_f32 v230, v230
    v_exp_f32 v231, v231
    v_smfmac_f32_32x32x32_bf16 v[232:247], v[160:163], v[216:223], v254
    v_exp_f32 v200, v200
    v_exp_f32 v201, v201
    v_exp_f32 v202, v202
    v_smfmac_f32_32x32x32_bf16 v[232:247], v[164:167], v[224:231], v254
    v_exp_f32 v203, v203
    v_exp_f32 v204, v204
    v_exp_f32 v205, v205
    v_mfma_f32_32x32x16_bf16 v[216:231], v[60:63], v[248:251], 0
    ds_read_b32 v3, v7 offset:352
    v_exp_f32 v206, v206
    v_exp_f32 v207, v207
    v_exp_f32 v208, v208
    v_exp_f32 v209, v209
    v_exp_f32 v210, v210
    v_exp_f32 v211, v211
    v_exp_f32 v212, v212
    v_exp_f32 v213, v213
    v_exp_f32 v214, v214
    v_exp_f32 v215, v215
    v_smfmac_f32_32x32x32_bf16 v[232:247], v[168:171], v[200:207], v254
    v_exp_f32 v216, v216
    v_exp_f32 v217, v217
    v_exp_f32 v218, v218
    v_smfmac_f32_32x32x32_bf16 v[232:247], v[172:175], v[208:215], v254
    v_exp_f32 v219, v219
    v_exp_f32 v220, v220
    v_exp_f32 v221, v221
    v_mfma_f32_32x32x16_bf16 v[200:215], v[64:67], v[248:251], 0
    s_waitcnt lgkmcnt(0)
    v_exp_f32 v222, v222
    v_exp_f32 v223, v223
    v_exp_f32 v224, v224
    v_exp_f32 v225, v225
    v_exp_f32 v226, v226
    v_exp_f32 v227, v227
    v_exp_f32 v228, v228
    v_cmp_ne_u32 vcc, 1, v3
    v_exp_f32 v229, v229
    v_exp_f32 v230, v230
    s_and_b64 vcc, vcc, 6
    s_cbranch_vccnz L_f1slow
L_f1ok:
    v_exp_f32 v231, v231
    v_smfmac_f32_32x32x32_bf16 v[232:247], v[176:179], v[216:223], v254
    v_exp_f32 v200, v200
    v_exp_f32 v201, v201
    v_exp_f32 v202, v202
    v_smfmac_f32_32x32x32_bf16 v[232:247], v[180:183], v[224:231], v254
    v_exp_f32 v203, v203
    v_exp_f32 v204, v204
    v_exp_f32 v205, v205
    v_mfma_f32_32x32x16_bf16 v[216:231], v[68:71], v[248:251], 0
    ds_read_b128 v[248:251], v252 offset:6144
    v_exp_f32 v206, v206
    v_exp_f32 v207, v207
    v_exp_f32 v208, v208
    v_exp_f32 v209, v209
    v_exp_f32 v210, v210
    v_exp_f32 v211, v211
    v_exp_f32 v212, v212
    v_exp_f32 v213, v213
    v_exp_f32 v214, v214
    v_exp_f32 v215, v215
    v_smfmac_f32_32x32x32_bf16 v[232:247], v[184:187], v[200:207], v254
    v_exp_f32 v216, v216
    v_exp_f32 v217, v217
    v_exp_f32 v218, v218
    v_smfmac_f32_32x32x32_bf16 v[232:247], v[188:191], v[208:215], v254
    s_waitcnt lgkmcnt(0)
    v_exp_f32 v219, v219
    v_exp_f32 v220, v220
    v_exp_f32 v221, v221
    v_mfma_f32_32x32x16_bf16 v[200:215], v[8:11], v[248:251], 0
    s_nop 0
    v_exp_f32 v222, v222
    v_exp_f32 v223, v223
    v_exp_f32 v224, v224
    v_exp_f32 v225, v225
    v_exp_f32 v226, v226
    v_exp_f32 v227, v227
    v_exp_f32 v228, v228
    v_exp_f32 v229, v229
    v_exp_f32 v230, v230
    v_exp_f32 v231, v231
    v_smfmac_f32_32x32x32_bf16 v[232:247], v[192:195], v[216:223], v254
    v_exp_f32 v200, v200
    v_exp_f32 v201, v201
    v_exp_f32 v202, v202
    v_smfmac_f32_32x32x32_bf16 v[232:247], v[196:199], v[224:231], v254
    v_exp_f32 v203, v203
    v_exp_f32 v204, v204
    v_exp_f32 v205, v205
    v_mfma_f32_32x32x16_bf16 v[216:231], v[12:15], v[248:251], 0
    s_nop 0
    v_exp_f32 v206, v206
    v_exp_f32 v207, v207
    v_exp_f32 v208, v208
    v_exp_f32 v209, v209
    v_exp_f32 v210, v210
    v_exp_f32 v211, v211
    v_exp_f32 v212, v212
    ds_write_b128 v5, v[232:235] offset:2048
    ds_write_b128 v5, v[236:239] offset:3072
    ds_write_b32 v6, v240 offset:2560
    v_mov_b64 v[232:233], 0
    v_mov_b64 v[234:235], 0
    v_mov_b64 v[236:237], 0
    v_mov_b64 v[238:239], 0
    v_mov_b64 v[240:241], 0
    v_exp_f32 v213, v213
    v_exp_f32 v214, v214
    v_exp_f32 v215, v215
    v_smfmac_f32_32x32x32_bf16 v[232:247], v[72:75], v[200:207], v254
    v_exp_f32 v216, v216
    v_exp_f32 v217, v217
    v_exp_f32 v218, v218
    v_smfmac_f32_32x32x32_bf16 v[232:247], v[76:79], v[208:215], v254
    v_exp_f32 v219, v219
    v_exp_f32 v220, v220
    v_exp_f32 v221, v221
    v_mfma_f32_32x32x16_bf16 v[200:215], v[16:19], v[248:251], 0
    s_nop 0
    v_exp_f32 v222, v222
    v_exp_f32 v223, v223
    v_exp_f32 v224, v224
    v_exp_f32 v225, v225
    v_exp_f32 v226, v226
    v_exp_f32 v227, v227
    v_exp_f32 v228, v228
    v_exp_f32 v229, v229
    v_exp_f32 v230, v230
    v_exp_f32 v231, v231
    v_smfmac_f32_32x32x32_bf16 v[232:247], v[80:83], v[216:223], v254
    v_exp_f32 v200, v200
    v_exp_f32 v201, v201
    v_exp_f32 v202, v202
    v_smfmac_f32_32x32x32_bf16 v[232:247], v[84:87], v[224:231], v254
    v_exp_f32 v203, v203
    v_exp_f32 v204, v204
    v_exp_f32 v205, v205
    v_mfma_f32_32x32x16_bf16 v[216:231], v[20:23], v[248:251], 0
    s_nop 0
    v_exp_f32 v206, v206
    v_exp_f32 v207, v207
    v_exp_f32 v208, v208
    v_exp_f32 v209, v209
    v_exp_f32 v210, v210
    v_exp_f32 v211, v211
    v_exp_f32 v212, v212
    v_exp_f32 v213, v213
    v_exp_f32 v214, v214
    v_exp_f32 v215, v215
    v_smfmac_f32_32x32x32_bf16 v[232:247], v[88:91], v[200:207], v254
    v_exp_f32 v216, v216
    v_exp_f32 v217, v217
    v_exp_f32 v218, v218
    v_smfmac_f32_32x32x32_bf16 v[232:247], v[92:95], v[208:215], v254
    v_exp_f32 v219, v219
    v_exp_f32 v220, v220
    v_exp_f32 v221, v221
    v_mfma_f32_32x32x16_bf16 v[200:215], v[24:27], v[248:251], 0
    s_nop 0
    v_exp_f32 v222, v222
    v_exp_f32 v223, v223
    v_exp_f32 v224, v224
    v_exp_f32 v225, v225
    v_exp_f32 v226, v226
    v_exp_f32 v227, v227
    v_exp_f32 v228, v228
    v_exp_f32 v229, v229
    v_exp_f32 v230, v230
    v_exp_f32 v231, v231
    v_smfmac_f32_32x32x32_bf16 v[232:247], v[96:99], v[216:223], v254
    v_exp_f32 v200, v200
    v_exp_f32 v201, v201
    v_exp_f32 v202, v202
    v_smfmac_f32_32x32x32_bf16 v[232:247], v[100:103], v[224:231], v254
    v_exp_f32 v203, v203
    v_exp_f32 v204, v204
    v_exp_f32 v205, v205
    v_mfma_f32_32x32x16_bf16 v[216:231], v[28:31], v[248:251], 0
    s_nop 0
    v_exp_f32 v206, v206
    v_exp_f32 v207, v207
    v_exp_f32 v208, v208
    v_exp_f32 v209, v209
    v_exp_f32 v210, v210
    v_exp_f32 v211, v211
    v_exp_f32 v212, v212
    v_exp_f32 v213, v213
    v_exp_f32 v214, v214
    v_exp_f32 v215, v215
    v_smfmac_f32_32x32x32_bf16 v[232:247], v[104:107], v[200:207], v254
    v_exp_f32 v216, v216
    v_exp_f32 v217, v217
    v_exp_f32 v218, v218
    v_smfmac_f32_32x32x32_bf16 v[232:247], v[108:111], v[208:215], v254
    v_exp_f32 v219, v219
    v_exp_f32 v220, v220
    v_exp_f32 v221, v221
    v_mfma_f32_32x32x16_bf16 v[200:215], v[32:35], v[248:251], 0
    s_nop 0
    v_exp_f32 v222, v222
    v_exp_f32 v223, v223
    v_exp_f32 v224, v224
    v_exp_f32 v225, v225
    v_exp_f32 v226, v226
    v_exp_f32 v227, v227
    v_exp_f32 v228, v228
    v_exp_f32 v229, v229
    v_exp_f32 v230, v230
    v_exp_f32 v231, v231
    v_smfmac_f32_32x32x32_bf16 v[232:247], v[112:115], v[216:223], v254
    v_exp_f32 v200, v200
    v_exp_f32 v201, v201
    v_exp_f32 v202, v202
    v_smfmac_f32_32x32x32_bf16 v[232:247], v[116:119], v[224:231], v254
    v_exp_f32 v203, v203
    v_exp_f32 v204, v204
    v_exp_f32 v205, v205
    v_mfma_f32_32x32x16_bf16 v[216:231], v[36:39], v[248:251], 0
    s_nop 0
    v_exp_f32 v206, v206
    v_exp_f32 v207, v207
    v_exp_f32 v208, v208
    v_exp_f32 v209, v209
    v_exp_f32 v210, v210
    v_exp_f32 v211, v211
    v_exp_f32 v212, v212
    v_exp_f32 v213, v213
    v_exp_f32 v214, v214
    v_exp_f32 v215, v215
    v_smfmac_f32_32x32x32_bf16 v[232:247], v[120:123], v[200:207], v254
    v_exp_f32 v216, v216
    v_exp_f32 v217, v217
    v_exp_f32 v218, v218
    v_smfmac_f32_32x32x32_bf16 v[232:247], v[124:127], v[208:215], v254
    v_exp_f32 v219, v219
    v_exp_f32 v220, v220
    v_exp_f32 v221, v221
    v_mfma_f32_32x32x16_bf16 v[200:215], v[40:43], v[248:251], 0
    s_nop 0
    v_exp_f32 v222, v222
    v_exp_f32 v223, v223
    v_exp_f32 v224, v224
    v_exp_f32 v225, v225
    v_exp_f32 v226, v226
    v_exp_f32 v227, v227
    v_exp_f32 v228, v228
    v_exp_f32 v229, v229
    v_exp_f32 v230, v230
    v_exp_f32 v231, v231
    v_smfmac_f32_32x32x32_bf16 v[232:247], v[128:131], v[216:223], v254
    v_exp_f32 v200, v200
    v_exp_f32 v201, v201
    v_exp_f32 v202, v202
    v_smfmac_f32_32x32x32_bf16 v[232:247], v[132:135], v[224:231], v254
    v_exp_f32 v203, v203
    v_exp_f32 v204, v204
    v_exp_f32 v205, v205
    v_mfma_f32_32x32x16_bf16 v[216:231], v[44:47], v[248:251], 0
    s_nop 0
    v_exp_f32 v206, v206
    v_exp_f32 v207, v207
    v_exp_f32 v208, v208
    v_exp_f32 v209, v209
    v_exp_f32 v210, v210
    v_exp_f32 v211, v211
    v_exp_f32 v212, v212
    v_exp_f32 v213, v213
    v_exp_f32 v214, v214
    v_exp_f32 v215, v215
    v_smfmac_f32_32x32x32_bf16 v[232:247], v[136:139], v[200:207], v254
    v_exp_f32 v216, v216
    v_exp_f32 v217, v217
    v_exp_f32 v218, v218
    v_smfmac_f32_32x32x32_bf16 v[232:247], v[140:143], v[208:215], v254
    v_exp_f32 v219, v219
    v_exp_f32 v220, v220
    v_exp_f32 v221, v221
    v_mfma_f32_32x32x16_bf16 v[200:215], v[48:51], v[248:251], 0
    s_nop 0
    v_exp_f32 v222, v222
    v_exp_f32 v223, v223
    v_exp_f32 v224, v224
    v_exp_f32 v225, v225
    v_exp_f32 v226, v226
    v_exp_f32 v227, v227
    v_exp_f32 v228, v228
    v_exp_f32 v229, v229
    v_exp_f32 v230, v230
    v_exp_f32 v231, v231
    v_smfmac_f32_32x32x32_bf16 v[232:247], v[144:147], v[216:223], v254
    v_exp_f32 v200, v200
    v_exp_f32 v201, v201
    v_exp_f32 v202, v202
    v_smfmac_f32_32x32x32_bf16 v[232:247], v[148:151], v[224:231], v254
    v_exp_f32 v203, v203
    v_exp_f32 v204, v204
    v_exp_f32 v205, v205
    v_mfma_f32_32x32x16_bf16 v[216:231], v[52:55], v[248:251], 0
    s_nop 0
    v_exp_f32 v206, v206
    v_exp_f32 v207, v207
    v_exp_f32 v208, v208
    v_exp_f32 v209, v209
    v_exp_f32 v210, v210
    v_exp_f32 v211, v211
    v_exp_f32 v212, v212
    v_exp_f32 v213, v213
    v_exp_f32 v214, v214
    v_exp_f32 v215, v215
    v_smfmac_f32_32x32x32_bf16 v[232:247], v[152:155], v[200:207], v254
    v_exp_f32 v216, v216
    v_exp_f32 v217, v217
    v_exp_f32 v218, v218
    v_smfmac_f32_32x32x32_bf16 v[232:247], v[156:159], v[208:215], v254
    v_exp_f32 v219, v219
    v_exp_f32 v220, v220
    v_exp_f32 v221, v221
    v_mfma_f32_32x32x16_bf16 v[200:215], v[56:59], v[248:251], 0
    s_nop 0
    v_exp_f32 v222, v222
    v_exp_f32 v223, v223
    v_exp_f32 v224, v224
    v_exp_f32 v225, v225
    v_exp_f32 v226, v226
    v_exp_f32 v227, v227
    v_exp_f32 v228, v228
    v_exp_f32 v229, v229
    v_exp_f32 v230, v230
    v_exp_f32 v231, v231
    v_smfmac_f32_32x32x32_bf16 v[232:247], v[160:163], v[216:223], v254
    v_exp_f32 v200, v200
    v_exp_f32 v201, v201
    v_exp_f32 v202, v202
    v_smfmac_f32_32x32x32_bf16 v[232:247], v[164:167], v[224:231], v254
    v_exp_f32 v203, v203
    v_exp_f32 v204, v204
    v_exp_f32 v205, v205
    v_mfma_f32_32x32x16_bf16 v[216:231], v[60:63], v[248:251], 0
    s_nop 0
    v_exp_f32 v206, v206
    v_exp_f32 v207, v207
    v_exp_f32 v208, v208
    v_exp_f32 v209, v209
    v_exp_f32 v210, v210
    v_exp_f32 v211, v211
    v_exp_f32 v212, v212
    v_exp_f32 v213, v213
    v_exp_f32 v214, v214
    v_exp_f32 v215, v215
    v_smfmac_f32_32x32x32_bf16 v[232:247], v[168:171], v[200:207], v254
    v_exp_f32 v216, v216
    v_exp_f32 v217, v217
    v_exp_f32 v218, v218
    v_smfmac_f32_32x32x32_bf16 v[232:247], v[172:175], v[208:215], v254
    v_exp_f32 v219, v219
    v_exp_f32 v220, v220
    v_exp_f32 v221, v221
    v_mfma_f32_32x32x16_bf16 v[200:215], v[64:67], v[248:251], 0
    s_nop 0
    v_exp_f32 v222, v222
    v_exp_f32 v223, v223
    v_exp_f32 v224, v224
    v_exp_f32 v225, v225
    v_exp_f32 v226, v226
    v_exp_f32 v227, v227
    v_exp_f32 v228, v228
    v_exp_f32 v229, v229
    v_exp_f32 v230, v230
    v_exp_f32 v231, v231
    v_smfmac_f32_32x32x32_bf16 v[232:247], v[176:179], v[216:223], v254
    v_exp_f32 v200, v200
    v_exp_f32 v201, v201
    v_exp_f32 v202, v202
    v_smfmac_f32_32x32x32_bf16 v[232:247], v[180:183], v[224:231], v254
    v_exp_f32 v203, v203
    v_exp_f32 v204, v204
    v_exp_f32 v205, v205
    v_mfma_f32_32x32x16_bf16 v[216:231], v[68:71], v[248:251], 0
    ds_read_b128 v[248:251], v252 offset:7168
    v_exp_f32 v206, v206
    v_exp_f32 v207, v207
    v_exp_f32 v208, v208
    v_exp_f32 v209, v209
    v_exp_f32 v210, v210
    v_exp_f32 v211, v211
    v_exp_f32 v212, v212
    v_exp_f32 v213, v213
    v_exp_f32 v214, v214
    v_exp_f32 v215, v215
    v_smfmac_f32_32x32x32_bf16 v[232:247], v[184:187], v[200:207], v254
    v_exp_f32 v216, v216
    v_exp_f32 v217, v217
    v_exp_f32 v218, v218
    v_smfmac_f32_32x32x32_bf16 v[232:247], v[188:191], v[208:215], v254
    s_waitcnt lgkmcnt(0)
    v_exp_f32 v219, v219
    v_exp_f32 v220, v220
    v_exp_f32 v221, v221
    v_mfma_f32_32x32x16_bf16 v[200:215], v[8:11], v[248:251], 0
    s_nop 0
    v_exp_f32 v222, v222
    v_exp_f32 v223, v223
    v_exp_f32 v224, v224
    v_exp_f32 v225, v225
    v_exp_f32 v226, v226
    v_exp_f32 v227, v227
    v_exp_f32 v228, v228
    v_exp_f32 v229, v229
    v_exp_f32 v230, v230
    v_exp_f32 v231, v231
    v_smfmac_f32_32x32x32_bf16 v[232:247], v[192:195], v[216:223], v254
    v_exp_f32 v200, v200
    v_exp_f32 v201, v201
    v_exp_f32 v202, v202
    v_smfmac_f32_32x32x32_bf16 v[232:247], v[196:199], v[224:231], v254
    v_exp_f32 v203, v203
    v_exp_f32 v204, v204
    v_exp_f32 v205, v205
    v_mfma_f32_32x32x16_bf16 v[216:231], v[12:15], v[248:251], 0
    s_nop 0
    v_exp_f32 v206, v206
    v_exp_f32 v207, v207
    v_exp_f32 v208, v208
    v_exp_f32 v209, v209
    v_exp_f32 v210, v210
    v_exp_f32 v211, v211
    v_exp_f32 v212, v212
    ds_write_b128 v5, v[232:235] offset:4096
    ds_write_b128 v5, v[236:239] offset:5120
    ds_write_b32 v6, v240 offset:3072
    v_mov_b64 v[232:233], 0
    v_mov_b64 v[234:235], 0
    v_mov_b64 v[236:237], 0
    v_mov_b64 v[238:239], 0
    v_mov_b64 v[240:241], 0
    v_exp_f32 v213, v213
    v_exp_f32 v214, v214
    v_exp_f32 v215, v215
    v_smfmac_f32_32x32x32_bf16 v[232:247], v[72:75], v[200:207], v254
    v_exp_f32 v216, v216
    v_exp_f32 v217, v217
    v_exp_f32 v218, v218
    v_smfmac_f32_32x32x32_bf16 v[232:247], v[76:79], v[208:215], v254
    v_exp_f32 v219, v219
    v_exp_f32 v220, v220
    v_exp_f32 v221, v221
    v_mfma_f32_32x32x16_bf16 v[200:215], v[16:19], v[248:251], 0
    s_nop 0
    v_exp_f32 v222, v222
    v_exp_f32 v223, v223
    v_exp_f32 v224, v224
    v_exp_f32 v225, v225
    v_exp_f32 v226, v226
    v_exp_f32 v227, v227
    v_exp_f32 v228, v228
    v_exp_f32 v229, v229
    v_exp_f32 v230, v230
    v_exp_f32 v231, v231
    v_smfmac_f32_32x32x32_bf16 v[232:247], v[80:83], v[216:223], v254
    v_exp_f32 v200, v200
    v_exp_f32 v201, v201
    v_exp_f32 v202, v202
    v_smfmac_f32_32x32x32_bf16 v[232:247], v[84:87], v[224:231], v254
    v_exp_f32 v203, v203
    v_exp_f32 v204, v204
    v_exp_f32 v205, v205
    v_mfma_f32_32x32x16_bf16 v[216:231], v[20:23], v[248:251], 0
    s_nop 0
    v_exp_f32 v206, v206
    v_exp_f32 v207, v207
    v_exp_f32 v208, v208
    v_exp_f32 v209, v209
    v_exp_f32 v210, v210
    v_exp_f32 v211, v211
    v_exp_f32 v212, v212
    v_exp_f32 v213, v213
    v_exp_f32 v214, v214
    v_exp_f32 v215, v215
    v_smfmac_f32_32x32x32_bf16 v[232:247], v[88:91], v[200:207], v254
    v_exp_f32 v216, v216
    v_exp_f32 v217, v217
    v_exp_f32 v218, v218
    v_smfmac_f32_32x32x32_bf16 v[232:247], v[92:95], v[208:215], v254
    v_exp_f32 v219, v219
    v_exp_f32 v220, v220
    v_exp_f32 v221, v221
    v_mfma_f32_32x32x16_bf16 v[200:215], v[24:27], v[248:251], 0
    s_nop 0
    v_exp_f32 v222, v222
    v_exp_f32 v223, v223
    v_exp_f32 v224, v224
    v_exp_f32 v225, v225
    v_exp_f32 v226, v226
    v_exp_f32 v227, v227
    v_exp_f32 v228, v228
    v_exp_f32 v229, v229
    v_exp_f32 v230, v230
    v_exp_f32 v231, v231
    v_smfmac_f32_32x32x32_bf16 v[232:247], v[96:99], v[216:223], v254
    v_exp_f32 v200, v200
    v_exp_f32 v201, v201
    v_exp_f32 v202, v202
    v_smfmac_f32_32x32x32_bf16 v[232:247], v[100:103], v[224:231], v254
    v_exp_f32 v203, v203
    v_exp_f32 v204, v204
    v_exp_f32 v205, v205
    v_mfma_f32_32x32x16_bf16 v[216:231], v[28:31], v[248:251], 0
    s_nop 0
    v_exp_f32 v206, v206
    v_exp_f32 v207, v207
    v_exp_f32 v208, v208
    v_exp_f32 v209, v209
    v_exp_f32 v210, v210
    v_exp_f32 v211, v211
    v_exp_f32 v212, v212
    v_exp_f32 v213, v213
    v_exp_f32 v214, v214
    v_exp_f32 v215, v215
    v_smfmac_f32_32x32x32_bf16 v[232:247], v[104:107], v[200:207], v254
    v_exp_f32 v216, v216
    v_exp_f32 v217, v217
    v_exp_f32 v218, v218
    v_smfmac_f32_32x32x32_bf16 v[232:247], v[108:111], v[208:215], v254
    v_exp_f32 v219, v219
    v_exp_f32 v220, v220
    v_exp_f32 v221, v221
    v_mfma_f32_32x32x16_bf16 v[200:215], v[32:35], v[248:251], 0
    s_nop 0
    v_exp_f32 v222, v222
    v_exp_f32 v223, v223
    v_exp_f32 v224, v224
    v_exp_f32 v225, v225
    v_exp_f32 v226, v226
    v_exp_f32 v227, v227
    v_exp_f32 v228, v228
    v_exp_f32 v229, v229
    v_exp_f32 v230, v230
    v_exp_f32 v231, v231
    v_smfmac_f32_32x32x32_bf16 v[232:247], v[112:115], v[216:223], v254
    v_exp_f32 v200, v200
    v_exp_f32 v201, v201
    v_exp_f32 v202, v202
    v_smfmac_f32_32x32x32_bf16 v[232:247], v[116:119], v[224:231], v254
    v_exp_f32 v203, v203
    v_exp_f32 v204, v204
    v_exp_f32 v205, v205
    v_mfma_f32_32x32x16_bf16 v[216:231], v[36:39], v[248:251], 0
    s_nop 0
    v_exp_f32 v206, v206
    v_exp_f32 v207, v207
    v_exp_f32 v208, v208
    v_exp_f32 v209, v209
    v_exp_f32 v210, v210
    v_exp_f32 v211, v211
    v_exp_f32 v212, v212
    v_exp_f32 v213, v213
    v_exp_f32 v214, v214
    v_exp_f32 v215, v215
    v_smfmac_f32_32x32x32_bf16 v[232:247], v[120:123], v[200:207], v254
    v_exp_f32 v216, v216
    v_exp_f32 v217, v217
    v_exp_f32 v218, v218
    v_smfmac_f32_32x32x32_bf16 v[232:247], v[124:127], v[208:215], v254
    v_exp_f32 v219, v219
    v_exp_f32 v220, v220
    v_exp_f32 v221, v221
    v_mfma_f32_32x32x16_bf16 v[200:215], v[40:43], v[248:251], 0
    s_nop 0
    v_exp_f32 v222, v222
    v_exp_f32 v223, v223
    v_exp_f32 v224, v224
    v_exp_f32 v225, v225
    v_exp_f32 v226, v226
    v_exp_f32 v227, v227
    v_exp_f32 v228, v228
    v_exp_f32 v229, v229
    v_exp_f32 v230, v230
    v_exp_f32 v231, v231
    v_smfmac_f32_32x32x32_bf16 v[232:247], v[128:131], v[216:223], v254
    v_exp_f32 v200, v200
    v_exp_f32 v201, v201
    v_exp_f32 v202, v202
    v_smfmac_f32_32x32x32_bf16 v[232:247], v[132:135], v[224:231], v254
    v_exp_f32 v203, v203
    v_exp_f32 v204, v204
    v_exp_f32 v205, v205
    v_mfma_f32_32x32x16_bf16 v[216:231], v[44:47], v[248:251], 0
    s_nop 0
    v_exp_f32 v206, v206
    v_exp_f32 v207, v207
    v_exp_f32 v208, v208
    v_exp_f32 v209, v209
    v_exp_f32 v210, v210
    v_exp_f32 v211, v211
    v_exp_f32 v212, v212
    v_exp_f32 v213, v213
    v_exp_f32 v214, v214
    v_exp_f32 v215, v215
    v_smfmac_f32_32x32x32_bf16 v[232:247], v[136:139], v[200:207], v254
    v_exp_f32 v216, v216
    v_exp_f32 v217, v217
    v_exp_f32 v218, v218
    v_smfmac_f32_32x32x32_bf16 v[232:247], v[140:143], v[208:215], v254
    v_exp_f32 v219, v219
    v_exp_f32 v220, v220
    v_exp_f32 v221, v221
    v_mfma_f32_32x32x16_bf16 v[200:215], v[48:51], v[248:251], 0
    s_nop 0
    v_exp_f32 v222, v222
    v_exp_f32 v223, v223
    v_exp_f32 v224, v224
    v_exp_f32 v225, v225
    v_exp_f32 v226, v226
    v_exp_f32 v227, v227
    v_exp_f32 v228, v228
    v_exp_f32 v229, v229
    v_exp_f32 v230, v230
    v_exp_f32 v231, v231
    v_smfmac_f32_32x32x32_bf16 v[232:247], v[144:147], v[216:223], v254
    v_exp_f32 v200, v200
    v_exp_f32 v201, v201
    v_exp_f32 v202, v202
    v_smfmac_f32_32x32x32_bf16 v[232:247], v[148:151], v[224:231], v254
    v_exp_f32 v203, v203
    v_exp_f32 v204, v204
    v_exp_f32 v205, v205
    v_mfma_f32_32x32x16_bf16 v[216:231], v[52:55], v[248:251], 0
    s_nop 0
    v_exp_f32 v206, v206
    v_exp_f32 v207, v207
    v_exp_f32 v208, v208
    v_exp_f32 v209, v209
    v_exp_f32 v210, v210
    v_exp_f32 v211, v211
    v_exp_f32 v212, v212
    v_exp_f32 v213, v213
    v_exp_f32 v214, v214
    v_exp_f32 v215, v215
    v_smfmac_f32_32x32x32_bf16 v[232:247], v[152:155], v[200:207], v254
    v_exp_f32 v216, v216
    v_exp_f32 v217, v217
    v_exp_f32 v218, v218
    v_smfmac_f32_32x32x32_bf16 v[232:247], v[156:159], v[208:215], v254
    v_exp_f32 v219, v219
    v_exp_f32 v220, v220
    v_exp_f32 v221, v221
    v_mfma_f32_32x32x16_bf16 v[200:215], v[56:59], v[248:251], 0
    ds_read_b32 v3, v7 offset:352
    v_exp_f32 v222, v222
    v_exp_f32 v223, v223
    v_exp_f32 v224, v224
    v_exp_f32 v225, v225
    v_exp_f32 v226, v226
    v_exp_f32 v227, v227
    v_exp_f32 v228, v228
    v_exp_f32 v229, v229
    v_exp_f32 v230, v230
    v_exp_f32 v231, v231
    v_smfmac_f32_32x32x32_bf16 v[232:247], v[160:163], v[216:223], v254
    v_exp_f32 v200, v200
    v_exp_f32 v201, v201
    v_exp_f32 v202, v202
    v_smfmac_f32_32x32x32_bf16 v[232:247], v[164:167], v[224:231], v254
    v_exp_f32 v203, v203
    v_exp_f32 v204, v204
    v_exp_f32 v205, v205
    v_mfma_f32_32x32x16_bf16 v[216:231], v[60:63], v[248:251], 0
    s_waitcnt lgkmcnt(0)
    v_exp_f32 v206, v206
    v_exp_f32 v207, v207
    v_exp_f32 v208, v208
    v_exp_f32 v209, v209
    v_exp_f32 v210, v210
    v_exp_f32 v211, v211
    v_exp_f32 v212, v212
    v_cmp_ne_u32 vcc, 1, v3
    v_exp_f32 v213, v213
    v_exp_f32 v214, v214
    s_and_b64 vcc, vcc, 8
    s_cbranch_vccnz L_f3slow
L_f3ok:
    v_exp_f32 v215, v215
    v_smfmac_f32_32x32x32_bf16 v[232:247], v[168:171], v[200:207], v254
    v_exp_f32 v216, v216
    v_exp_f32 v217, v217
    v_exp_f32 v218, v218
    v_smfmac_f32_32x32x32_bf16 v[232:247], v[172:175], v[208:215], v254
    v_exp_f32 v219, v219
    v_exp_f32 v220, v220
    v_exp_f32 v221, v221
    v_mfma_f32_32x32x16_bf16 v[200:215], v[64:67], v[248:251], 0
    s_nop 0
    v_exp_f32 v222, v222
    v_exp_f32 v223, v223
    v_exp_f32 v224, v224
    v_exp_f32 v225, v225
    v_exp_f32 v226, v226
    v_exp_f32 v227, v227
    v_exp_f32 v228, v228
    v_exp_f32 v229, v229
    v_exp_f32 v230, v230
    v_exp_f32 v231, v231
    v_smfmac_f32_32x32x32_bf16 v[232:247], v[176:179], v[216:223], v254
    v_exp_f32 v200, v200
    v_exp_f32 v201, v201
    v_exp_f32 v202, v202
    v_smfmac_f32_32x32x32_bf16 v[232:247], v[180:183], v[224:231], v254
    v_exp_f32 v203, v203
    v_exp_f32 v204, v204
    v_exp_f32 v205, v205
    v_mfma_f32_32x32x16_bf16 v[216:231], v[68:71], v[248:251], 0
    ds_read_b32 v3, v253 offset:144
    v_exp_f32 v206, v206
    v_exp_f32 v207, v207
    v_exp_f32 v208, v208
    v_exp_f32 v209, v209
    v_exp_f32 v210, v210
    v_exp_f32 v211, v211
    v_exp_f32 v212, v212
    v_exp_f32 v213, v213
    v_exp_f32 v214, v214
    v_exp_f32 v215, v215
    v_smfmac_f32_32x32x32_bf16 v[232:247], v[184:187], v[200:207], v254
    v_exp_f32 v216, v216
    v_exp_f32 v217, v217
    v_exp_f32 v218, v218
    v_smfmac_f32_32x32x32_bf16 v[232:247], v[188:191], v[208:215], v254
    v_exp_f32 v219, v219
    v_exp_f32 v220, v220
    v_exp_f32 v221, v221
    s_nop 0
    v_exp_f32 v222, v222
    v_exp_f32 v223, v223
    v_exp_f32 v224, v224
    v_exp_f32 v225, v225
    v_exp_f32 v226, v226
    v_exp_f32 v227, v227
    v_exp_f32 v228, v228
    v_exp_f32 v229, v229
    v_exp_f32 v230, v230
    v_exp_f32 v231, v231
    v_smfmac_f32_32x32x32_bf16 v[232:247], v[192:195], v[216:223], v254
    s_nop 0
    v_smfmac_f32_32x32x32_bf16 v[232:247], v[196:199], v[224:231], v254
    s_waitcnt lgkmcnt(0)
    v_readfirstlane_b32 s89, v3
    v_mov_b32 v251, v1
    v_add_u32 v2, s22, v1
    v_add_u32 v4, s23, v6
    s_getpc_b64 s[0:1]
L_apc:
    s_add_u32 s0, s0, L_aduty_done-L_apc
    s_addc_u32 s1, s1, 0
    s_mov_b32 s2, 1
    s_cmp_eq_u32 s89, 1
    v_mov_b32 v254, v7
    s_nop 0
    ds_write_b128 v5, v[232:235] offset:6144
    ds_write_b128 v5, v[236:239] offset:7168
    ds_write_b32 v6, v240 offset:3584
    s_cbranch_scc0 L_aduty_done
    s_mov_b32 s20, s21
L_duty:
    ds_read_b32 v232, v4
    ds_read_b32 v233, v4 offset:128
    ds_read_b32 v234, v4 offset:256
    ds_read_b32 v235, v4 offset:384
    ds_read_b128 v[200:203], v2
    ds_read_b128 v[204:207], v2 offset:1024
    ds_read_b128 v[208:211], v2 offset:8192
    ds_read_b128 v[212:215], v2 offset:9216
    ds_read_b128 v[216:219], v2 offset:16384
    ds_read_b128 v[220:223], v2 offset:17408
    ds_read_b128 v[224:227], v2 offset:24576
    ds_read_b128 v[228:231], v2 offset:25600
    ds_read_b32 v250, v254 offset:176
    s_waitcnt lgkmcnt(9)
    s_setprio 2
    v_max3_u32 v236, v232, v233, v234
    v_max_u32 v236, v236, v235
    v_cmp_eq_u32 vcc, -1, v236
    s_nop 0
    s_cbranch_vccnz L_duty_no
    v_add_f32 v232, v232, v233
    v_add_f32 v234, v234, v235
    v_add_f32 v232, v232, v234
    v_rcp_f32 v234, v232
    s_waitcnt lgkmcnt(5)
    v_pk_add_f32 v[200:201], v[200:201], v[208:209]
    v_pk_add_f32 v[202:203], v[202:203], v[210:211]
    v_pk_add_f32 v[204:205], v[204:205], v[212:213]
    v_pk_add_f32 v[206:207], v[206:207], v[214:215]
    v_mov_b32 v235, v234
    s_waitcnt lgkmcnt(0)
    v_pk_add_f32 v[216:217], v[216:217], v[224:225]
    v_pk_add_f32 v[218:219], v[218:219], v[226:227]
    v_pk_add_f32 v[220:221], v[220:221], v[228:229]
    v_pk_add_f32 v[222:223], v[222:223], v[230:231]
    v_pk_add_f32 v[200:201], v[200:201], v[216:217]
    v_pk_add_f32 v[202:203], v[202:203], v[218:219]
    v_pk_add_f32 v[204:205], v[204:205], v[220:221]
    v_pk_add_f32 v[206:207], v[206:207], v[222:223]
    v_pk_mul_f32 v[200:201], v[200:201], v[234:235]
    v_pk_mul_f32 v[202:203], v[202:203], v[234:235]
    v_pk_mul_f32 v[204:205], v[204:205], v[234:235]
    v_pk_mul_f32 v[206:207], v[206:207], v[234:235]
    v_cvt_pk_bf16_f32 v236, v200, v201
    v_cvt_pk_bf16_f32 v237, v202, v203
    v_cvt_pk_bf16_f32 v238, v204, v205
    v_cvt_pk_bf16_f32 v239, v206, v207
    v_dot2_f32_bf16 v233, v236, s70, 0
    v_dot2_f32_bf16 v233, v237, s70, v233
    v_dot2_f32_bf16 v233, v238, s70, v233
    v_dot2_f32_bf16 v233, v239, s70, v233
    v_subrev_u32 v235, 0x2f800000, v232
    v_cmp_lt_u32 vcc, 0x28000000, v235
    v_cmp_ne_u32 s[72:73], 0, v250
    s_add_u32 s89, s89, 1
    v_cmp_class_f32 s[78:79], v233, s24
    s_or_b64 vcc, vcc, s[72:73]
    s_nop 0
    s_or_b64 vcc, vcc, s[78:79]
    s_cbranch_vccnz L_duty_bad
    buffer_store_dwordx4 v[236:239], v251, s[12:15], s20 offen sc1
    v_mov_b32 v250, s89
    s_mov_b32 s2, 9
    s_mov_b64 exec, 1
    ds_max_u32 v253, v250 offset:144
    s_mov_b64 exec, -1
L_duty_next:
    ds_write_b32 v253, v255 offset:352
    v_add_u32 v4, 2048, v4
    s_mov_b32 s20, s21
    s_setprio 0
L_duty_ret:
    s_setpc_b64 s[0:1]
L_duty_no:
    s_setprio 0
    s_waitcnt lgkmcnt(0)
    s_cmp_eq_u32 s2, 0
    s_cbranch_scc1 L_duty_ret
    s_sub_u32 s3, s3, 1
    s_cbranch_scc1 L_exit
    s_cmp_eq_u32 s2, 1
    s_cbranch_scc1 L_duty
    s_sleep 6
    s_branch L_duty
L_duty_bad:
    ds_write_b32 v254, v255 offset:176
    s_branch L_duty_next
L_aduty_done:
    s_setprio 0
L_status:
    s_sleep 4
    ds_read_b32 v3, v7 offset:144
    ds_read_b32 v4, v7 offset:176
    s_waitcnt lgkmcnt(0)
    v_cmp_ne_u32 vcc, 0, v4
    s_nop 0
    s_cbranch_vccnz L_slow
    v_cmp_ne_u32 vcc, 2, v3
    s_nop 0
    s_cbranch_vccnz L_retry_80
L_fin:
L_exit:
    s_endpgm
L_retry_2:
    s_sub_u32 s3, s3, 1
    s_cbranch_scc1 L_exit
    s_branch L_spin_1
L_retry_4:
    s_sub_u32 s3, s3, 1
    s_cbranch_scc1 L_exit
    s_sleep 1
    s_branch L_spin_3
L_retry_6:
    s_sub_u32 s3, s3, 1
    s_cbranch_scc1 L_exit
    s_sleep 2
    s_branch L_spin_5
L_f1one:
    s_add_u32 m0, s66, 0
    s_add_u32 s75, s65, 44032
    buffer_load_dwordx4 v72, s[40:43], s65 offen lds
    s_cmp_ge_u32 s75, s42
    s_cselect_b32 s65, 0, s75
    s_add_u32 m0, s66, 1024
    s_add_u32 s75, s65, 44032
    buffer_load_dwordx4 v72, s[40:43], s65 offen lds
    s_cmp_ge_u32 s75, s42
    s_cselect_b32 s65, 0, s75
    s_add_u32 m0, s66, 2048
    s_add_u32 s75, s65, 44032
    buffer_load_dwordx4 v72, s[40:43], s65 offen lds
    s_cmp_ge_u32 s75, s42
    s_cselect_b32 s65, 0, s75
    s_add_u32 m0, s66, 3072
    s_add_u32 s75, s65, 44032
    buffer_load_dwordx4 v72, s[40:43], s65 offen lds
    s_cmp_ge_u32 s75, s42
    s_cselect_b32 s65, 0, s75
    s_add_u32 m0, s66, 4096
    s_add_u32 s75, s65, 44032
    buffer_load_dwordx4 v72, s[40:43], s65 offen lds
    s_cmp_ge_u32 s75, s42
    s_cselect_b32 s65, 0, s75
    s_add_u32 m0, s66, 5120
    s_add_u32 s75, s65, 44032
    buffer_load_dwordx4 v72, s[40:43], s65 offen lds
    s_cmp_ge_u32 s75, s42
    s_cselect_b32 s65, 0, s75
    s_add_u32 m0, s66, 6144
    s_add_u32 s75, s65, 44032
    buffer_load_dwordx4 v72, s[40:43], s65 offen lds
    s_cmp_ge_u32 s75, s42
    s_cselect_b32 s65, 0, s75
    s_add_u32 m0, s66, 7168
    s_add_u32 s75, s65, 44032
    buffer_load_dwordx4 v72, s[40:43], s65 offen lds
    s_cmp_ge_u32 s75, s42
    s_cselect_b32 s65, 0, s75
    ds_read_b128 v[116:119], v76
    ds_read_b128 v[120:123], v76 offset:512
    s_waitcnt vmcnt(7)
    ds_read_b64_tr_b16 v[108:109], v74
    ds_read_b64_tr_b16 v[110:111], v74 offset:256
    ds_read_b128 v[132:135], v76 offset:2080
    ds_read_b128 v[136:139], v76 offset:2592
    s_waitcnt vmcnt(6)
    ds_read_b64_tr_b16 v[124:125], v74 offset:1024
    ds_read_b64_tr_b16 v[126:127], v74 offset:1280
    ds_read_b128 v[148:151], v76 offset:4160
    ds_read_b128 v[152:155], v76 offset:4672
    s_waitcnt vmcnt(5)
    ds_read_b64_tr_b16 v[140:141], v74 offset:2048
    ds_read_b64_tr_b16 v[142:143], v74 offset:2304
    s_waitcnt lgkmcnt(8)
    v_mfma_f32_32x32x16_bf16 v[184:199], v[108:111], v[116:119], 0
    ds_read_b128 v[164:167], v76 offset:6240
    ds_read_b128 v[168:171], v76 offset:6752
    v_mfma_f32_32x32x16_bf16 v[200:215], v[108:111], v[120:123], 0
    s_waitcnt vmcnt(4)
    ds_read_b64_tr_b16 v[156:157], v74 offset:3072
    ds_read_b64_tr_b16 v[158:159], v74 offset:3328
    s_add_u32 m0, s66, 0
    s_add_u32 s75, s65, 44032
    buffer_load_dwordx4 v72, s[40:43], s65 offen lds
    s_cmp_ge_u32 s75, s42
    s_cselect_b32 s65, 0, s75
    s_cmp_lt_u32 s6, 4
    s_cbranch_scc1 L_nomall
    s_lshl2_add_u32 s71, s5, s6
    s_lshl2_add_u32 s71, s71, s88
    s_sub_u32 s71, s71, 16
    s_mul_i32 s76, s71, 2752
    buffer_load_dword v63, v73, s[52:55], s76 offen
    s_lshl_b32 s76, s71, 10
    s_mov_b64 exec, 0xffff
    buffer_load_dword v63, v73, s[56:59], s76 offen
    s_mov_b64 exec, -1
L_nomall:
    s_waitcnt lgkmcnt(8)
    v_mfma_f32_32x32x16_bf16 v[184:199], v[124:127], v[132:135], v[184:199]
    ds_read_b128 v[116:119], v77
    ds_read_b128 v[120:123], v77 offset:512
    v_mfma_f32_32x32x16_bf16 v[200:215], v[124:127], v[136:139], v[200:215]
    s_waitcnt vmcnt(4)
    ds_read_b64_tr_b16 v[108:109], v74 offset:4096
    ds_read_b64_tr_b16 v[110:111], v74 offset:4352
    s_add_u32 m0, s66, 1024
    s_add_u32 s75, s65, 44032
    buffer_load_dwordx4 v72, s[40:43], s65 offen lds
    s_cmp_ge_u32 s75, s42
    s_cselect_b32 s65, 0, s75
    s_waitcnt lgkmcnt(8)
    v_mfma_f32_32x32x16_bf16 v[184:199], v[140:143], v[148:151], v[184:199]
    ds_read_b128 v[132:135], v77 offset:2080
    ds_read_b128 v[136:139], v77 offset:2592
    v_mfma_f32_32x32x16_bf16 v[200:215], v[140:143], v[152:155], v[200:215]
    s_waitcnt vmcnt(4)
    ds_read_b64_tr_b16 v[124:125], v74 offset:5120
    ds_read_b64_tr_b16 v[126:127], v74 offset:5376
    s_add_u32 m0, s66, 2048
    s_add_u32 s75, s65, 44032
    buffer_load_dwordx4 v72, s[40:43], s65 offen lds
    s_cmp_ge_u32 s75, s42
    s_cselect_b32 s65, 0, s75
    s_waitcnt lgkmcnt(8)
    v_mfma_f32_32x32x16_bf16 v[184:199], v[156:159], v[164:167], v[184:199]
    ds_read_b128 v[148:151], v77 offset:4160
    ds_read_b128 v[152:155], v77 offset:4672
    v_mfma_f32_32x32x16_bf16 v[200:215], v[156:159], v[168:171], v[200:215]
    s_waitcnt vmcnt(4)
    ds_read_b64_tr_b16 v[140:141], v74 offset:6144
    ds_read_b64_tr_b16 v[142:143], v74 offset:6400
    s_add_u32 m0, s66, 3072
    s_add_u32 s75, s65, 44032
    buffer_load_dwordx4 v72, s[40:43], s65 offen lds
    s_cmp_ge_u32 s75, s42
    s_cselect_b32 s65, 0, s75
    s_waitcnt lgkmcnt(8)
    v_mfma_f32_32x32x16_bf16 v[184:199], v[108:111], v[116:119], v[184:199]
    ds_read_b128 v[164:167], v77 offset:6240
    ds_read_b128 v[168:171], v77 offset:6752
    v_mfma_f32_32x32x16_bf16 v[200:215], v[108:111], v[120:123], v[200:215]
    s_waitcnt vmcnt(4)
    ds_read_b64_tr_b16 v[156:157], v74 offset:7168
    ds_read_b64_tr_b16 v[158:159], v74 offset:7424
    s_add_u32 m0, s66, 4096
    s_add_u32 s75, s65, 44032
    buffer_load_dwordx4 v72, s[40:43], s65 offen lds
    s_cmp_ge_u32 s75, s42
    s_cselect_b32 s65, 0, s75
    s_waitcnt lgkmcnt(8)
    v_mfma_f32_32x32x16_bf16 v[184:199], v[124:127], v[132:135], v[184:199]
    ds_read_b128 v[116:119], v78
    ds_read_b128 v[120:123], v78 offset:512
    v_mfma_f32_32x32x16_bf16 v[200:215], v[124:127], v[136:139], v[200:215]
    s_waitcnt vmcnt(4)
    ds_read_b64_tr_b16 v[108:109], v74
    ds_read_b64_tr_b16 v[110:111], v74 offset:256
    s_add_u32 m0, s66, 5120
    s_add_u32 s75, s65, 44032
    buffer_load_dwordx4 v72, s[40:43], s65 offen lds
    s_cmp_ge_u32 s75, s42
    s_cselect_b32 s65, 0, s75
    s_waitcnt lgkmcnt(8)
    v_mfma_f32_32x32x16_bf16 v[184:199], v[140:143], v[148:151], v[184:199]
    ds_read_b128 v[132:135], v78 offset:2080
    ds_read_b128 v[136:139], v78 offset:2592
    v_mfma_f32_32x32x16_bf16 v[200:215], v[140:143], v[152:155], v[200:215]
    s_waitcnt vmcnt(4)
    ds_read_b64_tr_b16 v[124:125], v74 offset:1024
    ds_read_b64_tr_b16 v[126:127], v74 offset:1280
    s_add_u32 m0, s66, 6144
    s_add_u32 s75, s65, 44032
    buffer_load_dwordx4 v72, s[40:43], s65 offen lds
    s_cmp_ge_u32 s75, s42
    s_cselect_b32 s65, 0, s75
    s_waitcnt lgkmcnt(8)
    v_mfma_f32_32x32x16_bf16 v[184:199], v[156:159], v[164:167], v[184:199]
    ds_read_b128 v[148:151], v78 offset:4160
    ds_read_b128 v[152:155], v78 offset:4672
    v_mfma_f32_32x32x16_bf16 v[200:215], v[156:159], v[168:171], v[200:215]
    s_waitcnt vmcnt(4)
    ds_read_b64_tr_b16 v[140:141], v74 offset:2048
    ds_read_b64_tr_b16 v[142:143], v74 offset:2304
    s_add_u32 m0, s66, 7168
    s_add_u32 s75, s65, 44032
    buffer_load_dwordx4 v72, s[40:43], s65 offen lds
    s_cmp_ge_u32 s75, s42
    s_cselect_b32 s65, 0, s75
    s_waitcnt lgkmcnt(8)
    v_mfma_f32_32x32x16_bf16 v[184:199], v[108:111], v[116:119], v[184:199]
    ds_read_b128 v[164:167], v78 offset:6240
    ds_read_b128 v[168:171], v78 offset:6752
    v_mfma_f32_32x32x16_bf16 v[200:215], v[108:111], v[120:123], v[200:215]
    s_waitcnt vmcnt(4)
    ds_read_b64_tr_b16 v[156:157], v74 offset:3072
    ds_read_b64_tr_b16 v[158:159], v74 offset:3328
    s_add_u32 m0, s66, 0
    s_add_u32 s75, s65, 44032
    buffer_load_dwordx4 v72, s[40:43], s65 offen lds
    s_cmp_ge_u32 s75, s42
    s_cselect_b32 s65, 0, s75
    s_waitcnt lgkmcnt(8)
    v_mfma_f32_32x32x16_bf16 v[184:199], v[124:127], v[132:135], v[184:199]
    ds_read_b128 v[116:119], v79
    ds_read_b128 v[120:123], v79 offset:512
    v_mfma_f32_32x32x16_bf16 v[200:215], v[124:127], v[136:139], v[200:215]
    s_waitcnt vmcnt(4)
    ds_read_b64_tr_b16 v[108:109], v74 offset:4096
    ds_read_b64_tr_b16 v[110:111], v74 offset:4352
    s_add_u32 m0, s66, 1024
    s_add_u32 s75, s65, 44032
    buffer_load_dwordx4 v72, s[40:43], s65 offen lds
    s_cmp_ge_u32 s75, s42
    s_cselect_b32 s65, 0, s75
    s_waitcnt lgkmcnt(8)
    v_mfma_f32_32x32x16_bf16 v[184:199], v[140:143], v[148:151], v[184:199]
    ds_read_b128 v[132:135], v79 offset:2080
    ds_read_b128 v[136:139], v79 offset:2592
    v_mfma_f32_32x32x16_bf16 v[200:215], v[140:143], v[152:155], v[200:215]
    s_waitcnt vmcnt(4)
    ds_read_b64_tr_b16 v[124:125], v74 offset:5120
    ds_read_b64_tr_b16 v[126:127], v74 offset:5376
    s_add_u32 m0, s66, 2048
    s_add_u32 s75, s65, 44032
    buffer_load_dwordx4 v72, s[40:43], s65 offen lds
    s_cmp_ge_u32 s75, s42
    s_cselect_b32 s65, 0, s75
    s_waitcnt lgkmcnt(8)
    v_mfma_f32_32x32x16_bf16 v[184:199], v[156:159], v[164:167], v[184:199]
    ds_read_b128 v[148:151], v79 offset:4160
    ds_read_b128 v[152:155], v79 offset:4672
    v_mfma_f32_32x32x16_bf16 v[200:215], v[156:159], v[168:171], v[200:215]
    s_waitcnt vmcnt(4)
    ds_read_b64_tr_b16 v[140:141], v74 offset:6144
    ds_read_b64_tr_b16 v[142:143], v74 offset:6400
    s_add_u32 m0, s66, 3072
    s_add_u32 s75, s65, 44032
    buffer_load_dwordx4 v72, s[40:43], s65 offen lds
    s_cmp_ge_u32 s75, s42
    s_cselect_b32 s65, 0, s75
    s_waitcnt lgkmcnt(8)
    v_mfma_f32_32x32x16_bf16 v[184:199], v[108:111], v[116:119], v[184:199]
    ds_read_b128 v[164:167], v79 offset:6240
    ds_read_b128 v[168:171], v79 offset:6752
    v_mfma_f32_32x32x16_bf16 v[200:215], v[108:111], v[120:123], v[200:215]
    s_waitcnt vmcnt(4)
    ds_read_b64_tr_b16 v[156:157], v74 offset:7168
    ds_read_b64_tr_b16 v[158:159], v74 offset:7424
    s_add_u32 m0, s66, 4096
    s_add_u32 s75, s65, 44032
    buffer_load_dwordx4 v72, s[40:43], s65 offen lds
    s_cmp_ge_u32 s75, s42
    s_cselect_b32 s65, 0, s75
    s_waitcnt lgkmcnt(8)
    v_mfma_f32_32x32x16_bf16 v[184:199], v[124:127], v[132:135], v[184:199]
    ds_read_b128 v[116:119], v80
    ds_read_b128 v[120:123], v80 offset:512
    v_mfma_f32_32x32x16_bf16 v[200:215], v[124:127], v[136:139], v[200:215]
    s_waitcnt vmcnt(4)
    ds_read_b64_tr_b16 v[108:109], v74
    ds_read_b64_tr_b16 v[110:111], v74 offset:256
    s_add_u32 m0, s66, 5120
    s_add_u32 s75, s65, 44032
    buffer_load_dwordx4 v72, s[40:43], s65 offen lds
    s_cmp_ge_u32 s75, s42
    s_cselect_b32 s65, 0, s75
    s_waitcnt lgkmcnt(8)
    v_mfma_f32_32x32x16_bf16 v[184:199], v[140:143], v[148:151], v[184:199]
    ds_read_b128 v[132:135], v80 offset:2080
    ds_read_b128 v[136:139], v80 offset:2592
    v_mfma_f32_32x32x16_bf16 v[200:215], v[140:143], v[152:155], v[200:215]
    s_waitcnt vmcnt(4)
    ds_read_b64_tr_b16 v[124:125], v74 offset:1024
    ds_read_b64_tr_b16 v[126:127], v74 offset:1280
    s_add_u32 m0, s66, 6144
    s_add_u32 s75, s65, 44032
    buffer_load_dwordx4 v72, s[40:43], s65 offen lds
    s_cmp_ge_u32 s75, s42
    s_cselect_b32 s65, 0, s75
    s_waitcnt lgkmcnt(8)
    v_mfma_f32_32x32x16_bf16 v[184:199], v[156:159], v[164:167], v[184:199]
    ds_read_b128 v[148:151], v80 offset:4160
    ds_read_b128 v[152:155], v80 offset:4672
    v_mfma_f32_32x32x16_bf16 v[200:215], v[156:159], v[168:171], v[200:215]
    s_waitcnt vmcnt(4)
    ds_read_b64_tr_b16 v[140:141], v74 offset:2048
    ds_read_b64_tr_b16 v[142:143], v74 offset:2304
    s_add_u32 m0, s66, 7168
    s_add_u32 s75, s65, 44032
    buffer_load_dwordx4 v72, s[40:43], s65 offen lds
    s_cmp_ge_u32 s75, s42
    s_cselect_b32 s65, 0, s75
    s_waitcnt lgkmcnt(8)
    v_mfma_f32_32x32x16_bf16 v[184:199], v[108:111], v[116:119], v[184:199]
    ds_read_b128 v[164:167], v80 offset:6240
    ds_read_b128 v[168:171], v80 offset:6752
    v_mfma_f32_32x32x16_bf16 v[200:215], v[108:111], v[120:123], v[200:215]
    s_waitcnt vmcnt(4)
    ds_read_b64_tr_b16 v[156:157], v74 offset:3072
    ds_read_b64_tr_b16 v[158:159], v74 offset:3328
    s_add_u32 m0, s66, 0
    s_add_u32 s75, s65, 44032
    buffer_load_dwordx4 v72, s[40:43], s65 offen lds
    s_cmp_ge_u32 s75, s42
    s_cselect_b32 s65, 0, s75
    s_waitcnt lgkmcnt(8)
    v_mfma_f32_32x32x16_bf16 v[184:199], v[124:127], v[132:135], v[184:199]
    ds_read_b128 v[116:119], v81
    ds_read_b128 v[120:123], v81 offset:512
    v_mfma_f32_32x32x16_bf16 v[200:215], v[124:127], v[136:139], v[200:215]
    s_waitcnt vmcnt(4)
    ds_read_b64_tr_b16 v[108:109], v74 offset:4096
    ds_read_b64_tr_b16 v[110:111], v74 offset:4352
    s_add_u32 m0, s66, 1024
    s_add_u32 s75, s65, 44032
    buffer_load_dwordx4 v72, s[40:43], s65 offen lds
    s_cmp_ge_u32 s75, s42
    s_cselect_b32 s65, 0, s75
    s_waitcnt lgkmcnt(8)
    v_mfma_f32_32x32x16_bf16 v[184:199], v[140:143], v[148:151], v[184:199]
    ds_read_b128 v[132:135], v81 offset:2080
    ds_read_b128 v[136:139], v81 offset:2592
    v_mfma_f32_32x32x16_bf16 v[200:215], v[140:143], v[152:155], v[200:215]
    s_waitcnt vmcnt(4)
    ds_read_b64_tr_b16 v[124:125], v74 offset:5120
    ds_read_b64_tr_b16 v[126:127], v74 offset:5376
    s_add_u32 m0, s66, 2048
    s_add_u32 s75, s65, 44032
    buffer_load_dwordx4 v72, s[40:43], s65 offen lds
    s_cmp_ge_u32 s75, s42
    s_cselect_b32 s65, 0, s75
    s_waitcnt lgkmcnt(8)
    v_mfma_f32_32x32x16_bf16 v[184:199], v[156:159], v[164:167], v[184:199]
    ds_read_b128 v[148:151], v81 offset:4160
    ds_read_b128 v[152:155], v81 offset:4672
    v_mfma_f32_32x32x16_bf16 v[200:215], v[156:159], v[168:171], v[200:215]
    s_waitcnt vmcnt(4)
    ds_read_b64_tr_b16 v[140:141], v74 offset:6144
    ds_read_b64_tr_b16 v[142:143], v74 offset:6400
    s_add_u32 m0, s66, 3072
    s_add_u32 s75, s65, 44032
    buffer_load_dwordx4 v72, s[40:43], s65 offen lds
    s_cmp_ge_u32 s75, s42
    s_cselect_b32 s65, 0, s75
    s_waitcnt lgkmcnt(8)
    v_mfma_f32_32x32x16_bf16 v[184:199], v[108:111], v[116:119], v[184:199]
    ds_read_b128 v[164:167], v81 offset:6240
    ds_read_b128 v[168:171], v81 offset:6752
    v_mfma_f32_32x32x16_bf16 v[200:215], v[108:111], v[120:123], v[200:215]
    s_waitcnt vmcnt(4)
    ds_read_b64_tr_b16 v[156:157], v74 offset:7168
    ds_read_b64_tr_b16 v[158:159], v74 offset:7424
    s_add_u32 m0, s66, 4096
    s_add_u32 s75, s65, 44032
    buffer_load_dwordx4 v72, s[40:43], s65 offen lds
    s_cmp_ge_u32 s75, s42
    s_cselect_b32 s65, 0, s75
    s_waitcnt lgkmcnt(8)
    v_mfma_f32_32x32x16_bf16 v[184:199], v[124:127], v[132:135], v[184:199]
    ds_read_b128 v[116:119], v82
    ds_read_b128 v[120:123], v82 offset:512
    v_mfma_f32_32x32x16_bf16 v[200:215], v[124:127], v[136:139], v[200:215]
    s_waitcnt vmcnt(4)
    ds_read_b64_tr_b16 v[108:109], v74
    ds_read_b64_tr_b16 v[110:111], v74 offset:256
    s_add_u32 m0, s66, 5120
    s_add_u32 s75, s65, 44032
    buffer_load_dwordx4 v72, s[40:43], s65 offen lds
    s_cmp_ge_u32 s75, s42
    s_cselect_b32 s65, 0, s75
    s_waitcnt lgkmcnt(8)
    v_mfma_f32_32x32x16_bf16 v[184:199], v[140:143], v[148:151], v[184:199]
    ds_read_b128 v[132:135], v82 offset:2080
    ds_read_b128 v[136:139], v82 offset:2592
    v_mfma_f32_32x32x16_bf16 v[200:215], v[140:143], v[152:155], v[200:215]
    s_waitcnt vmcnt(4)
    ds_read_b64_tr_b16 v[124:125], v74 offset:1024
    ds_read_b64_tr_b16 v[126:127], v74 offset:1280
    s_add_u32 m0, s66, 6144
    s_add_u32 s75, s65, 44032
    buffer_load_dwordx4 v72, s[40:43], s65 offen lds
    s_cmp_ge_u32 s75, s42
    s_cselect_b32 s65, 0, s75
    s_waitcnt lgkmcnt(8)
    v_mfma_f32_32x32x16_bf16 v[184:199], v[156:159], v[164:167], v[184:199]
    ds_read_b128 v[148:151], v82 offset:4160
    ds_read_b128 v[152:155], v82 offset:4672
    v_mfma_f32_32x32x16_bf16 v[200:215], v[156:159], v[168:171], v[200:215]
    s_waitcnt vmcnt(4)
    ds_read_b64_tr_b16 v[140:141], v74 offset:2048
    ds_read_b64_tr_b16 v[142:143], v74 offset:2304
    s_add_u32 m0, s66, 7168
    s_add_u32 s75, s65, 44032
    buffer_load_dwordx4 v72, s[40:43], s65 offen lds
    s_cmp_ge_u32 s75, s42
    s_cselect_b32 s65, 0, s75
    s_waitcnt lgkmcnt(8)
    v_mfma_f32_32x32x16_bf16 v[184:199], v[108:111], v[116:119], v[184:199]
    ds_read_b128 v[164:167], v82 offset:6240
    ds_read_b128 v[168:171], v82 offset:6752
    v_mfma_f32_32x32x16_bf16 v[200:215], v[108:111], v[120:123], v[200:215]
    s_waitcnt vmcnt(4)
    ds_read_b64_tr_b16 v[156:157], v74 offset:3072
    ds_read_b64_tr_b16 v[158:159], v74 offset:3328
    s_waitcnt lgkmcnt(8)
    v_mfma_f32_32x32x16_bf16 v[184:199], v[124:127], v[132:135], v[184:199]
    ds_read_b128 v[116:119], v83
    ds_read_b128 v[120:123], v83 offset:512
    v_mfma_f32_32x32x16_bf16 v[200:215], v[124:127], v[136:139], v[200:215]
    s_waitcnt vmcnt(3)
    ds_read_b64_tr_b16 v[108:109], v74 offset:4096
    ds_read_b64_tr_b16 v[110:111], v74 offset:4352
    s_waitcnt lgkmcnt(8)
    v_mfma_f32_32x32x16_bf16 v[184:199], v[140:143], v[148:151], v[184:199]
    ds_read_b128 v[132:135], v83 offset:2080
    ds_read_b128 v[136:139], v83 offset:2592
    v_mfma_f32_32x32x16_bf16 v[200:215], v[140:143], v[152:155], v[200:215]
    s_waitcnt vmcnt(2)
    ds_read_b64_tr_b16 v[124:125], v74 offset:5120
    ds_read_b64_tr_b16 v[126:127], v74 offset:5376
    s_waitcnt lgkmcnt(8)
    v_mfma_f32_32x32x16_bf16 v[184:199], v[156:159], v[164:167], v[184:199]
    ds_read_b128 v[148:151], v83 offset:4160
    ds_read_b128 v[152:155], v83 offset:4672
    v_mfma_f32_32x32x16_bf16 v[200:215], v[156:159], v[168:171], v[200:215]
    s_waitcnt vmcnt(1)
    ds_read_b64_tr_b16 v[140:141], v74 offset:6144
    ds_read_b64_tr_b16 v[142:143], v74 offset:6400
    s_waitcnt lgkmcnt(8)
    v_mfma_f32_32x32x16_bf16 v[184:199], v[108:111], v[116:119], v[184:199]
    ds_read_b128 v[164:167], v83 offset:6240
    ds_read_b128 v[168:171], v83 offset:6752
    v_mfma_f32_32x32x16_bf16 v[200:215], v[108:111], v[120:123], v[200:215]
    s_waitcnt vmcnt(0)
    ds_read_b64_tr_b16 v[156:157], v74 offset:7168
    ds_read_b64_tr_b16 v[158:159], v74 offset:7424
    s_waitcnt lgkmcnt(8)
    v_mfma_f32_32x32x16_bf16 v[184:199], v[124:127], v[132:135], v[184:199]
    v_mfma_f32_32x32x16_bf16 v[200:215], v[124:127], v[136:139], v[200:215]
    s_waitcnt lgkmcnt(4)
    v_mfma_f32_32x32x16_bf16 v[184:199], v[140:143], v[148:151], v[184:199]
    v_mfma_f32_32x32x16_bf16 v[200:215], v[140:143], v[152:155], v[200:215]
    s_waitcnt lgkmcnt(0)
    v_mfma_f32_32x32x16_bf16 v[184:199], v[156:159], v[164:167], v[184:199]
    v_mfma_f32_32x32x16_bf16 v[200:215], v[156:159], v[168:171], v[200:215]
    s_branch L_f1done
L_dutyb:
    ds_read_b32 v192, v4
    ds_read_b32 v193, v4 offset:128
    ds_read_b32 v194, v4 offset:256
    ds_read_b32 v195, v4 offset:384
    ds_read_b128 v[160:163], v2
    ds_read_b128 v[164:167], v2 offset:1024
    ds_read_b128 v[168:171], v2 offset:8192
    ds_read_b128 v[172:175], v2 offset:9216
    ds_read_b128 v[176:179], v2 offset:16384
    ds_read_b128 v[180:183], v2 offset:17408
    ds_read_b128 v[184:187], v2 offset:24576
    ds_read_b128 v[188:191], v2 offset:25600
    ds_read_b32 v250, v254 offset:176
    s_waitcnt lgkmcnt(9)
    s_setprio 2
    v_max3_u32 v196, v192, v193, v194
    v_max_u32 v196, v196, v195
    v_cmp_eq_u32 vcc, -1, v196
    s_nop 0
    s_cbranch_vccnz L_dutyb_no
    v_add_f32 v192, v192, v193
    v_add_f32 v194, v194, v195
    v_add_f32 v192, v192, v194
    v_rcp_f32 v194, v192
    s_waitcnt lgkmcnt(5)
    v_pk_add_f32 v[160:161], v[160:161], v[168:169]
    v_pk_add_f32 v[162:163], v[162:163], v[170:171]
    v_pk_add_f32 v[164:165], v[164:165], v[172:173]
    v_pk_add_f32 v[166:167], v[166:167], v[174:175]
    v_mov_b32 v195, v194
    s_waitcnt lgkmcnt(0)
    v_pk_add_f32 v[176:177], v[176:177], v[184:185]
    v_pk_add_f32 v[178:179], v[178:179], v[186:187]
    v_pk_add_f32 v[180:181], v[180:181], v[188:189]
    v_pk_add_f32 v[182:183], v[182:183], v[190:191]
    v_pk_add_f32 v[160:161], v[160:161], v[176:177]
    v_pk_add_f32 v[162:163], v[162:163], v[178:179]
    v_pk_add_f32 v[164:165], v[164:165], v[180:181]
    v_pk_add_f32 v[166:167], v[166:167], v[182:183]
    v_pk_mul_f32 v[160:161], v[160:161], v[194:195]
    v_pk_mul_f32 v[162:163], v[162:163], v[194:195]
    v_pk_mul_f32 v[164:165], v[164:165], v[194:195]
    v_pk_mul_f32 v[166:167], v[166:167], v[194:195]
    v_cvt_pk_bf16_f32 v196, v160, v161
    v_cvt_pk_bf16_f32 v197, v162, v163
    v_cvt_pk_bf16_f32 v198, v164, v165
    v_cvt_pk_bf16_f32 v199, v166, v167
    v_dot2_f32_bf16 v193, v196, s70, 0
    v_dot2_f32_bf16 v193, v197, s70, v193
    v_dot2_f32_bf16 v193, v198, s70, v193
    v_dot2_f32_bf16 v193, v199, s70, v193
    v_subrev_u32 v195, 0x2f800000, v192
    v_cmp_lt_u32 vcc, 0x28000000, v195
    v_cmp_ne_u32 s[72:73], 0, v250
    s_add_u32 s89, s89, 1
    v_cmp_class_f32 s[78:79], v193, s24
    s_or_b64 vcc, vcc, s[72:73]
    s_nop 0
    s_or_b64 vcc, vcc, s[78:79]
    s_cbranch_vccnz L_dutyb_bad
    buffer_store_dwordx4 v[196:199], v251, s[12:15], s20 offen sc1
    v_mov_b32 v250, s89
    s_mov_b32 s2, 9
    s_mov_b64 exec, 1
    ds_max_u32 v253, v250 offset:144
    s_mov_b64 exec, -1
L_dutyb_next:
    ds_write_b32 v253, v255 offset:352
    v_add_u32 v4, 2048, v4
    s_mov_b32 s20, s21
    s_setprio 0
L_dutyb_ret:
    s_setpc_b64 s[0:1]
L_dutyb_no:
    s_setprio 0
    s_waitcnt lgkmcnt(0)
    s_cmp_eq_u32 s2, 0
    s_cbranch_scc1 L_dutyb_ret
    s_sub_u32 s3, s3, 1
    s_cbranch_scc1 L_exit
    s_cmp_eq_u32 s2, 1
    s_cbranch_scc1 L_dutyb
    s_sleep 6
    s_branch L_dutyb
L_dutyb_bad:
    ds_write_b32 v254, v255 offset:176
    s_branch L_dutyb_next
L_retry_10:
    s_sub_u32 s3, s3, 1
    s_cbranch_scc1 L_exit
    s_sleep 8
    s_branch L_epoll
L_retry_12:
    s_sub_u32 s3, s3, 1
    s_cbranch_scc1 L_exit
    s_sleep 2
    s_branch L_spin_11
L_retry_14:
    s_sub_u32 s3, s3, 1
    s_cbranch_scc1 L_exit
    s_sleep 2
    s_branch L_spin_13
L_f2late:
    s_waitcnt vmcnt(0)
    s_mov_b64 exec, 1
    buffer_store_dwordx2 v[64:65], v66, s[12:15], s87 offen sc1
    s_mov_b64 exec, -1
    s_cmp_eq_u32 s39, 2
    s_cbranch_scc1 L_f2pre
    s_mov_b32 exec_hi, 0
    buffer_load_dword v63, v75, s[56:59], s72 offen
    s_mov_b32 exec_hi, -1
    buffer_load_dword v63, v75, s[52:55], s73 offen
    buffer_load_dword v63, v75, s[52:55], s74 offen
    s_lshl_b32 s71, s89, 2
    s_add_u32 s71, s71, s86
    s_mov_b32 s2, 0
    s_cmp_lt_u32 s71, 4
    s_cbranch_scc0 L_noduty_8
    s_call_b64 s[0:1], L_duty
L_noduty_8:
    s_waitcnt vmcnt(1)
    s_lshl2_add_u32 s71, s6, s88
    s_and_b32 s71, s71, 19
    s_cmp_eq_u32 s71, 19
    s_cbranch_scc0 L_nostage
    s_call_b64 s[0:1], L_stage
L_nostage:
    s_lshl_b32 s65, s64, 3
    s_add_u32 m0, s66, 4096
    s_add_u32 s75, s65, 16384
    buffer_load_dwordx4 v1, s[52:55], s65 offen lds
    s_add_u32 m0, s66, 5056
    s_cmp_ge_u32 s75, s81
    buffer_load_dwordx4 v1, s[52:55], s65 offen offset:64 lds
    s_cselect_b32 s65, s80, s75
    s_add_u32 m0, s66, 6144
    s_add_u32 s75, s65, 16384
    buffer_load_dwordx4 v1, s[52:55], s65 offen lds
    s_add_u32 m0, s66, 7104
    s_cmp_ge_u32 s75, s81
    buffer_load_dwordx4 v1, s[52:55], s65 offen offset:64 lds
    s_cselect_b32 s65, s80, s75
    s_add_u32 m0, s66, 8192
    s_add_u32 s75, s65, 16384
    buffer_load_dwordx4 v1, s[52:55], s65 offen lds
    s_add_u32 m0, s66, 9152
    s_cmp_ge_u32 s75, s81
    buffer_load_dwordx4 v1, s[52:55], s65 offen offset:64 lds
    s_cselect_b32 s65, s80, s75
    s_add_u32 m0, s66, 10240
    s_add_u32 s75, s65, 16384
    buffer_load_dwordx4 v1, s[52:55], s65 offen lds
    s_add_u32 m0, s66, 11200
    s_cmp_ge_u32 s75, s81
    buffer_load_dwordx4 v1, s[52:55], s65 offen offset:64 lds
    s_cselect_b32 s65, s80, s75
    s_add_u32 m0, s66, 0
    s_add_u32 s75, s65, 16384
    buffer_load_dwordx4 v1, s[52:55], s65 offen lds
    s_add_u32 m0, s66, 960
    s_cmp_ge_u32 s75, s81
    buffer_load_dwordx4 v1, s[52:55], s65 offen offset:64 lds
    s_cselect_b32 s65, s80, s75
    s_add_u32 m0, s66, 2048
    s_add_u32 s75, s65, 16384
    buffer_load_dwordx4 v1, s[52:55], s65 offen lds
    s_add_u32 m0, s66, 3008
    s_cmp_ge_u32 s75, s81
    buffer_load_dwordx4 v1, s[52:55], s65 offen offset:64 lds
    s_cselect_b32 s65, s80, s75
L_f2pre:
    s_lshl_b32 s71, s89, 2
    s_add_u32 s71, s71, s86
    s_mov_b32 s2, 0
    s_cmp_lt_u32 s71, 4
    s_cbranch_scc0 L_noduty_9
    s_call_b64 s[0:1], L_duty
L_noduty_9:
L_epoll:
    buffer_load_dwordx2 v[6:7], v62, s[12:15], s67 offen offset:704 sc1
    s_waitcnt vmcnt(0)
    s_setprio 2
    v_cmp_ne_u64 vcc, s[26:27], v[6:7]
    s_setprio 0
    s_cbranch_vccnz L_retry_10
    buffer_load_dwordx4 v[124:127], v251, s[48:51], s64 offen sc1
    buffer_load_dwordx4 v[128:131], v251, s[48:51], s64 offen offset:1024 sc1
    s_add_u32 s64, s64, 2048
    s_cmp_ge_u32 s64, s83
    s_cselect_b32 s64, s82, s64
    buffer_load_dwordx4 v[132:135], v251, s[48:51], s64 offen sc1
    buffer_load_dwordx4 v[136:139], v251, s[48:51], s64 offen offset:1024 sc1
    s_add_u32 s64, s64, 2048
    s_cmp_ge_u32 s64, s83
    s_cselect_b32 s64, s82, s64
    buffer_load_dwordx4 v[200:203], v251, s[48:51], s64 offen sc1
    buffer_load_dwordx4 v[204:207], v251, s[48:51], s64 offen offset:1024 sc1
    s_add_u32 s64, s64, 2048
    s_cmp_ge_u32 s64, s83
    s_cselect_b32 s64, s82, s64
    buffer_load_dwordx4 v[208:211], v251, s[48:51], s64 offen sc1
    buffer_load_dwordx4 v[212:215], v251, s[48:51], s64 offen offset:1024 sc1
    s_add_u32 s64, s64, 2048
    s_cmp_ge_u32 s64, s83
    s_cselect_b32 s64, s82, s64
    buffer_load_dwordx4 v[216:219], v251, s[48:51], s64 offen sc1
    buffer_load_dwordx4 v[220:223], v251, s[48:51], s64 offen offset:1024 sc1
    s_add_u32 s64, s64, 2048
    s_cmp_ge_u32 s64, s83
    s_cselect_b32 s64, s82, s64
    buffer_load_dwordx4 v[224:227], v251, s[48:51], s64 offen sc1
    buffer_load_dwordx4 v[228:231], v251, s[48:51], s64 offen offset:1024 sc1
    s_add_u32 s64, s64, 2048
    s_cmp_ge_u32 s64, s83
    s_cselect_b32 s64, s82, s64
L_spin_11:
    ds_read_b32 v250, v254 offset:80
    s_waitcnt lgkmcnt(0)
    s_setprio 2
    v_cmp_ne_u32 vcc, 1, v250
    s_setprio 0
    s_cbranch_vccnz L_retry_12
    s_waitcnt vmcnt(8)
    s_cmp_eq_u32 s88, 3
    s_cbranch_scc0 L_f2go
    s_cmp_lt_u32 s6, 4
    s_cbranch_scc0 L_f2go
    s_call_b64 s[0:1], L_stage
    s_branch L_f2go
L_stage:
L_spin_13:
    ds_read_b32 v250, v254 offset:80
    s_waitcnt lgkmcnt(0)
    s_setprio 2
    v_cmp_ne_u32 vcc, 1, v250
    s_setprio 3
    s_cbranch_vccnz L_retry_14
    s_mov_b32 m0, 114688
    s_mov_b32 s76, 0
    buffer_load_dwordx4 v1, s[56:59], s76 offen lds
    s_mov_b32 m0, 81920
    s_waitcnt vmcnt(40)
    buffer_load_dwordx4 v60, s[56:59], s76 offen lds
    s_mov_b32 m0, 115712
    s_mov_b32 s76, 65536
    buffer_load_dwordx4 v1, s[56:59], s76 offen lds
    s_mov_b32 m0, 82944
    s_waitcnt vmcnt(40)
    buffer_load_dwordx4 v60, s[56:59], s76 offen lds
    s_mov_b32 m0, 116736
    s_mov_b32 s76, 131072
    buffer_load_dwordx4 v1, s[56:59], s76 offen lds
    s_mov_b32 m0, 83968
    s_waitcnt vmcnt(40)
    buffer_load_dwordx4 v60, s[56:59], s76 offen lds
    s_mov_b32 m0, 117760
    s_mov_b32 s76, 196608
    buffer_load_dwordx4 v1, s[56:59], s76 offen lds
    s_mov_b32 m0, 84992
    s_waitcnt vmcnt(40)
    buffer_load_dwordx4 v60, s[56:59], s76 offen lds
    s_mov_b32 m0, 118784
    s_mov_b32 s76, 262144
    buffer_load_dwordx4 v1, s[56:59], s76 offen lds
    s_mov_b32 m0, 86016
    s_waitcnt vmcnt(40)
    buffer_load_dwordx4 v60, s[56:59], s76 offen lds
    s_mov_b32 m0, 119808
    s_mov_b32 s76, 327680
    buffer_load_dwordx4 v1, s[56:59], s76 offen lds
    s_mov_b32 m0, 87040
    s_waitcnt vmcnt(40)
    buffer_load_dwordx4 v60, s[56:59], s76 offen lds
    s_mov_b32 m0, 120832
    s_mov_b32 s76, 393216
    buffer_load_dwordx4 v1, s[56:59], s76 offen lds
    s_mov_b32 m0, 88064
    s_waitcnt vmcnt(40)
    buffer_load_dwordx4 v60, s[56:59], s76 offen lds
    s_mov_b32 m0, 121856
    s_mov_b32 s76, 458752
    buffer_load_dwordx4 v1, s[56:59], s76 offen lds
    s_mov_b32 m0, 89088
    s_waitcnt vmcnt(40)
    buffer_load_dwordx4 v60, s[56:59], s76 offen lds
    s_mov_b32 m0, 122880
    s_mov_b32 s76, 16384
    buffer_load_dwordx4 v1, s[56:59], s76 offen lds
    s_mov_b32 m0, 90112
    s_waitcnt vmcnt(40)
    buffer_load_dwordx4 v60, s[56:59], s76 offen lds
    s_mov_b32 m0, 123904
    s_mov_b32 s76, 81920
    buffer_load_dwordx4 v1, s[56:59], s76 offen lds
    s_mov_b32 m0, 91136
    s_waitcnt vmcnt(40)
    buffer_load_dwordx4 v60, s[56:59], s76 offen lds
    s_mov_b32 m0, 124928
    s_mov_b32 s76, 147456
    buffer_load_dwordx4 v1, s[56:59], s76 offen lds
    s_mov_b32 m0, 92160
    s_waitcnt vmcnt(40)
    buffer_load_dwordx4 v60, s[56:59], s76 offen lds
    s_mov_b32 m0, 125952
    s_mov_b32 s76, 212992
    buffer_load_dwordx4 v1, s[56:59], s76 offen lds
    s_mov_b32 m0, 93184
    s_waitcnt vmcnt(40)
    buffer_load_dwordx4 v60, s[56:59], s76 offen lds
    s_mov_b32 m0, 126976
    s_mov_b32 s76, 278528
    buffer_load_dwordx4 v1, s[56:59], s76 offen lds
    s_mov_b32 m0, 94208
    s_waitcnt vmcnt(40)
    buffer_load_dwordx4 v60, s[56:59], s76 offen lds
    s_mov_b32 m0, 128000
    s_mov_b32 s76, 344064
    buffer_load_dwordx4 v1, s[56:59], s76 offen lds
    s_mov_b32 m0, 95232
    s_waitcnt vmcnt(40)
    buffer_load_dwordx4 v60, s[56:59], s76 offen lds
    s_mov_b32 m0, 129024
    s_mov_b32 s76, 409600
    buffer_load_dwordx4 v1, s[56:59], s76 offen lds
    s_mov_b32 m0, 96256
    s_waitcnt vmcnt(40)
    buffer_load_dwordx4 v60, s[56:59], s76 offen lds
    s_mov_b32 m0, 130048
    s_mov_b32 s76, 475136
    buffer_load_dwordx4 v1, s[56:59], s76 offen lds
    s_mov_b32 m0, 97280
    s_waitcnt vmcnt(40)
    buffer_load_dwordx4 v60, s[56:59], s76 offen lds
    s_mov_b32 m0, 131072
    s_mov_b32 s76, 32768
    buffer_load_dwordx4 v1, s[56:59], s76 offen lds
    s_mov_b32 m0, 98304
    s_waitcnt vmcnt(40)
    buffer_load_dwordx4 v60, s[56:59], s76 offen lds
    s_mov_b32 m0, 132096
    s_mov_b32 s76, 98304
    buffer_load_dwordx4 v1, s[56:59], s76 offen lds
    s_mov_b32 m0, 99328
    s_waitcnt vmcnt(40)
    buffer_load_dwordx4 v60, s[56:59], s76 offen lds
    s_mov_b32 m0, 133120
    s_mov_b32 s76, 163840
    buffer_load_dwordx4 v1, s[56:59], s76 offen lds
    s_mov_b32 m0, 100352
    s_waitcnt vmcnt(40)
    buffer_load_dwordx4 v60, s[56:59], s76 offen lds
    s_mov_b32 m0, 134144
    s_mov_b32 s76, 229376
    buffer_load_dwordx4 v1, s[56:59], s76 offen lds
    s_mov_b32 m0, 101376
    s_waitcnt vmcnt(40)
    buffer_load_dwordx4 v60, s[56:59], s76 offen lds
    s_mov_b32 m0, 135168
    s_mov_b32 s76, 294912
    buffer_load_dwordx4 v1, s[56:59], s76 offen lds
    s_mov_b32 m0, 102400
    s_waitcnt vmcnt(40)
    buffer_load_dwordx4 v60, s[56:59], s76 offen lds
    s_mov_b32 m0, 136192
    s_mov_b32 s76, 360448
    buffer_load_dwordx4 v1, s[56:59], s76 offen lds
    s_mov_b32 m0, 103424
    s_waitcnt vmcnt(40)
    buffer_load_dwordx4 v60, s[56:59], s76 offen lds
    s_mov_b32 m0, 137216
    s_mov_b32 s76, 425984
    buffer_load_dwordx4 v1, s[56:59], s76 offen lds
    s_mov_b32 m0, 104448
    s_waitcnt vmcnt(40)
    buffer_load_dwordx4 v60, s[56:59], s76 offen lds
    s_mov_b32 m0, 138240
    s_mov_b32 s76, 491520
    buffer_load_dwordx4 v1, s[56:59], s76 offen lds
    s_mov_b32 m0, 105472
    s_waitcnt vmcnt(40)
    buffer_load_dwordx4 v60, s[56:59], s76 offen lds
    s_mov_b32 m0, 139264
    s_mov_b32 s76, 49152
    buffer_load_dwordx4 v1, s[56:59], s76 offen lds
    s_mov_b32 m0, 106496
    s_waitcnt vmcnt(40)
    buffer_load_dwordx4 v60, s[56:59], s76 offen lds
    s_mov_b32 m0, 140288
    s_mov_b32 s76, 114688
    buffer_load_dwordx4 v1, s[56:59], s76 offen lds
    s_mov_b32 m0, 107520
    s_waitcnt vmcnt(40)
    buffer_load_dwordx4 v60, s[56:59], s76 offen lds
    s_mov_b32 m0, 141312
    s_mov_b32 s76, 180224
    buffer_load_dwordx4 v1, s[56:59], s76 offen lds
    s_mov_b32 m0, 108544
    s_waitcnt vmcnt(40)
    buffer_load_dwordx4 v60, s[56:59], s76 offen lds
    s_mov_b32 m0, 142336
    s_mov_b32 s76, 245760
    buffer_load_dwordx4 v1, s[56:59], s76 offen lds
    s_mov_b32 m0, 109568
    s_waitcnt vmcnt(40)
    buffer_load_dwordx4 v60, s[56:59], s76 offen lds
    s_mov_b32 m0, 143360
    s_mov_b32 s76, 311296
    buffer_load_dwordx4 v1, s[56:59], s76 offen lds
    s_mov_b32 m0, 110592
    s_waitcnt vmcnt(40)
    buffer_load_dwordx4 v60, s[56:59], s76 offen lds
    s_mov_b32 m0, 144384
    s_mov_b32 s76, 376832
    buffer_load_dwordx4 v1, s[56:59], s76 offen lds
    s_mov_b32 m0, 111616
    s_waitcnt vmcnt(40)
    buffer_load_dwordx4 v60, s[56:59], s76 offen lds
    s_mov_b32 m0, 145408
    s_mov_b32 s76, 442368
    buffer_load_dwordx4 v1, s[56:59], s76 offen lds
    s_mov_b32 m0, 112640
    s_waitcnt vmcnt(40)
    buffer_load_dwordx4 v60, s[56:59], s76 offen lds
    s_mov_b32 m0, 146432
    s_mov_b32 s76, 507904
    buffer_load_dwordx4 v1, s[56:59], s76 offen lds
    s_mov_b32 m0, 113664
    s_waitcnt vmcnt(40)
    buffer_load_dwordx4 v60, s[56:59], s76 offen lds
    s_waitcnt vmcnt(0)
    ds_write_b32 v254, v255 offset:272
    s_setprio 0
    s_setpc_b64 s[0:1]
L_retry_16:
    s_sub_u32 s3, s3, 1
    s_cbranch_scc1 L_exit
    s_sleep 2
    s_branch L_spin_15
L_retry_18:
    s_sub_u32 s3, s3, 1
    s_cbranch_scc1 L_exit
    s_sleep 8
    s_branch L_poll_17
L_lslow:
L_poll_17:
    buffer_load_dwordx2 v[6:7], v0, s[12:15], s67 offen sc1
    s_waitcnt vmcnt(0)
    s_setprio 2
    v_cmp_ne_u64 vcc, s[26:27], v[6:7]
    s_setprio 0
    s_cbranch_vccnz L_retry_18
    s_branch L_lok
L_retry_23:
    s_sub_u32 s3, s3, 1
    s_cbranch_scc1 L_exit
    s_sleep 1
    s_branch L_spin_22
L_retry_25:
    s_sub_u32 s3, s3, 1
    s_cbranch_scc1 L_exit
    s_sleep 1
    s_branch L_spin_24
L_again_28:
    s_sub_u32 s3, s3, 1
    s_cbranch_scc1 L_exit
    buffer_load_dwordx4 v[24:27], v252, s[12:15], s16 offen sc1
    buffer_load_dwordx4 v[28:31], v252, s[12:15], s17 offen sc1
    buffer_load_dwordx4 v[32:35], v252, s[12:15], s18 offen sc1
    buffer_load_dwordx4 v[36:39], v252, s[12:15], s19 offen sc1
    s_waitcnt vmcnt(0)
    v_max3_u32 v250, v24, v27, v28
    v_max3_u32 v250, v31, v32, v250
    v_max3_u32 v250, v35, v36, v250
    v_max_u32 v250, v39, v250
    v_cmp_eq_u32 vcc, -1, v250
    s_nop 0
    s_cbranch_vccnz L_again_28
    s_branch L_ok_27
L_again_30:
    s_sub_u32 s3, s3, 1
    s_cbranch_scc1 L_exit
    buffer_load_dwordx4 v[40:43], v252, s[12:15], s16 offen offset:1024 sc1
    buffer_load_dwordx4 v[44:47], v252, s[12:15], s17 offen offset:1024 sc1
    buffer_load_dwordx4 v[48:51], v252, s[12:15], s18 offen offset:1024 sc1
    buffer_load_dwordx4 v[52:55], v252, s[12:15], s19 offen offset:1024 sc1
    s_waitcnt vmcnt(0)
    v_max3_u32 v250, v40, v43, v44
    v_max3_u32 v250, v47, v48, v250
    v_max3_u32 v250, v51, v52, v250
    v_max_u32 v250, v55, v250
    v_cmp_eq_u32 vcc, -1, v250
    s_nop 0
    s_cbranch_vccnz L_again_30
    s_branch L_ok_29
L_again_32:
    s_sub_u32 s3, s3, 1
    s_cbranch_scc1 L_exit
    buffer_load_dwordx4 v[56:59], v252, s[12:15], s16 offen offset:2048 sc1
    buffer_load_dwordx4 v[60:63], v252, s[12:15], s17 offen offset:2048 sc1
    buffer_load_dwordx4 v[64:67], v252, s[12:15], s18 offen offset:2048 sc1
    buffer_load_dwordx4 v[68:71], v252, s[12:15], s19 offen offset:2048 sc1
    s_waitcnt vmcnt(0)
    v_max3_u32 v250, v56, v59, v60
    v_max3_u32 v250, v63, v64, v250
    v_max3_u32 v250, v67, v68, v250
    v_max_u32 v250, v71, v250
    v_cmp_eq_u32 vcc, -1, v250
    s_nop 0
    s_cbranch_vccnz L_again_32
    s_branch L_ok_31
L_again_34:
    s_sub_u32 s3, s3, 1
    s_cbranch_scc1 L_exit
    buffer_load_dwordx4 v[24:27], v252, s[12:15], s16 offen offset:3072 sc1
    buffer_load_dwordx4 v[28:31], v252, s[12:15], s17 offen offset:3072 sc1
    buffer_load_dwordx4 v[32:35], v252, s[12:15], s18 offen offset:3072 sc1
    buffer_load_dwordx4 v[36:39], v252, s[12:15], s19 offen offset:3072 sc1
    s_waitcnt vmcnt(0)
    v_max3_u32 v250, v24, v27, v28
    v_max3_u32 v250, v31, v32, v250
    v_max3_u32 v250, v35, v36, v250
    v_max_u32 v250, v39, v250
    v_cmp_eq_u32 vcc, -1, v250
    s_nop 0
    s_cbranch_vccnz L_again_34
    s_branch L_ok_33
L_again_37:
    s_sub_u32 s3, s3, 1
    s_cbranch_scc1 L_exit
    buffer_load_dwordx4 v[40:43], v252, s[12:15], s80 offen sc1
    buffer_load_dwordx4 v[44:47], v252, s[12:15], s81 offen sc1
    buffer_load_dwordx4 v[48:51], v252, s[12:15], s82 offen sc1
    buffer_load_dwordx4 v[52:55], v252, s[12:15], s83 offen sc1
    s_waitcnt vmcnt(0)
    v_max3_u32 v250, v40, v43, v44
    v_max3_u32 v250, v47, v48, v250
    v_max3_u32 v250, v51, v52, v250
    v_max_u32 v250, v55, v250
    v_cmp_eq_u32 vcc, -1, v250
    s_nop 0
    s_cbranch_vccnz L_again_37
    s_branch L_ok_36
L_again_39:
    s_sub_u32 s3, s3, 1
    s_cbranch_scc1 L_exit
    buffer_load_dwordx4 v[56:59], v252, s[12:15], s80 offen offset:1024 sc1
    buffer_load_dwordx4 v[60:63], v252, s[12:15], s81 offen offset:1024 sc1
    buffer_load_dwordx4 v[64:67], v252, s[12:15], s82 offen offset:1024 sc1
    buffer_load_dwordx4 v[68:71], v252, s[12:15], s83 offen offset:1024 sc1
    s_waitcnt vmcnt(0)
    v_max3_u32 v250, v56, v59, v60
    v_max3_u32 v250, v63, v64, v250
    v_max3_u32 v250, v67, v68, v250
    v_max_u32 v250, v71, v250
    v_cmp_eq_u32 vcc, -1, v250
    s_nop 0
    s_cbranch_vccnz L_again_39
    s_branch L_ok_38
L_again_41:
    s_sub_u32 s3, s3, 1
    s_cbranch_scc1 L_exit
    buffer_load_dwordx4 v[24:27], v252, s[12:15], s80 offen offset:2048 sc1
    buffer_load_dwordx4 v[28:31], v252, s[12:15], s81 offen offset:2048 sc1
    buffer_load_dwordx4 v[32:35], v252, s[12:15], s82 offen offset:2048 sc1
    buffer_load_dwordx4 v[36:39], v252, s[12:15], s83 offen offset:2048 sc1
    s_waitcnt vmcnt(0)
    v_max3_u32 v250, v24, v27, v28
    v_max3_u32 v250, v31, v32, v250
    v_max3_u32 v250, v35, v36, v250
    v_max_u32 v250, v39, v250
    v_cmp_eq_u32 vcc, -1, v250
    s_nop 0
    s_cbranch_vccnz L_again_41
    s_branch L_ok_40
L_again_46:
    s_sub_u32 s3, s3, 1
    s_cbranch_scc1 L_exit
    s_sleep 4
    buffer_load_dwordx4 v[24:27], v252, s[12:15], s16 offen sc1
    buffer_load_dwordx4 v[28:31], v252, s[12:15], s17 offen sc1
    buffer_load_dwordx4 v[32:35], v252, s[12:15], s18 offen sc1
    buffer_load_dwordx4 v[36:39], v252, s[12:15], s19 offen sc1
    s_waitcnt vmcnt(0)
    s_branch L_chk_45
L_again_48:
    s_sub_u32 s3, s3, 1
    s_cbranch_scc1 L_exit
    s_sleep 4
    buffer_load_dwordx4 v[40:43], v252, s[12:15], s16 offen offset:1024 sc1
    buffer_load_dwordx4 v[44:47], v252, s[12:15], s17 offen offset:1024 sc1
    buffer_load_dwordx4 v[48:51], v252, s[12:15], s18 offen offset:1024 sc1
    buffer_load_dwordx4 v[52:55], v252, s[12:15], s19 offen offset:1024 sc1
    s_waitcnt vmcnt(0)
    s_branch L_chk_47
L_again_50:
    s_sub_u32 s3, s3, 1
    s_cbranch_scc1 L_exit
    s_sleep 4
    buffer_load_dwordx4 v[56:59], v252, s[12:15], s16 offen offset:2048 sc1
    buffer_load_dwordx4 v[60:63], v252, s[12:15], s17 offen offset:2048 sc1
    buffer_load_dwordx4 v[64:67], v252, s[12:15], s18 offen offset:2048 sc1
    buffer_load_dwordx4 v[68:71], v252, s[12:15], s19 offen offset:2048 sc1
    s_waitcnt vmcnt(0)
    s_branch L_chk_49
L_again_53:
    s_sub_u32 s3, s3, 1
    s_cbranch_scc1 L_exit
    s_sleep 4
    buffer_load_dwordx4 v[24:27], v252, s[12:15], s16 offen offset:3072 sc1
    buffer_load_dwordx4 v[28:31], v252, s[12:15], s17 offen offset:3072 sc1
    buffer_load_dwordx4 v[32:35], v252, s[12:15], s18 offen offset:3072 sc1
    buffer_load_dwordx4 v[36:39], v252, s[12:15], s19 offen offset:3072 sc1
    s_branch L_chk_52
L_retry_56:
    s_sub_u32 s3, s3, 1
    s_cbranch_scc1 L_exit
    s_sleep 4
    s_branch L_wd_55
L_retry_58:
    s_sub_u32 s3, s3, 1
    s_cbranch_scc1 L_exit
    s_sleep 1
    s_branch L_wd_57
L_retry_60:
    s_sub_u32 s3, s3, 1
    s_cbranch_scc1 L_exit
    s_sleep 1
    s_branch L_wd_59
L_again_62:
    s_sub_u32 s3, s3, 1
    s_cbranch_scc1 L_exit
    buffer_load_dwordx4 v[40:43], v252, s[12:15], s80 offen sc1
    buffer_load_dwordx4 v[44:47], v252, s[12:15], s81 offen sc1
    buffer_load_dwordx4 v[48:51], v252, s[12:15], s82 offen sc1
    buffer_load_dwordx4 v[52:55], v252, s[12:15], s83 offen sc1
    s_waitcnt vmcnt(0)
    s_branch L_chk_61
L_again_64:
    s_sub_u32 s3, s3, 1
    s_cbranch_scc1 L_exit
    buffer_load_dwordx4 v[56:59], v252, s[12:15], s80 offen offset:1024 sc1
    buffer_load_dwordx4 v[60:63], v252, s[12:15], s81 offen offset:1024 sc1
    buffer_load_dwordx4 v[64:67], v252, s[12:15], s82 offen offset:1024 sc1
    buffer_load_dwordx4 v[68:71], v252, s[12:15], s83 offen offset:1024 sc1
    s_waitcnt vmcnt(0)
    s_branch L_chk_63
L_again_66:
    s_sub_u32 s3, s3, 1
    s_cbranch_scc1 L_exit
    buffer_load_dwordx4 v[24:27], v252, s[12:15], s80 offen offset:2048 sc1
    buffer_load_dwordx4 v[28:31], v252, s[12:15], s81 offen offset:2048 sc1
    buffer_load_dwordx4 v[32:35], v252, s[12:15], s82 offen offset:2048 sc1
    buffer_load_dwordx4 v[36:39], v252, s[12:15], s83 offen offset:2048 sc1
    s_branch L_chk_65
L_early:
    s_bitcmp1_b32 s76, s86
    s_cselect_b32 s89, s89, 2
    s_lshl_b32 s71, s89, 2
    s_add_u32 s71, s71, s86
    s_mov_b32 s2, 2
    s_cmp_lt_u32 s71, 7
    s_cbranch_scc0 L_noduty_44
    s_call_b64 s[0:1], L_duty
L_noduty_44:
L_chk_45:
    s_waitcnt vmcnt(11)
    s_setprio 2
    v_max_u32 v250, v24, v27
    s_waitcnt vmcnt(10)
    v_max3_u32 v250, v28, v31, v250
    s_waitcnt vmcnt(9)
    v_max3_u32 v250, v32, v35, v250
    s_waitcnt vmcnt(8)
    v_max3_u32 v250, v36, v39, v250
    v_cmp_eq_u32 vcc, -1, v250
    s_setprio 0
    s_cbranch_vccnz L_again_46
    v_mfma_f32_16x16x32_bf16 v[8:11], v[72:75], v[24:27], v[8:11]
    v_mfma_f32_16x16x32_bf16 v[12:15], v[76:79], v[24:27], v[12:15]
    v_mfma_f32_16x16x32_bf16 v[8:11], v[80:83], v[28:31], v[8:11]
    v_mfma_f32_16x16x32_bf16 v[12:15], v[84:87], v[28:31], v[12:15]
    v_mfma_f32_16x16x32_bf16 v[8:11], v[88:91], v[32:35], v[8:11]
    v_mfma_f32_16x16x32_bf16 v[12:15], v[92:95], v[32:35], v[12:15]
    v_mfma_f32_16x16x32_bf16 v[8:11], v[96:99], v[36:39], v[8:11]
    v_mfma_f32_16x16x32_bf16 v[12:15], v[100:103], v[36:39], v[12:15]
    buffer_load_dwordx4 v[24:27], v252, s[12:15], s16 offen offset:3072 sc1
    buffer_load_dwordx4 v[28:31], v252, s[12:15], s17 offen offset:3072 sc1
    buffer_load_dwordx4 v[32:35], v252, s[12:15], s18 offen offset:3072 sc1
    buffer_load_dwordx4 v[36:39], v252, s[12:15], s19 offen offset:3072 sc1
L_chk_47:
    s_waitcnt vmcnt(11)
    s_setprio 2
    v_max_u32 v250, v40, v43
    s_waitcnt vmcnt(10)
    v_max3_u32 v250, v44, v47, v250
    s_waitcnt vmcnt(9)
    v_max3_u32 v250, v48, v51, v250
    s_waitcnt vmcnt(8)
    v_max3_u32 v250, v52, v55, v250
    v_cmp_eq_u32 vcc, -1, v250
    s_setprio 0
    s_cbranch_vccnz L_again_48
    v_mfma_f32_16x16x32_bf16 v[8:11], v[104:107], v[40:43], v[8:11]
    v_mfma_f32_16x16x32_bf16 v[12:15], v[108:111], v[40:43], v[12:15]
    v_mfma_f32_16x16x32_bf16 v[8:11], v[112:115], v[44:47], v[8:11]
    v_mfma_f32_16x16x32_bf16 v[12:15], v[116:119], v[44:47], v[12:15]
    v_mfma_f32_16x16x32_bf16 v[8:11], v[120:123], v[48:51], v[8:11]
    v_mfma_f32_16x16x32_bf16 v[12:15], v[124:127], v[48:51], v[12:15]
    v_mfma_f32_16x16x32_bf16 v[8:11], v[128:131], v[52:55], v[8:11]
    v_mfma_f32_16x16x32_bf16 v[12:15], v[132:135], v[52:55], v[12:15]
L_chk_49:
    s_waitcnt vmcnt(7)
    s_setprio 2
    v_max_u32 v250, v56, v59
    s_waitcnt vmcnt(6)
    v_max3_u32 v250, v60, v63, v250
    s_waitcnt vmcnt(5)
    v_max3_u32 v250, v64, v67, v250
    s_waitcnt vmcnt(4)
    v_max3_u32 v250, v68, v71, v250
    v_cmp_eq_u32 vcc, -1, v250
    s_setprio 0
    s_cbranch_vccnz L_again_50
    v_mfma_f32_16x16x32_bf16 v[8:11], v[136:139], v[56:59], v[8:11]
    v_mfma_f32_16x16x32_bf16 v[12:15], v[140:143], v[56:59], v[12:15]
    v_mfma_f32_16x16x32_bf16 v[8:11], v[144:147], v[60:63], v[8:11]
    v_mfma_f32_16x16x32_bf16 v[12:15], v[148:151], v[60:63], v[12:15]
    v_mfma_f32_16x16x32_bf16 v[8:11], v[152:155], v[64:67], v[8:11]
    v_mfma_f32_16x16x32_bf16 v[12:15], v[156:159], v[64:67], v[12:15]
    v_mfma_f32_16x16x32_bf16 v[8:11], v[160:163], v[68:71], v[8:11]
    v_mfma_f32_16x16x32_bf16 v[12:15], v[164:167], v[68:71], v[12:15]
L_wd_51:
    ds_read_b32 v232, v254 offset:144
    ds_read_b32 v233, v254 offset:176
    s_waitcnt lgkmcnt(0)
    s_setprio 2
    v_lshl_or_b32 v232, v233, 1, v232
    v_cmp_gt_u32 vcc, 2, v232
    s_setprio 0
    s_nop 0
    s_mov_b32 s76, vcc_lo
    s_and_b64 vcc, vcc, 0
    s_bitcmp1_b32 s76, s86
    s_cselect_b32 s89, s89, 2
L_chk_52:
    s_waitcnt vmcnt(3)
    s_setprio 2
    v_max_u32 v250, v24, v27
    s_waitcnt vmcnt(2)
    v_max3_u32 v250, v28, v31, v250
    s_waitcnt vmcnt(1)
    v_max3_u32 v250, v32, v35, v250
    s_waitcnt vmcnt(0)
    v_max3_u32 v250, v36, v39, v250
    v_cmp_eq_u32 vcc, -1, v250
    s_setprio 0
    s_cbranch_vccnz L_again_53
    v_mfma_f32_16x16x32_bf16 v[8:11], v[168:171], v[24:27], v[8:11]
    v_mfma_f32_16x16x32_bf16 v[12:15], v[172:175], v[24:27], v[12:15]
    v_mfma_f32_16x16x32_bf16 v[8:11], v[176:179], v[28:31], v[8:11]
    v_mfma_f32_16x16x32_bf16 v[12:15], v[180:183], v[28:31], v[12:15]
    v_mfma_f32_16x16x32_bf16 v[8:11], v[184:187], v[32:35], v[8:11]
    v_mfma_f32_16x16x32_bf16 v[12:15], v[188:191], v[32:35], v[12:15]
    v_mfma_f32_16x16x32_bf16 v[8:11], v[192:195], v[36:39], v[8:11]
    v_mfma_f32_16x16x32_bf16 v[12:15], v[196:199], v[36:39], v[12:15]
    s_nop 5
    s_setprio 2
    v_cvt_pk_bf16_f32 v240, v8, v9
    v_cvt_pk_bf16_f32 v241, v10, v11
    v_cvt_pk_bf16_f32 v242, v12, v13
    v_cvt_pk_bf16_f32 v243, v14, v15
    buffer_store_dwordx4 v[240:243], v249, s[60:63], s22 offen
    s_setprio 0
    s_lshl_b32 s71, s89, 2
    s_add_u32 s71, s71, s86
    s_mov_b32 s2, 2
    s_cmp_lt_u32 s71, 7
    s_cbranch_scc0 L_noduty_54
    s_call_b64 s[0:1], L_duty
L_noduty_54:
L_wd_55:
    ds_read_b32 v232, v254 offset:144
    ds_read_b32 v233, v254 offset:176
    s_waitcnt lgkmcnt(0)
    s_setprio 2
    v_lshl_or_b32 v232, v233, 1, v232
    v_cmp_gt_u32 vcc, 2, v232
    s_setprio 0
    s_nop 0
    s_mov_b32 s76, vcc_lo
    s_and_b64 vcc, vcc, 7
    s_cbranch_vccnz L_retry_56
    buffer_load_dwordx4 v[40:43], v252, s[12:15], s80 offen sc1
    buffer_load_dwordx4 v[44:47], v252, s[12:15], s81 offen sc1
    buffer_load_dwordx4 v[48:51], v252, s[12:15], s82 offen sc1
    buffer_load_dwordx4 v[52:55], v252, s[12:15], s83 offen sc1
    buffer_load_dwordx4 v[56:59], v252, s[12:15], s80 offen offset:1024 sc1
    buffer_load_dwordx4 v[60:63], v252, s[12:15], s81 offen offset:1024 sc1
    buffer_load_dwordx4 v[64:67], v252, s[12:15], s82 offen offset:1024 sc1
    buffer_load_dwordx4 v[68:71], v252, s[12:15], s83 offen offset:1024 sc1
L_wd_57:
    ds_read_b32 v232, v254 offset:144
    ds_read_b32 v233, v254 offset:176
    s_waitcnt lgkmcnt(0)
    s_setprio 2
    v_lshl_or_b32 v232, v233, 1, v232
    v_cmp_gt_u32 vcc, 2, v232
    s_setprio 0
    s_nop 0
    s_mov_b32 s76, vcc_lo
    s_and_b64 vcc, vcc, 8
    s_cbranch_vccnz L_retry_58
    buffer_load_dwordx4 v[24:27], v252, s[12:15], s80 offen offset:2048 sc1
    buffer_load_dwordx4 v[28:31], v252, s[12:15], s81 offen offset:2048 sc1
    buffer_load_dwordx4 v[32:35], v252, s[12:15], s82 offen offset:2048 sc1
    buffer_load_dwordx4 v[36:39], v252, s[12:15], s83 offen offset:2048 sc1
    s_branch L_mid2
L_mid:
    s_setprio 0
L_wd_59:
    ds_read_b32 v232, v254 offset:144
    ds_read_b32 v233, v254 offset:176
    s_waitcnt lgkmcnt(0)
    s_setprio 2
    v_lshl_or_b32 v232, v233, 1, v232
    v_cmp_gt_u32 vcc, 2, v232
    s_setprio 0
    s_nop 0
    s_mov_b32 s76, vcc_lo
    s_and_b64 vcc, vcc, 8
    s_cbranch_vccnz L_retry_60
L_mid2:
    ds_read_b128 v[200:203], v248
    ds_read_b128 v[204:207], v248 offset:512
    ds_read_b128 v[208:211], v248 offset:12288
    ds_read_b128 v[212:215], v248 offset:12800
    ds_read_b128 v[216:219], v248 offset:24576
    ds_read_b128 v[220:223], v248 offset:25088
    ds_read_b128 v[224:227], v248 offset:36864
    ds_read_b128 v[228:231], v248 offset:37376
    s_waitcnt vmcnt(12) lgkmcnt(4)
    s_setprio 2
    v_pk_add_f32 v[200:201], v[200:201], v[208:209]
    v_pk_add_f32 v[202:203], v[202:203], v[210:211]
    v_pk_add_f32 v[204:205], v[204:205], v[212:213]
    v_pk_add_f32 v[206:207], v[206:207], v[214:215]
    s_waitcnt lgkmcnt(0)
    v_pk_add_f32 v[216:217], v[216:217], v[224:225]
    v_pk_add_f32 v[218:219], v[218:219], v[226:227]
    v_pk_add_f32 v[220:221], v[220:221], v[228:229]
    v_pk_add_f32 v[222:223], v[222:223], v[230:231]
    v_pk_add_f32 v[200:201], v[200:201], v[216:217]
    v_pk_add_f32 v[202:203], v[202:203], v[218:219]
    v_pk_add_f32 v[204:205], v[204:205], v[220:221]
    v_pk_add_f32 v[206:207], v[206:207], v[222:223]
    v_dot2_f32_bf16 v16, v244, s68, v200
    v_dot2_f32_bf16 v17, v244, s69, v201
    v_dot2_f32_bf16 v18, v245, s68, v202
    v_dot2_f32_bf16 v19, v245, s69, v203
    v_dot2_f32_bf16 v20, v246, s68, v204
    v_dot2_f32_bf16 v21, v246, s69, v205
    v_dot2_f32_bf16 v22, v247, s68, v206
    v_dot2_f32_bf16 v23, v247, s69, v207
    s_setprio 0
L_chk_61:
    s_waitcnt vmcnt(11)
    s_setprio 2
    v_max_u32 v250, v40, v43
    s_waitcnt vmcnt(10)
    v_max3_u32 v250, v44, v47, v250
    s_waitcnt vmcnt(9)
    v_max3_u32 v250, v48, v51, v250
    s_waitcnt vmcnt(8)
    v_max3_u32 v250, v52, v55, v250
    v_cmp_eq_u32 vcc, -1, v250
    s_setprio 0
    s_cbranch_vccnz L_again_62
    v_mfma_f32_16x16x32_bf16 v[16:19], v[72:75], v[40:43], v[16:19]
    v_mfma_f32_16x16x32_bf16 v[20:23], v[76:79], v[40:43], v[20:23]
    v_mfma_f32_16x16x32_bf16 v[16:19], v[80:83], v[44:47], v[16:19]
    v_mfma_f32_16x16x32_bf16 v[20:23], v[84:87], v[44:47], v[20:23]
    v_mfma_f32_16x16x32_bf16 v[16:19], v[88:91], v[48:51], v[16:19]
    v_mfma_f32_16x16x32_bf16 v[20:23], v[92:95], v[48:51], v[20:23]
    v_mfma_f32_16x16x32_bf16 v[16:19], v[96:99], v[52:55], v[16:19]
    v_mfma_f32_16x16x32_bf16 v[20:23], v[100:103], v[52:55], v[20:23]
L_chk_63:
    s_waitcnt vmcnt(7)
    s_setprio 2
    v_max_u32 v250, v56, v59
    s_waitcnt vmcnt(6)
    v_max3_u32 v250, v60, v63, v250
    s_waitcnt vmcnt(5)
    v_max3_u32 v250, v64, v67, v250
    s_waitcnt vmcnt(4)
    v_max3_u32 v250, v68, v71, v250
    v_cmp_eq_u32 vcc, -1, v250
    s_setprio 0
    s_cbranch_vccnz L_again_64
    v_mfma_f32_16x16x32_bf16 v[16:19], v[104:107], v[56:59], v[16:19]
    v_mfma_f32_16x16x32_bf16 v[20:23], v[108:111], v[56:59], v[20:23]
    v_mfma_f32_16x16x32_bf16 v[16:19], v[112:115], v[60:63], v[16:19]
    v_mfma_f32_16x16x32_bf16 v[20:23], v[116:119], v[60:63], v[20:23]
    v_mfma_f32_16x16x32_bf16 v[16:19], v[120:123], v[64:67], v[16:19]
    v_mfma_f32_16x16x32_bf16 v[20:23], v[124:127], v[64:67], v[20:23]
    v_mfma_f32_16x16x32_bf16 v[16:19], v[128:131], v[68:71], v[16:19]
    v_mfma_f32_16x16x32_bf16 v[20:23], v[132:135], v[68:71], v[20:23]
L_chk_65:
    s_waitcnt vmcnt(3)
    s_setprio 2
    v_max_u32 v250, v24, v27
    s_waitcnt vmcnt(2)
    v_max3_u32 v250, v28, v31, v250
    s_waitcnt vmcnt(1)
    v_max3_u32 v250, v32, v35, v250
    s_waitcnt vmcnt(0)
    v_max3_u32 v250, v36, v39, v250
    v_cmp_eq_u32 vcc, -1, v250
    s_setprio 0
    s_cbranch_vccnz L_again_66
    v_mfma_f32_16x16x32_bf16 v[16:19], v[136:139], v[24:27], v[16:19]
    v_mfma_f32_16x16x32_bf16 v[20:23], v[140:143], v[24:27], v[20:23]
    v_mfma_f32_16x16x32_bf16 v[16:19], v[144:147], v[28:31], v[16:19]
    v_mfma_f32_16x16x32_bf16 v[20:23], v[148:151], v[28:31], v[20:23]
    v_mfma_f32_16x16x32_bf16 v[16:19], v[152:155], v[32:35], v[16:19]
    v_mfma_f32_16x16x32_bf16 v[20:23], v[156:159], v[32:35], v[20:23]
    v_mfma_f32_16x16x32_bf16 v[16:19], v[160:163], v[36:39], v[16:19]
    v_mfma_f32_16x16x32_bf16 v[20:23], v[164:167], v[36:39], v[20:23]
    buffer_load_dwordx4 v[40:43], v252, s[12:15], s80 offen offset:3072 sc1
    buffer_load_dwordx4 v[44:47], v252, s[12:15], s81 offen offset:3072 sc1
    buffer_load_dwordx4 v[48:51], v252, s[12:15], s82 offen offset:3072 sc1
    buffer_load_dwordx4 v[52:55], v252, s[12:15], s83 offen offset:3072 sc1
    s_branch L_last
L_retry_68:
    s_sub_u32 s3, s3, 1
    s_cbranch_scc1 L_exit
    s_branch L_spin_67
L_rs_69:
    s_sub_u32 s3, s3, 1
    s_cbranch_scc1 L_exit
    ds_read_b32 v53, v254 offset:128
    ds_read_b32 v68, v45
    s_branch L_rsok_70
L_rs_72:
    s_sub_u32 s3, s3, 1
    s_cbranch_scc1 L_exit
    ds_read_b32 v53, v254 offset:128
    ds_read_b128 v[68:71], v46
    s_branch L_rsok_73
L_tag:
    s_sub_u32 s3, s3, 1
    s_cbranch_scc1 L_exit
    s_sleep 2
    buffer_load_dwordx2 v[54:55], v52, s[44:47], 0 offen sc1
    s_branch L_tagchk
L_retry_76:
    s_sub_u32 s3, s3, 1
    s_cbranch_scc1 L_exit
    s_branch L_spin_75
L_retry_77:
    s_sub_u32 s3, s3, 1
    s_cbranch_scc1 L_exit
    s_mov_b64 exec, vcc
    s_branch L_kvpoll
L_retry_79:
    s_sub_u32 s3, s3, 1
    s_cbranch_scc1 L_exit
    s_branch L_spin_78
L_qslow:
    s_sub_u32 s3, s3, 1
    s_cbranch_scc1 L_exit
    s_sleep 1
    ds_read_b32 v3, v7 offset:48
    s_waitcnt lgkmcnt(0)
    v_cmp_ne_u32 vcc, 1, v3
    s_nop 1
    s_and_b64 vcc, vcc, 15
    s_cbranch_vccnz L_qslow
    s_branch L_qok
L_f0slow:
    s_sub_u32 s3, s3, 1
    s_cbranch_scc1 L_exit
    s_sleep 1
    ds_read_b32 v3, v7 offset:352
    s_waitcnt lgkmcnt(0)
    v_cmp_ne_u32 vcc, 1, v3
    s_nop 1
    s_and_b64 vcc, vcc, 1
    s_cbranch_vccnz L_f0slow
    s_branch L_f0ok
L_f1slow:
    s_sub_u32 s3, s3, 1
    s_cbranch_scc1 L_exit
    s_sleep 1
    ds_read_b32 v3, v7 offset:352
    s_waitcnt lgkmcnt(0)
    v_cmp_ne_u32 vcc, 1, v3
    s_nop 1
    s_and_b64 vcc, vcc, 6
    s_cbranch_vccnz L_f1slow
    s_branch L_f1ok
L_f3slow:
    s_sub_u32 s3, s3, 1
    s_cbranch_scc1 L_exit
    s_sleep 1
    ds_read_b32 v3, v7 offset:352
    s_waitcnt lgkmcnt(0)
    v_cmp_ne_u32 vcc, 1, v3
    s_nop 1
    s_and_b64 vcc, vcc, 8
    s_cbranch_vccnz L_f3slow
    s_branch L_f3ok
L_retry_80:
    s_sub_u32 s3, s3, 1
    s_cbranch_scc1 L_exit
    s_branch L_status
L_code_end:
L_slow:
L_spin_81:
    ds_read_b32 v3, v7 offset:112
    s_waitcnt lgkmcnt(0)
    v_cmp_ne_u32 vcc, 1, v3
    s_nop 0
    s_cbranch_vccnz L_retry_82
    s_lshl_b32 s71, s4, 8
    s_add_u32 s71, s71, 161792
    v_lshl_add_u32 v2, v0, 2, s71
    v_and_b32 v4, 31, v0
    v_lshlrev_b32 v4, 2, v4
    v_add_u32 v4, 161792, v4
    v_add_u32 v6, 6144, v6
    v_add_u32 v254, 49152, v1
    v_mov_b32 v255, 0xdddddddd
    s_lshl_b32 s73, s5, 16
    s_lshl_b32 s74, s6, 12
    s_add_u32 s73, s73, s74
    s_add_u32 s73, s73, 0x40000
    s_mov_b32 s89, 0
    s_mov_b32 s75, 0
L_slow_loop:
    ds_read_b128 v[248:251], v252
    v_mov_b32 v3, 0xff800000
    s_waitcnt lgkmcnt(0)
    v_add_u32 v252, 1024, v252
    v_mfma_f32_32x32x16_bf16 v[200:215], v[8:11], v[248:251], 0
    s_nop 11
    v_max3_f32 v3, v3, v200, v201
    v_max3_f32 v3, v3, v202, v203
    v_max3_f32 v3, v3, v204, v205
    v_max3_f32 v3, v3, v206, v207
    v_max3_f32 v3, v3, v208, v209
    v_max3_f32 v3, v3, v210, v211
    v_max3_f32 v3, v3, v212, v213
    v_max3_f32 v3, v3, v214, v215
    v_mfma_f32_32x32x16_bf16 v[200:215], v[12:15], v[248:251], 0
    s_nop 11
    v_max3_f32 v3, v3, v200, v201
    v_max3_f32 v3, v3, v202, v203
    v_max3_f32 v3, v3, v204, v205
    v_max3_f32 v3, v3, v206, v207
    v_max3_f32 v3, v3, v208, v209
    v_max3_f32 v3, v3, v210, v211
    v_max3_f32 v3, v3, v212, v213
    v_max3_f32 v3, v3, v214, v215
    v_mfma_f32_32x32x16_bf16 v[200:215], v[16:19], v[248:251], 0
    s_nop 11
    v_max3_f32 v3, v3, v200, v201
    v_max3_f32 v3, v3, v202, v203
    v_max3_f32 v3, v3, v204, v205
    v_max3_f32 v3, v3, v206, v207
    v_max3_f32 v3, v3, v208, v209
    v_max3_f32 v3, v3, v210, v211
    v_max3_f32 v3, v3, v212, v213
    v_max3_f32 v3, v3, v214, v215
    v_mfma_f32_32x32x16_bf16 v[200:215], v[20:23], v[248:251], 0
    s_nop 11
    v_max3_f32 v3, v3, v200, v201
    v_max3_f32 v3, v3, v202, v203
    v_max3_f32 v3, v3, v204, v205
    v_max3_f32 v3, v3, v206, v207
    v_max3_f32 v3, v3, v208, v209
    v_max3_f32 v3, v3, v210, v211
    v_max3_f32 v3, v3, v212, v213
    v_max3_f32 v3, v3, v214, v215
    v_mfma_f32_32x32x16_bf16 v[200:215], v[24:27], v[248:251], 0
    s_nop 11
    v_max3_f32 v3, v3, v200, v201
    v_max3_f32 v3, v3, v202, v203
    v_max3_f32 v3, v3, v204, v205
    v_max3_f32 v3, v3, v206, v207
    v_max3_f32 v3, v3, v208, v209
    v_max3_f32 v3, v3, v210, v211
    v_max3_f32 v3, v3, v212, v213
    v_max3_f32 v3, v3, v214, v215
    v_mfma_f32_32x32x16_bf16 v[200:215], v[28:31], v[248:251], 0
    s_nop 11
    v_max3_f32 v3, v3, v200, v201
    v_max3_f32 v3, v3, v202, v203
    v_max3_f32 v3, v3, v204, v205
    v_max3_f32 v3, v3, v206, v207
    v_max3_f32 v3, v3, v208, v209
    v_max3_f32 v3, v3, v210, v211
    v_max3_f32 v3, v3, v212, v213
    v_max3_f32 v3, v3, v214, v215
    v_mfma_f32_32x32x16_bf16 v[200:215], v[32:35], v[248:251], 0
    s_nop 11
    v_max3_f32 v3, v3, v200, v201
    v_max3_f32 v3, v3, v202, v203
    v_max3_f32 v3, v3, v204, v205
    v_max3_f32 v3, v3, v206, v207
    v_max3_f32 v3, v3, v208, v209
    v_max3_f32 v3, v3, v210, v211
    v_max3_f32 v3, v3, v212, v213
    v_max3_f32 v3, v3, v214, v215
    v_mfma_f32_32x32x16_bf16 v[200:215], v[36:39], v[248:251], 0
    s_nop 11
    v_max3_f32 v3, v3, v200, v201
    v_max3_f32 v3, v3, v202, v203
    v_max3_f32 v3, v3, v204, v205
    v_max3_f32 v3, v3, v206, v207
    v_max3_f32 v3, v3, v208, v209
    v_max3_f32 v3, v3, v210, v211
    v_max3_f32 v3, v3, v212, v213
    v_max3_f32 v3, v3, v214, v215
    v_mfma_f32_32x32x16_bf16 v[200:215], v[40:43], v[248:251], 0
    s_nop 11
    v_max3_f32 v3, v3, v200, v201
    v_max3_f32 v3, v3, v202, v203
    v_max3_f32 v3, v3, v204, v205
    v_max3_f32 v3, v3, v206, v207
    v_max3_f32 v3, v3, v208, v209
    v_max3_f32 v3, v3, v210, v211
    v_max3_f32 v3, v3, v212, v213
    v_max3_f32 v3, v3, v214, v215
    v_mfma_f32_32x32x16_bf16 v[200:215], v[44:47], v[248:251], 0
    s_nop 11
    v_max3_f32 v3, v3, v200, v201
    v_max3_f32 v3, v3, v202, v203
    v_max3_f32 v3, v3, v204, v205
    v_max3_f32 v3, v3, v206, v207
    v_max3_f32 v3, v3, v208, v209
    v_max3_f32 v3, v3, v210, v211
    v_max3_f32 v3, v3, v212, v213
    v_max3_f32 v3, v3, v214, v215
    v_mfma_f32_32x32x16_bf16 v[200:215], v[48:51], v[248:251], 0
    s_nop 11
    v_max3_f32 v3, v3, v200, v201
    v_max3_f32 v3, v3, v202, v203
    v_max3_f32 v3, v3, v204, v205
    v_max3_f32 v3, v3, v206, v207
    v_max3_f32 v3, v3, v208, v209
    v_max3_f32 v3, v3, v210, v211
    v_max3_f32 v3, v3, v212, v213
    v_max3_f32 v3, v3, v214, v215
    v_mfma_f32_32x32x16_bf16 v[200:215], v[52:55], v[248:251], 0
    s_nop 11
    v_max3_f32 v3, v3, v200, v201
    v_max3_f32 v3, v3, v202, v203
    v_max3_f32 v3, v3, v204, v205
    v_max3_f32 v3, v3, v206, v207
    v_max3_f32 v3, v3, v208, v209
    v_max3_f32 v3, v3, v210, v211
    v_max3_f32 v3, v3, v212, v213
    v_max3_f32 v3, v3, v214, v215
    v_mfma_f32_32x32x16_bf16 v[200:215], v[56:59], v[248:251], 0
    s_nop 11
    v_max3_f32 v3, v3, v200, v201
    v_max3_f32 v3, v3, v202, v203
    v_max3_f32 v3, v3, v204, v205
    v_max3_f32 v3, v3, v206, v207
    v_max3_f32 v3, v3, v208, v209
    v_max3_f32 v3, v3, v210, v211
    v_max3_f32 v3, v3, v212, v213
    v_max3_f32 v3, v3, v214, v215
    v_mfma_f32_32x32x16_bf16 v[200:215], v[60:63], v[248:251], 0
    s_nop 11
    v_max3_f32 v3, v3, v200, v201
    v_max3_f32 v3, v3, v202, v203
    v_max3_f32 v3, v3, v204, v205
    v_max3_f32 v3, v3, v206, v207
    v_max3_f32 v3, v3, v208, v209
    v_max3_f32 v3, v3, v210, v211
    v_max3_f32 v3, v3, v212, v213
    v_max3_f32 v3, v3, v214, v215
    v_mfma_f32_32x32x16_bf16 v[200:215], v[64:67], v[248:251], 0
    s_nop 11
    v_max3_f32 v3, v3, v200, v201
    v_max3_f32 v3, v3, v202, v203
    v_max3_f32 v3, v3, v204, v205
    v_max3_f32 v3, v3, v206, v207
    v_max3_f32 v3, v3, v208, v209
    v_max3_f32 v3, v3, v210, v211
    v_max3_f32 v3, v3, v212, v213
    v_max3_f32 v3, v3, v214, v215
    v_mfma_f32_32x32x16_bf16 v[200:215], v[68:71], v[248:251], 0
    s_nop 11
    v_max3_f32 v3, v3, v200, v201
    v_max3_f32 v3, v3, v202, v203
    v_max3_f32 v3, v3, v204, v205
    v_max3_f32 v3, v3, v206, v207
    v_max3_f32 v3, v3, v208, v209
    v_max3_f32 v3, v3, v210, v211
    v_max3_f32 v3, v3, v212, v213
    v_max3_f32 v3, v3, v214, v215
    ds_write_b32 v2, v3
    s_add_u32 s75, s75, 1
    v_mov_b32 v3, s75
    ds_write_b32 v253, v3 offset:192
L_spin_83:
    ds_read_b32 v3, v7 offset:192
    s_waitcnt lgkmcnt(0)
    v_cmp_gt_u32 vcc, s75, v3
    s_nop 0
    s_cbranch_vccnz L_retry_84
    ds_read_b32 v200, v4
    ds_read_b32 v201, v4 offset:128
    ds_read_b32 v202, v4 offset:256
    ds_read_b32 v203, v4 offset:384
    ds_read_b32 v204, v4 offset:512
    ds_read_b32 v205, v4 offset:640
    ds_read_b32 v206, v4 offset:768
    ds_read_b32 v207, v4 offset:896
    s_waitcnt lgkmcnt(0)
    v_max3_f32 v3, v200, v201, v202
    v_max3_f32 v3, v3, v203, v204
    v_max3_f32 v3, v3, v205, v206
    v_max_f32 v3, v3, v207
    v_sub_f32 v216, 0, v3
    v_mov_b32 v232, 0
    v_sub_f32 v217, 0, v3
    v_mov_b32 v233, 0
    v_sub_f32 v218, 0, v3
    v_mov_b32 v234, 0
    v_sub_f32 v219, 0, v3
    v_mov_b32 v235, 0
    v_sub_f32 v220, 0, v3
    v_mov_b32 v236, 0
    v_sub_f32 v221, 0, v3
    v_mov_b32 v237, 0
    v_sub_f32 v222, 0, v3
    v_mov_b32 v238, 0
    v_sub_f32 v223, 0, v3
    v_mov_b32 v239, 0
    v_sub_f32 v224, 0, v3
    v_mov_b32 v240, 0
    v_sub_f32 v225, 0, v3
    v_mov_b32 v241, 0
    v_sub_f32 v226, 0, v3
    v_mov_b32 v242, 0
    v_sub_f32 v227, 0, v3
    v_mov_b32 v243, 0
    v_sub_f32 v228, 0, v3
    v_mov_b32 v244, 0
    v_sub_f32 v229, 0, v3
    v_mov_b32 v245, 0
    v_sub_f32 v230, 0, v3
    v_mov_b32 v246, 0
    v_sub_f32 v231, 0, v3
    v_mov_b32 v247, 0
    s_nop 1
    v_mfma_f32_32x32x16_bf16 v[200:215], v[8:11], v[248:251], v[216:231]
    s_nop 11
    v_exp_f32 v200, v200
    v_exp_f32 v201, v201
    v_exp_f32 v202, v202
    v_exp_f32 v203, v203
    v_exp_f32 v204, v204
    v_exp_f32 v205, v205
    v_exp_f32 v206, v206
    v_exp_f32 v207, v207
    v_exp_f32 v208, v208
    v_exp_f32 v209, v209
    v_exp_f32 v210, v210
    v_exp_f32 v211, v211
    v_exp_f32 v212, v212
    v_exp_f32 v213, v213
    v_exp_f32 v214, v214
    v_exp_f32 v215, v215
    s_nop 1
    v_smfmac_f32_32x32x32_bf16 v[232:247], v[72:75], v[200:207], v255
    v_smfmac_f32_32x32x32_bf16 v[232:247], v[76:79], v[208:215], v255
    v_mfma_f32_32x32x16_bf16 v[200:215], v[12:15], v[248:251], v[216:231]
    s_nop 11
    v_exp_f32 v200, v200
    v_exp_f32 v201, v201
    v_exp_f32 v202, v202
    v_exp_f32 v203, v203
    v_exp_f32 v204, v204
    v_exp_f32 v205, v205
    v_exp_f32 v206, v206
    v_exp_f32 v207, v207
    v_exp_f32 v208, v208
    v_exp_f32 v209, v209
    v_exp_f32 v210, v210
    v_exp_f32 v211, v211
    v_exp_f32 v212, v212
    v_exp_f32 v213, v213
    v_exp_f32 v214, v214
    v_exp_f32 v215, v215
    s_nop 1
    v_smfmac_f32_32x32x32_bf16 v[232:247], v[80:83], v[200:207], v255
    v_smfmac_f32_32x32x32_bf16 v[232:247], v[84:87], v[208:215], v255
    v_mfma_f32_32x32x16_bf16 v[200:215], v[16:19], v[248:251], v[216:231]
    s_nop 11
    v_exp_f32 v200, v200
    v_exp_f32 v201, v201
    v_exp_f32 v202, v202
    v_exp_f32 v203, v203
    v_exp_f32 v204, v204
    v_exp_f32 v205, v205
    v_exp_f32 v206, v206
    v_exp_f32 v207, v207
    v_exp_f32 v208, v208
    v_exp_f32 v209, v209
    v_exp_f32 v210, v210
    v_exp_f32 v211, v211
    v_exp_f32 v212, v212
    v_exp_f32 v213, v213
    v_exp_f32 v214, v214
    v_exp_f32 v215, v215
    s_nop 1
    v_smfmac_f32_32x32x32_bf16 v[232:247], v[88:91], v[200:207], v255
    v_smfmac_f32_32x32x32_bf16 v[232:247], v[92:95], v[208:215], v255
    v_mfma_f32_32x32x16_bf16 v[200:215], v[20:23], v[248:251], v[216:231]
    s_nop 11
    v_exp_f32 v200, v200
    v_exp_f32 v201, v201
    v_exp_f32 v202, v202
    v_exp_f32 v203, v203
    v_exp_f32 v204, v204
    v_exp_f32 v205, v205
    v_exp_f32 v206, v206
    v_exp_f32 v207, v207
    v_exp_f32 v208, v208
    v_exp_f32 v209, v209
    v_exp_f32 v210, v210
    v_exp_f32 v211, v211
    v_exp_f32 v212, v212
    v_exp_f32 v213, v213
    v_exp_f32 v214, v214
    v_exp_f32 v215, v215
    s_nop 1
    v_smfmac_f32_32x32x32_bf16 v[232:247], v[96:99], v[200:207], v255
    v_smfmac_f32_32x32x32_bf16 v[232:247], v[100:103], v[208:215], v255
    v_mfma_f32_32x32x16_bf16 v[200:215], v[24:27], v[248:251], v[216:231]
    s_nop 11
    v_exp_f32 v200, v200
    v_exp_f32 v201, v201
    v_exp_f32 v202, v202
    v_exp_f32 v203, v203
    v_exp_f32 v204, v204
    v_exp_f32 v205, v205
    v_exp_f32 v206, v206
    v_exp_f32 v207, v207
    v_exp_f32 v208, v208
    v_exp_f32 v209, v209
    v_exp_f32 v210, v210
    v_exp_f32 v211, v211
    v_exp_f32 v212, v212
    v_exp_f32 v213, v213
    v_exp_f32 v214, v214
    v_exp_f32 v215, v215
    s_nop 1
    v_smfmac_f32_32x32x32_bf16 v[232:247], v[104:107], v[200:207], v255
    v_smfmac_f32_32x32x32_bf16 v[232:247], v[108:111], v[208:215], v255
    v_mfma_f32_32x32x16_bf16 v[200:215], v[28:31], v[248:251], v[216:231]
    s_nop 11
    v_exp_f32 v200, v200
    v_exp_f32 v201, v201
    v_exp_f32 v202, v202
    v_exp_f32 v203, v203
    v_exp_f32 v204, v204
    v_exp_f32 v205, v205
    v_exp_f32 v206, v206
    v_exp_f32 v207, v207
    v_exp_f32 v208, v208
    v_exp_f32 v209, v209
    v_exp_f32 v210, v210
    v_exp_f32 v211, v211
    v_exp_f32 v212, v212
    v_exp_f32 v213, v213
    v_exp_f32 v214, v214
    v_exp_f32 v215, v215
    s_nop 1
    v_smfmac_f32_32x32x32_bf16 v[232:247], v[112:115], v[200:207], v255
    v_smfmac_f32_32x32x32_bf16 v[232:247], v[116:119], v[208:215], v255
    v_mfma_f32_32x32x16_bf16 v[200:215], v[32:35], v[248:251], v[216:231]
    s_nop 11
    v_exp_f32 v200, v200
    v_exp_f32 v201, v201
    v_exp_f32 v202, v202
    v_exp_f32 v203, v203
    v_exp_f32 v204, v204
    v_exp_f32 v205, v205
    v_exp_f32 v206, v206
    v_exp_f32 v207, v207
    v_exp_f32 v208, v208
    v_exp_f32 v209, v209
    v_exp_f32 v210, v210
    v_exp_f32 v211, v211
    v_exp_f32 v212, v212
    v_exp_f32 v213, v213
    v_exp_f32 v214, v214
    v_exp_f32 v215, v215
    s_nop 1
    v_smfmac_f32_32x32x32_bf16 v[232:247], v[120:123], v[200:207], v255
    v_smfmac_f32_32x32x32_bf16 v[232:247], v[124:127], v[208:215], v255
    v_mfma_f32_32x32x16_bf16 v[200:215], v[36:39], v[248:251], v[216:231]
    s_nop 11
    v_exp_f32 v200, v200
    v_exp_f32 v201, v201
    v_exp_f32 v202, v202
    v_exp_f32 v203, v203
    v_exp_f32 v204, v204
    v_exp_f32 v205, v205
    v_exp_f32 v206, v206
    v_exp_f32 v207, v207
    v_exp_f32 v208, v208
    v_exp_f32 v209, v209
    v_exp_f32 v210, v210
    v_exp_f32 v211, v211
    v_exp_f32 v212, v212
    v_exp_f32 v213, v213
    v_exp_f32 v214, v214
    v_exp_f32 v215, v215
    s_nop 1
    v_smfmac_f32_32x32x32_bf16 v[232:247], v[128:131], v[200:207], v255
    v_smfmac_f32_32x32x32_bf16 v[232:247], v[132:135], v[208:215], v255
    v_mfma_f32_32x32x16_bf16 v[200:215], v[40:43], v[248:251], v[216:231]
    s_nop 11
    v_exp_f32 v200, v200
    v_exp_f32 v201, v201
    v_exp_f32 v202, v202
    v_exp_f32 v203, v203
    v_exp_f32 v204, v204
    v_exp_f32 v205, v205
    v_exp_f32 v206, v206
    v_exp_f32 v207, v207
    v_exp_f32 v208, v208
    v_exp_f32 v209, v209
    v_exp_f32 v210, v210
    v_exp_f32 v211, v211
    v_exp_f32 v212, v212
    v_exp_f32 v213, v213
    v_exp_f32 v214, v214
    v_exp_f32 v215, v215
    s_nop 1
    v_smfmac_f32_32x32x32_bf16 v[232:247], v[136:139], v[200:207], v255
    v_smfmac_f32_32x32x32_bf16 v[232:247], v[140:143], v[208:215], v255
    v_mfma_f32_32x32x16_bf16 v[200:215], v[44:47], v[248:251], v[216:231]
    s_nop 11
    v_exp_f32 v200, v200
    v_exp_f32 v201, v201
    v_exp_f32 v202, v202
    v_exp_f32 v203, v203
    v_exp_f32 v204, v204
    v_exp_f32 v205, v205
    v_exp_f32 v206, v206
    v_exp_f32 v207, v207
    v_exp_f32 v208, v208
    v_exp_f32 v209, v209
    v_exp_f32 v210, v210
    v_exp_f32 v211, v211
    v_exp_f32 v212, v212
    v_exp_f32 v213, v213
    v_exp_f32 v214, v214
    v_exp_f32 v215, v215
    s_nop 1
    v_smfmac_f32_32x32x32_bf16 v[232:247], v[144:147], v[200:207], v255
    v_smfmac_f32_32x32x32_bf16 v[232:247], v[148:151], v[208:215], v255
    v_mfma_f32_32x32x16_bf16 v[200:215], v[48:51], v[248:251], v[216:231]
    s_nop 11
    v_exp_f32 v200, v200
    v_exp_f32 v201, v201
    v_exp_f32 v202, v202
    v_exp_f32 v203, v203
    v_exp_f32 v204, v204
    v_exp_f32 v205, v205
    v_exp_f32 v206, v206
    v_exp_f32 v207, v207
    v_exp_f32 v208, v208
    v_exp_f32 v209, v209
    v_exp_f32 v210, v210
    v_exp_f32 v211, v211
    v_exp_f32 v212, v212
    v_exp_f32 v213, v213
    v_exp_f32 v214, v214
    v_exp_f32 v215, v215
    s_nop 1
    v_smfmac_f32_32x32x32_bf16 v[232:247], v[152:155], v[200:207], v255
    v_smfmac_f32_32x32x32_bf16 v[232:247], v[156:159], v[208:215], v255
    v_mfma_f32_32x32x16_bf16 v[200:215], v[52:55], v[248:251], v[216:231]
    s_nop 11
    v_exp_f32 v200, v200
    v_exp_f32 v201, v201
    v_exp_f32 v202, v202
    v_exp_f32 v203, v203
    v_exp_f32 v204, v204
    v_exp_f32 v205, v205
    v_exp_f32 v206, v206
    v_exp_f32 v207, v207
    v_exp_f32 v208, v208
    v_exp_f32 v209, v209
    v_exp_f32 v210, v210
    v_exp_f32 v211, v211
    v_exp_f32 v212, v212
    v_exp_f32 v213, v213
    v_exp_f32 v214, v214
    v_exp_f32 v215, v215
    s_nop 1
    v_smfmac_f32_32x32x32_bf16 v[232:247], v[160:163], v[200:207], v255
    v_smfmac_f32_32x32x32_bf16 v[232:247], v[164:167], v[208:215], v255
    v_mfma_f32_32x32x16_bf16 v[200:215], v[56:59], v[248:251], v[216:231]
    s_nop 11
    v_exp_f32 v200, v200
    v_exp_f32 v201, v201
    v_exp_f32 v202, v202
    v_exp_f32 v203, v203
    v_exp_f32 v204, v204
    v_exp_f32 v205, v205
    v_exp_f32 v206, v206
    v_exp_f32 v207, v207
    v_exp_f32 v208, v208
    v_exp_f32 v209, v209
    v_exp_f32 v210, v210
    v_exp_f32 v211, v211
    v_exp_f32 v212, v212
    v_exp_f32 v213, v213
    v_exp_f32 v214, v214
    v_exp_f32 v215, v215
    s_nop 1
    v_smfmac_f32_32x32x32_bf16 v[232:247], v[168:171], v[200:207], v255
    v_smfmac_f32_32x32x32_bf16 v[232:247], v[172:175], v[208:215], v255
    v_mfma_f32_32x32x16_bf16 v[200:215], v[60:63], v[248:251], v[216:231]
    s_nop 11
    v_exp_f32 v200, v200
    v_exp_f32 v201, v201
    v_exp_f32 v202, v202
    v_exp_f32 v203, v203
    v_exp_f32 v204, v204
    v_exp_f32 v205, v205
    v_exp_f32 v206, v206
    v_exp_f32 v207, v207
    v_exp_f32 v208, v208
    v_exp_f32 v209, v209
    v_exp_f32 v210, v210
    v_exp_f32 v211, v211
    v_exp_f32 v212, v212
    v_exp_f32 v213, v213
    v_exp_f32 v214, v214
    v_exp_f32 v215, v215
    s_nop 1
    v_smfmac_f32_32x32x32_bf16 v[232:247], v[176:179], v[200:207], v255
    v_smfmac_f32_32x32x32_bf16 v[232:247], v[180:183], v[208:215], v255
    v_mfma_f32_32x32x16_bf16 v[200:215], v[64:67], v[248:251], v[216:231]
    s_nop 11
    v_exp_f32 v200, v200
    v_exp_f32 v201, v201
    v_exp_f32 v202, v202
    v_exp_f32 v203, v203
    v_exp_f32 v204, v204
    v_exp_f32 v205, v205
    v_exp_f32 v206, v206
    v_exp_f32 v207, v207
    v_exp_f32 v208, v208
    v_exp_f32 v209, v209
    v_exp_f32 v210, v210
    v_exp_f32 v211, v211
    v_exp_f32 v212, v212
    v_exp_f32 v213, v213
    v_exp_f32 v214, v214
    v_exp_f32 v215, v215
    s_nop 1
    v_smfmac_f32_32x32x32_bf16 v[232:247], v[184:187], v[200:207], v255
    v_smfmac_f32_32x32x32_bf16 v[232:247], v[188:191], v[208:215], v255
    v_mfma_f32_32x32x16_bf16 v[200:215], v[68:71], v[248:251], v[216:231]
    s_nop 11
    v_exp_f32 v200, v200
    v_exp_f32 v201, v201
    v_exp_f32 v202, v202
    v_exp_f32 v203, v203
    v_exp_f32 v204, v204
    v_exp_f32 v205, v205
    v_exp_f32 v206, v206
    v_exp_f32 v207, v207
    v_exp_f32 v208, v208
    v_exp_f32 v209, v209
    v_exp_f32 v210, v210
    v_exp_f32 v211, v211
    v_exp_f32 v212, v212
    v_exp_f32 v213, v213
    v_exp_f32 v214, v214
    v_exp_f32 v215, v215
    s_nop 1
    v_smfmac_f32_32x32x32_bf16 v[232:247], v[192:195], v[200:207], v255
    v_smfmac_f32_32x32x32_bf16 v[232:247], v[196:199], v[208:215], v255
    s_nop 11
    ds_write_b128 v5, v[232:235]
    ds_write_b128 v5, v[236:239] offset:1024
    ds_write_b32 v6, v240
    s_add_u32 s75, s75, 1
    v_mov_b32 v3, s75
    ds_write_b32 v253, v3 offset:192
L_spin_85:
    ds_read_b32 v3, v7 offset:192
    s_waitcnt lgkmcnt(0)
    v_cmp_gt_u32 vcc, s75, v3
    s_nop 0
    s_cbranch_vccnz L_retry_86
    s_cmp_eq_u32 s4, 0
    s_cbranch_scc0 L_slow_next
    ds_read_b32 v232, v6
    ds_read_b32 v233, v6 offset:128
    ds_read_b32 v234, v6 offset:256
    ds_read_b32 v235, v6 offset:384
    ds_read_b128 v[200:203], v254
    ds_read_b128 v[204:207], v254 offset:1024
    ds_read_b128 v[208:211], v254 offset:8192
    ds_read_b128 v[212:215], v254 offset:9216
    ds_read_b128 v[216:219], v254 offset:16384
    ds_read_b128 v[220:223], v254 offset:17408
    ds_read_b128 v[224:227], v254 offset:24576
    ds_read_b128 v[228:231], v254 offset:25600
    s_waitcnt lgkmcnt(8)
    v_add_f32 v232, v232, v233
    v_add_f32 v234, v234, v235
    v_add_f32 v232, v232, v234
    v_rcp_f32 v234, v232
    s_waitcnt lgkmcnt(4)
    v_pk_add_f32 v[200:201], v[200:201], v[208:209]
    v_pk_add_f32 v[202:203], v[202:203], v[210:211]
    v_pk_add_f32 v[204:205], v[204:205], v[212:213]
    v_pk_add_f32 v[206:207], v[206:207], v[214:215]
    v_mov_b32 v235, v234
    s_waitcnt lgkmcnt(0)
    v_pk_add_f32 v[216:217], v[216:217], v[224:225]
    v_pk_add_f32 v[218:219], v[218:219], v[226:227]
    v_pk_add_f32 v[220:221], v[220:221], v[228:229]
    v_pk_add_f32 v[222:223], v[222:223], v[230:231]
    v_pk_add_f32 v[200:201], v[200:201], v[216:217]
    v_pk_add_f32 v[202:203], v[202:203], v[218:219]
    v_pk_add_f32 v[204:205], v[204:205], v[220:221]
    v_pk_add_f32 v[206:207], v[206:207], v[222:223]
    v_pk_mul_f32 v[200:201], v[200:201], v[234:235]
    v_pk_mul_f32 v[202:203], v[202:203], v[234:235]
    v_pk_mul_f32 v[204:205], v[204:205], v[234:235]
    v_pk_mul_f32 v[206:207], v[206:207], v[234:235]
    v_cvt_pk_bf16_f32 v236, v200, v201
    v_cvt_pk_bf16_f32 v237, v202, v203
    v_cvt_pk_bf16_f32 v238, v204, v205
    v_cvt_pk_bf16_f32 v239, v206, v207
    v_min_u32 v236, -2, v236
    v_min_u32 v237, -2, v237
    v_min_u32 v238, -2, v238
    v_min_u32 v239, -2, v239
    s_lshr_b32 s71, s89, 2
    s_lshl_b32 s71, s71, 15
    s_and_b32 s72, s89, 3
    s_lshl_b32 s72, s72, 10
    s_add_u32 s71, s71, s72
    s_add_u32 s71, s71, s73
    buffer_store_dwordx4 v[236:239], v1, s[12:15], s71 offen sc1
    s_waitcnt vmcnt(0)
L_slow_next:
    s_add_u32 s89, s89, 1
    s_cmp_lt_u32 s89, 8
    s_cbranch_scc1 L_slow_loop
    s_branch L_fin
L_retry_82:
    s_sub_u32 s3, s3, 1
    s_cbranch_scc1 L_exit
    s_sleep 4
    s_branch L_spin_81
L_retry_84:
    s_sub_u32 s3, s3, 1
    s_cbranch_scc1 L_exit
    s_sleep 1
    s_branch L_spin_83
L_retry_86:
    s_sub_u32 s3, s3, 1
    s_cbranch_scc1 L_exit
    s_sleep 1
    s_branch L_spin_85
.section .rodata,"a"
.p2align 6
.amdhsa_kernel parallel_sum__grouped_kv_mqa__dense_activation_silu__prompt_kernel
.amdhsa_next_free_vgpr 256
.amdhsa_next_free_sgpr 102
.amdhsa_accum_offset 256
.amdhsa_group_segment_fixed_size 0
.amdhsa_kernarg_size 88
.amdhsa_user_sgpr_count 2
.amdhsa_user_sgpr_kernarg_segment_ptr 1
.amdhsa_system_sgpr_workgroup_id_x 1
.end_amdhsa_kernel
```
